```python
import torch

def _softmax(x, axis=-1):
    return torch.softmax(x, dim=axis)
def _gelu(x):
    return torch.nn.functional.gelu(x, approximate="tanh")
def _silu(x):
    return torch.nn.functional.silu(x)
def _sigmoid(x):
    return torch.sigmoid(x)
def _layernorm(x, axis=-1, eps=1e-5):
    m = x.mean(dim=axis, keepdim=True)
    v = x.var(dim=axis, keepdim=True, unbiased=False)
    return (x - m) / torch.sqrt(v + eps)
def _scatter_add(tgt, idx, src, axis=0):
    return tgt.clone().index_add_(axis, idx, src)
def _segment_sum(src, seg, n):
    out = torch.zeros((n,) + src.shape[1:], dtype=src.dtype)
    return out.index_add_(0, seg, src)
def _pad(x, pw):
    flat = tuple(v for pair in reversed(pw) for v in pair)
    return torch.nn.functional.pad(x, flat)

kernel_name = 'gated_mix__mha_block__glu_gated_bilinear__prompt'

def setup_inputs():

    _w = (lambda a: (lambda t: t.to(torch.bfloat16) if t.is_floating_point() else t)(torch.as_tensor(a)))
    def _A_setup():
        B, S, D, H = 1, 2048, 576, 32
        return {
            "x": _w((lambda *s: torch.randn(*s, dtype=torch.bfloat16) * 0.05)(B, S, D)),
            "wqkv": _w((lambda *s: torch.randn(*s, dtype=torch.bfloat16) * 0.8)(D, 3 * D)),
            "wo": _w((lambda *s: torch.randn(*s, dtype=torch.bfloat16) * 0.05)(D, D)),
        }
    _A_in = _A_setup()

    def _B_setup():
        B, S, D, F = 1, 2048, 576, 4608
        return {
            "x": _w((lambda *s: torch.randn(*s, dtype=torch.bfloat16) * 0.05)(B, S, D)),
            "w_gate": _w((lambda *s: torch.randn(*s, dtype=torch.bfloat16) * 3.2)(D, F) * (D ** -0.5)),
            "w_up": _w((lambda *s: torch.randn(*s, dtype=torch.bfloat16) * 3.2)(D, F) * (D ** -0.5)),
            "w_down": _w((lambda *s: torch.randn(*s, dtype=torch.bfloat16) * 3.2)(F, D) * (F ** -0.5)),
        }
    _B_in = _B_setup()

    return {
        "A_x": _A_in["x"],
        "A_wqkv": _A_in["wqkv"],
        "A_wo": _A_in["wo"],
        "B_x": _B_in["x"],
        "B_w_gate": _B_in["w_gate"],
        "B_w_up": _B_in["w_up"],
        "B_w_down": _B_in["w_down"],
        "gate_w": _w((lambda *s: torch.randn(*s, dtype=torch.bfloat16) * 0.05)(576) * 16.0),
    }

def reference(A_x, A_wqkv, A_wo, B_x, B_w_gate, B_w_up, B_w_down, gate_w):
    def _A_ref(x, wqkv, wo):
        B, S, D = x.shape
        H = 32
        Dh = D // H
        qkv = (lambda x, *d: x.permute(*d))((x @ wqkv).reshape(B, S, 3, H, Dh), 2, 0, 3, 1, 4)
        q, k, v = qkv[0], qkv[1], qkv[2]
        scores = torch.einsum("bhqd,bhkd->bhqk", q, k) * (Dh ** -0.5)
        p = _softmax(scores, axis=-1)
        o = torch.einsum("bhqk,bhkd->bhqd", p, v)
        return (lambda x, *d: x.permute(*d))(o, 0, 2, 1, 3).reshape(B, S, D) @ wo

    def _B_ref(x, w_gate, w_up, w_down):
        g = torch.einsum("bsd,df->bsf", x, w_gate)
        u = torch.einsum("bsd,df->bsf", x, w_up)
        h = g * u
        return torch.einsum("bsf,fd->bsd", h, w_down)

    x = A_x
    g = _sigmoid((x * gate_w).sum(-1, keepdims=True))
    a = _A_ref(x, A_wqkv, A_wo)
    b = _B_ref(x, B_w_gate, B_w_up, B_w_down)
    return g * a + (1 - g) * b
```

```asm
; @launch kernel=l1_kernel grid=(448,1,1) block=(512,1,1) lds=155648
; @launch kernel=l2_kernel grid=(512,1,1) block=(512,1,1) lds=74880
; @launch kernel=final_kernel grid=(192,1,1) block=(256,1,1) lds=73984
.amdgcn_target "amdgcn-amd-amdhsa--gfx950"
.text
    .globl l1_kernel
    .p2align 8
    .type l1_kernel,@function
l1_kernel:
    s_cmp_lt_u32 s2, 256
    s_cbranch_scc1 l1_kernel_A
    s_sub_u32 s2, s2, 256
    v_cmp_lt_u32 vcc, 255, v0
    s_cbranch_vccnz l1_kernel_exit
    s_branch qkv_kernel_body
l1_kernel_A:
    s_branch gu_kernel_body
l1_kernel_exit:
    s_endpgm
gu_kernel_body:
    s_cmp_ge_u32 s2, 256
    s_cbranch_scc1 gu_done
    s_load_dwordx2 s[4:5], s[0:1], 0
    s_load_dwordx4 s[40:43], s[0:1], 32
    s_load_dwordx2 s[44:45], s[0:1], 80
    s_load_dwordx4 s[64:67], s[0:1], 8
    s_load_dwordx2 s[68:69], s[0:1], 48
    v_lshrrev_b32 v1, 6, v0
    s_nop 0
    v_readfirstlane_b32 s24, v1
    v_and_b32 v0, 63, v0
    s_and_b32 s30, s2, 7
    s_lshl_b32 s30, s30, 5
    s_lshr_b32 s31, s2, 3
    s_add_u32 s30, s30, s31
    s_lshr_b32 s31, s30, 3
    s_and_b32 s30, s30, 7
    s_waitcnt lgkmcnt(0)
    s_mov_b32 s8, s4
    s_mov_b32 s9, s5
    s_mov_b32 s10, 2359296
    s_mov_b32 s11, 0x00020000
    s_cmp_lt_u32 s24, 4
    s_cselect_b32 s12, s40, s42
    s_cselect_b32 s13, s41, s43
    s_mov_b32 s14, 5308416
    s_mov_b32 s15, 0x00020000
    s_add_u32 s20, s44, 8388608
    s_addc_u32 s21, s45, 0
    s_mov_b32 s22, 18874368
    s_mov_b32 s23, 0x00020000
    s_mov_b32 s72, s64
    s_mov_b32 s73, s65
    s_mov_b32 s74, 1990656
    s_mov_b32 s75, 0x00020000
    s_mov_b32 s76, s66
    s_mov_b32 s77, s67
    s_mov_b32 s78, 663552
    s_mov_b32 s79, 0x00020000
    s_mov_b32 s80, s68
    s_mov_b32 s81, s69
    s_mov_b32 s82, 5308416
    s_mov_b32 s83, 0x00020000
    s_and_b32 s29, s24, 3
    s_lshr_b32 s33, s24, 2
    s_and_b32 s34, s24, 3
    v_lshrrev_b32 v10, 2, v0
    v_lshrrev_b32 v11, 4, v0
    v_sub_u32 v11, 4, v11
    v_and_b32 v11, 3, v11
    v_and_b32 v12, 3, v0
    v_xor_b32 v12, v12, v11
    s_lshl_b32 s26, s24, 4
    v_add_u32 v10, s26, v10
    s_mov_b32 s26, 1152
    v_mul_lo_u32 v10, v10, s26
    v_lshl_add_u32 v2, v12, 4, v10
    v_add_u32 v3, 147456, v2
    v_lshrrev_b32 v10, 3, v0
    v_bfe_u32 v11, v0, 4, 1
    s_and_b32 s26, s34, 1
    s_lshl_b32 s26, s26, 1
    v_or_b32 v11, s26, v11
    v_bfe_u32 v12, v0, 1, 2
    v_xor_b32 v12, v12, v11
    v_and_b32 v13, 1, v0
    v_lshlrev_b32 v13, 4, v13
    v_lshl_add_u32 v13, v12, 5, v13
    s_lshl_b32 s26, s34, 3
    v_add_u32 v10, s26, v10
    s_mov_b32 s26, 9216
    v_mul_lo_u32 v10, v10, s26
    v_add_u32 v4, v10, v13
    v_lshrrev_b32 v10, 1, v0
    s_lshl_b32 s26, s34, 3
    v_add_u32 v10, s26, v10
    s_and_b32 s26, s34, 1
    s_lshl_b32 s26, s26, 2
    v_xor_b32 v10, s26, v10
    s_mov_b32 s26, 9216
    v_mul_lo_u32 v10, v10, s26
    v_and_b32 v11, 1, v0
    v_lshl_add_u32 v10, v11, 4, v10
    v_add_u32 v5, 256, v10
    v_bfe_u32 v10, v0, 2, 2
    v_sub_u32 v10, 4, v10
    v_and_b32 v10, 3, v10
    v_lshrrev_b32 v11, 4, v0
    v_xor_b32 v10, v10, v11
    v_and_b32 v11, 15, v0
    s_mul_i32 s26, s29, 64
    v_add_u32 v11, s26, v11
    v_lshlrev_b32 v11, 6, v11
    v_lshl_add_u32 v14, v10, 4, v11
    s_mul_i32 s26, s33, 9216
    s_add_u32 s26, s26, 16384
    v_lshrrev_b32 v10, 4, v0
    v_bfe_u32 v11, v0, 2, 2
    v_lshl_add_u32 v11, v10, 3, v11
    v_and_b32 v12, 3, v0
    v_lshlrev_b32 v13, 7, v11
    v_lshl_add_u32 v13, v12, 3, v13
    v_add_u32 v13, s26, v13
    v_bfe_u32 v6, v0, 3, 1
    v_and_b32 v7, 1, v10
    v_lshl_or_b32 v6, v7, 1, v6
    v_xor_b32 v8, 0, v6
    v_lshl_add_u32 v20, v8, 5, v13
    v_xor_b32 v8, 1, v6
    v_lshl_add_u32 v21, v8, 5, v13
    v_xor_b32 v8, 2, v6
    v_lshl_add_u32 v22, v8, 5, v13
    v_xor_b32 v8, 3, v6
    v_lshl_add_u32 v23, v8, 5, v13
    v_lshlrev_b32 v13, 5, v11
    v_lshl_add_u32 v13, v12, 3, v13
    v_add_u32 v13, s26, v13
    v_add_u32 v13, 8192, v13
    v_lshl_add_u32 v24, v7, 7, v13
    v_xor_b32 v7, 1, v7
    v_lshl_add_u32 v25, v7, 7, v13
    s_lshl_b32 s25, s24, 10
    s_mul_i32 s38, s33, 9216
    s_add_u32 s38, s38, 16384
    s_lshl_b32 s26, s34, 8
    s_add_u32 s39, s38, s26
    s_add_u32 s39, s39, 8192
    s_lshl_b32 s26, s34, 10
    s_add_u32 s38, s38, s26
    s_mul_i32 s26, s30, 294912
    s_mul_i32 s27, s31, 288
    v_mov_b32 v100, 0
    v_mov_b32 v101, 0
    v_mov_b32 v102, 0
    v_mov_b32 v103, 0
    v_mov_b32 v104, 0
    v_mov_b32 v105, 0
    v_mov_b32 v106, 0
    v_mov_b32 v107, 0
    v_mov_b32 v108, 0
    v_mov_b32 v109, 0
    v_mov_b32 v110, 0
    v_mov_b32 v111, 0
    v_mov_b32 v112, 0
    v_mov_b32 v113, 0
    v_mov_b32 v114, 0
    v_mov_b32 v115, 0
    v_mov_b32 v116, 0
    v_mov_b32 v117, 0
    v_mov_b32 v118, 0
    v_mov_b32 v119, 0
    v_mov_b32 v120, 0
    v_mov_b32 v121, 0
    v_mov_b32 v122, 0
    v_mov_b32 v123, 0
    v_mov_b32 v124, 0
    v_mov_b32 v125, 0
    v_mov_b32 v126, 0
    v_mov_b32 v127, 0
    v_mov_b32 v128, 0
    v_mov_b32 v129, 0
    v_mov_b32 v130, 0
    v_mov_b32 v131, 0
    v_mov_b32 v132, 0
    v_mov_b32 v133, 0
    v_mov_b32 v134, 0
    v_mov_b32 v135, 0
    v_mov_b32 v136, 0
    v_mov_b32 v137, 0
    v_mov_b32 v138, 0
    v_mov_b32 v139, 0
    v_mov_b32 v140, 0
    v_mov_b32 v141, 0
    v_mov_b32 v142, 0
    v_mov_b32 v143, 0
    v_mov_b32 v144, 0
    v_mov_b32 v145, 0
    v_mov_b32 v146, 0
    v_mov_b32 v147, 0
    v_mov_b32 v148, 0
    v_mov_b32 v149, 0
    v_mov_b32 v150, 0
    v_mov_b32 v151, 0
    v_mov_b32 v152, 0
    v_mov_b32 v153, 0
    v_mov_b32 v154, 0
    v_mov_b32 v155, 0
    v_mov_b32 v156, 0
    v_mov_b32 v157, 0
    v_mov_b32 v158, 0
    v_mov_b32 v159, 0
    v_mov_b32 v160, 0
    v_mov_b32 v161, 0
    v_mov_b32 v162, 0
    v_mov_b32 v163, 0
    v_mov_b32 v164, 0
    v_mov_b32 v165, 0
    v_mov_b32 v166, 0
    v_mov_b32 v167, 0
    v_mov_b32 v168, 0
    v_mov_b32 v169, 0
    v_mov_b32 v170, 0
    v_mov_b32 v171, 0
    v_mov_b32 v172, 0
    v_mov_b32 v173, 0
    v_mov_b32 v174, 0
    v_mov_b32 v175, 0
    v_mov_b32 v176, 0
    v_mov_b32 v177, 0
    v_mov_b32 v178, 0
    v_mov_b32 v179, 0
    v_mov_b32 v180, 0
    v_mov_b32 v181, 0
    v_mov_b32 v182, 0
    v_mov_b32 v183, 0
    v_mov_b32 v184, 0
    v_mov_b32 v185, 0
    v_mov_b32 v186, 0
    v_mov_b32 v187, 0
    v_mov_b32 v188, 0
    v_mov_b32 v189, 0
    v_mov_b32 v190, 0
    v_mov_b32 v191, 0
    v_mov_b32 v192, 0
    v_mov_b32 v193, 0
    v_mov_b32 v194, 0
    v_mov_b32 v195, 0
    v_mov_b32 v196, 0
    v_mov_b32 v197, 0
    v_mov_b32 v198, 0
    v_mov_b32 v199, 0
    v_mov_b32 v200, 0
    v_mov_b32 v201, 0
    v_mov_b32 v202, 0
    v_mov_b32 v203, 0
    v_mov_b32 v204, 0
    v_mov_b32 v205, 0
    v_mov_b32 v206, 0
    v_mov_b32 v207, 0
    v_mov_b32 v208, 0
    v_mov_b32 v209, 0
    v_mov_b32 v210, 0
    v_mov_b32 v211, 0
    v_mov_b32 v212, 0
    v_mov_b32 v213, 0
    v_mov_b32 v214, 0
    v_mov_b32 v215, 0
    v_mov_b32 v216, 0
    v_mov_b32 v217, 0
    v_mov_b32 v218, 0
    v_mov_b32 v219, 0
    v_mov_b32 v220, 0
    v_mov_b32 v221, 0
    v_mov_b32 v222, 0
    v_mov_b32 v223, 0
    v_mov_b32 v224, 0
    v_mov_b32 v225, 0
    v_mov_b32 v226, 0
    v_mov_b32 v227, 0
    v_mov_b32 v228, 0
    v_mov_b32 v229, 0
    v_mov_b32 v230, 0
    v_mov_b32 v231, 0
    v_mov_b32 v232, 0
    v_mov_b32 v233, 0
    v_mov_b32 v234, 0
    v_mov_b32 v235, 0
    v_mov_b32 v236, 0
    v_mov_b32 v237, 0
    v_mov_b32 v238, 0
    v_mov_b32 v239, 0
    v_mov_b32 v240, 0
    v_mov_b32 v241, 0
    v_mov_b32 v242, 0
    v_mov_b32 v243, 0
    s_add_u32 m0, s25, 0
    s_nop 0
    buffer_load_dwordx4 v2, s[8:11], s26 offen lds
    s_add_u32 m0, s25, 8192
    s_nop 0
    buffer_load_dwordx4 v3, s[8:11], s26 offen lds
    s_add_u32 m0, s38, 0
    s_add_u32 s28, s27, 128
    buffer_load_dwordx4 v4, s[12:15], s27 offen lds
    s_add_u32 m0, s38, 4096
    s_nop 0
    buffer_load_dwordx4 v4, s[12:15], s28 offen lds
    s_add_u32 m0, s39, 0
    s_mov_b64 exec, 0xffff
    buffer_load_dwordx4 v5, s[12:15], s27 offen lds
    s_mov_b64 exec, -1
    s_add_u32 s26, s26, 64
    s_add_u32 s27, s27, 294912
    s_add_u32 m0, s25, 34816
    s_nop 0
    buffer_load_dwordx4 v2, s[8:11], s26 offen lds
    s_add_u32 m0, s25, 43008
    s_nop 0
    buffer_load_dwordx4 v3, s[8:11], s26 offen lds
    s_add_u32 m0, s38, 34816
    s_add_u32 s28, s27, 128
    buffer_load_dwordx4 v4, s[12:15], s27 offen lds
    s_add_u32 m0, s38, 38912
    s_nop 0
    buffer_load_dwordx4 v4, s[12:15], s28 offen lds
    s_add_u32 m0, s39, 34816
    s_mov_b64 exec, 0xffff
    buffer_load_dwordx4 v5, s[12:15], s27 offen lds
    s_mov_b64 exec, -1
    s_add_u32 s26, s26, 64
    s_add_u32 s27, s27, 294912
    s_add_u32 m0, s25, 69632
    s_nop 0
    buffer_load_dwordx4 v2, s[8:11], s26 offen lds
    s_add_u32 m0, s25, 77824
    s_nop 0
    buffer_load_dwordx4 v3, s[8:11], s26 offen lds
    s_add_u32 m0, s38, 69632
    s_add_u32 s28, s27, 128
    buffer_load_dwordx4 v4, s[12:15], s27 offen lds
    s_add_u32 m0, s38, 73728
    s_nop 0
    buffer_load_dwordx4 v4, s[12:15], s28 offen lds
    s_add_u32 m0, s39, 69632
    s_mov_b64 exec, 0xffff
    buffer_load_dwordx4 v5, s[12:15], s27 offen lds
    s_mov_b64 exec, -1
    s_add_u32 s26, s26, 64
    s_add_u32 s27, s27, 294912
    v_lshrrev_b32 v6, 2, v0
    s_and_b32 s46, s24, 3
    s_mul_i32 s46, s46, 18
    v_add_u32 v6, s46, v6
    v_lshlrev_b32 v6, 3, v6
    v_add_u32 v6, s30, v6
    s_mov_b32 s46, 9216
    v_mul_lo_u32 v6, v6, s46
    v_and_b32 v7, 3, v0
    v_mul_u32_u24 v7, 96, v7
    v_min_u32 v7, 284, v7
    v_add_u32 v6, v6, v7
    s_mul_i32 s46, s31, 288
    buffer_load_dword v8, v6, s[12:15], s46 offen
    v_add_u32 v6, 1179648, v6
    v_cmp_gt_u32 vcc, 8, v0
    v_mov_b32 v7, 0x7f000000
    s_nop 1
    v_cndmask_b32 v6, v7, v6, vcc
    buffer_load_dword v9, v6, s[12:15], s46 offen
    s_waitcnt vmcnt(12)
    s_barrier
    ds_read_b128 v[60:63], v14 offset:0
    ds_read_b128 v[64:67], v14 offset:1024
    ds_read_b128 v[68:71], v14 offset:2048
    ds_read_b128 v[72:75], v14 offset:3072
    ds_read_b64_tr_b16 v[76:77], v20 offset:0
    ds_read_b64_tr_b16 v[78:79], v20 offset:512
    ds_read_b64_tr_b16 v[80:81], v21 offset:0
    ds_read_b64_tr_b16 v[82:83], v21 offset:512
    ds_read_b64_tr_b16 v[84:85], v22 offset:0
    ds_read_b64_tr_b16 v[86:87], v22 offset:512
    s_waitcnt lgkmcnt(0)
    ds_read_b64_tr_b16 v[88:89], v23 offset:0
    ds_read_b64_tr_b16 v[90:91], v23 offset:512
    ds_read_b64_tr_b16 v[92:93], v20 offset:4096
    ds_read_b64_tr_b16 v[94:95], v20 offset:4608
    ds_read_b64_tr_b16 v[96:97], v21 offset:4096
    ds_read_b64_tr_b16 v[98:99], v21 offset:4608
    s_add_u32 m0, s25, 104448
    s_nop 0
    buffer_load_dwordx4 v2, s[8:11], s26 offen lds
    s_add_u32 m0, s25, 112640
    s_nop 0
    buffer_load_dwordx4 v3, s[8:11], s26 offen lds
    s_add_u32 m0, s38, 104448
    s_add_u32 s28, s27, 128
    buffer_load_dwordx4 v4, s[12:15], s27 offen lds
    s_add_u32 m0, s38, 108544
    s_nop 0
    buffer_load_dwordx4 v4, s[12:15], s28 offen lds
    s_add_u32 m0, s39, 104448
    s_mov_b64 exec, 0xffff
    buffer_load_dwordx4 v5, s[12:15], s27 offen lds
    s_mov_b64 exec, -1
    s_add_u32 s26, s26, 64
    s_add_u32 s27, s27, 294912
    v_mfma_f32_16x16x32_bf16 v[100:103], v[76:79], v[60:63], v[100:103]
    v_mfma_f32_16x16x32_bf16 v[104:107], v[76:79], v[64:67], v[104:107]
    v_mfma_f32_16x16x32_bf16 v[108:111], v[76:79], v[68:71], v[108:111]
    v_mfma_f32_16x16x32_bf16 v[112:115], v[76:79], v[72:75], v[112:115]
    v_mfma_f32_16x16x32_bf16 v[116:119], v[80:83], v[60:63], v[116:119]
    v_mfma_f32_16x16x32_bf16 v[120:123], v[80:83], v[64:67], v[120:123]
    v_mfma_f32_16x16x32_bf16 v[124:127], v[80:83], v[68:71], v[124:127]
    v_mfma_f32_16x16x32_bf16 v[128:131], v[80:83], v[72:75], v[128:131]
    v_mfma_f32_16x16x32_bf16 v[132:135], v[84:87], v[60:63], v[132:135]
    v_mfma_f32_16x16x32_bf16 v[136:139], v[84:87], v[64:67], v[136:139]
    v_mfma_f32_16x16x32_bf16 v[140:143], v[84:87], v[68:71], v[140:143]
    v_mfma_f32_16x16x32_bf16 v[144:147], v[84:87], v[72:75], v[144:147]
    s_waitcnt lgkmcnt(0)
    ds_read_b64_tr_b16 v[76:77], v22 offset:4096
    ds_read_b64_tr_b16 v[78:79], v22 offset:4608
    ds_read_b64_tr_b16 v[80:81], v23 offset:4096
    ds_read_b64_tr_b16 v[82:83], v23 offset:4608
    ds_read_b64_tr_b16 v[84:85], v24
    ds_read_b64_tr_b16 v[86:87], v25
    v_mfma_f32_16x16x32_bf16 v[148:151], v[88:91], v[60:63], v[148:151]
    v_mfma_f32_16x16x32_bf16 v[152:155], v[88:91], v[64:67], v[152:155]
    v_mfma_f32_16x16x32_bf16 v[156:159], v[88:91], v[68:71], v[156:159]
    v_mfma_f32_16x16x32_bf16 v[160:163], v[88:91], v[72:75], v[160:163]
    v_mfma_f32_16x16x32_bf16 v[164:167], v[92:95], v[60:63], v[164:167]
    v_mfma_f32_16x16x32_bf16 v[168:171], v[92:95], v[64:67], v[168:171]
    v_mfma_f32_16x16x32_bf16 v[172:175], v[92:95], v[68:71], v[172:175]
    v_mfma_f32_16x16x32_bf16 v[176:179], v[92:95], v[72:75], v[176:179]
    v_mfma_f32_16x16x32_bf16 v[180:183], v[96:99], v[60:63], v[180:183]
    v_mfma_f32_16x16x32_bf16 v[184:187], v[96:99], v[64:67], v[184:187]
    v_mfma_f32_16x16x32_bf16 v[188:191], v[96:99], v[68:71], v[188:191]
    v_mfma_f32_16x16x32_bf16 v[192:195], v[96:99], v[72:75], v[192:195]
    s_waitcnt lgkmcnt(0)
    s_waitcnt vmcnt(12)
    s_barrier
    v_add_u32 v14, 34816, v14
    v_add_u32 v20, 34816, v20
    v_add_u32 v21, 34816, v21
    v_add_u32 v22, 34816, v22
    v_add_u32 v23, 34816, v23
    v_add_u32 v24, 34816, v24
    v_add_u32 v25, 34816, v25
    ds_read_b128 v[30:33], v14 offset:0
    ds_read_b128 v[34:37], v14 offset:1024
    ds_read_b128 v[38:41], v14 offset:2048
    ds_read_b128 v[42:45], v14 offset:3072
    ds_read_b64_tr_b16 v[88:89], v20 offset:0
    ds_read_b64_tr_b16 v[90:91], v20 offset:512
    ds_read_b64_tr_b16 v[92:93], v21 offset:0
    ds_read_b64_tr_b16 v[94:95], v21 offset:512
    ds_read_b64_tr_b16 v[96:97], v22 offset:0
    ds_read_b64_tr_b16 v[98:99], v22 offset:512
    v_mfma_f32_16x16x32_bf16 v[196:199], v[76:79], v[60:63], v[196:199]
    v_mfma_f32_16x16x32_bf16 v[200:203], v[76:79], v[64:67], v[200:203]
    v_mfma_f32_16x16x32_bf16 v[204:207], v[76:79], v[68:71], v[204:207]
    v_mfma_f32_16x16x32_bf16 v[208:211], v[76:79], v[72:75], v[208:211]
    v_mfma_f32_16x16x32_bf16 v[212:215], v[80:83], v[60:63], v[212:215]
    v_mfma_f32_16x16x32_bf16 v[216:219], v[80:83], v[64:67], v[216:219]
    v_mfma_f32_16x16x32_bf16 v[220:223], v[80:83], v[68:71], v[220:223]
    v_mfma_f32_16x16x32_bf16 v[224:227], v[80:83], v[72:75], v[224:227]
    v_mfma_f32_16x16x32_bf16 v[228:231], v[84:87], v[60:63], v[228:231]
    v_mfma_f32_16x16x32_bf16 v[232:235], v[84:87], v[64:67], v[232:235]
    v_mfma_f32_16x16x32_bf16 v[236:239], v[84:87], v[68:71], v[236:239]
    v_mfma_f32_16x16x32_bf16 v[240:243], v[84:87], v[72:75], v[240:243]
    s_waitcnt lgkmcnt(0)
    ds_read_b64_tr_b16 v[76:77], v23 offset:0
    ds_read_b64_tr_b16 v[78:79], v23 offset:512
    ds_read_b64_tr_b16 v[80:81], v20 offset:4096
    ds_read_b64_tr_b16 v[82:83], v20 offset:4608
    ds_read_b64_tr_b16 v[84:85], v21 offset:4096
    ds_read_b64_tr_b16 v[86:87], v21 offset:4608
    s_add_u32 m0, s25, 0
    s_nop 0
    buffer_load_dwordx4 v2, s[8:11], s26 offen lds
    s_add_u32 m0, s25, 8192
    s_nop 0
    buffer_load_dwordx4 v3, s[8:11], s26 offen lds
    s_add_u32 m0, s38, 0
    s_add_u32 s28, s27, 128
    buffer_load_dwordx4 v4, s[12:15], s27 offen lds
    s_add_u32 m0, s38, 4096
    s_nop 0
    buffer_load_dwordx4 v4, s[12:15], s28 offen lds
    s_add_u32 m0, s39, 0
    s_mov_b64 exec, 0xffff
    buffer_load_dwordx4 v5, s[12:15], s27 offen lds
    s_mov_b64 exec, -1
    s_add_u32 s26, s26, 64
    s_add_u32 s27, s27, 294912
    v_mfma_f32_16x16x32_bf16 v[100:103], v[88:91], v[30:33], v[100:103]
    v_mfma_f32_16x16x32_bf16 v[104:107], v[88:91], v[34:37], v[104:107]
    v_mfma_f32_16x16x32_bf16 v[108:111], v[88:91], v[38:41], v[108:111]
    v_mfma_f32_16x16x32_bf16 v[112:115], v[88:91], v[42:45], v[112:115]
    v_mfma_f32_16x16x32_bf16 v[116:119], v[92:95], v[30:33], v[116:119]
    v_mfma_f32_16x16x32_bf16 v[120:123], v[92:95], v[34:37], v[120:123]
    v_mfma_f32_16x16x32_bf16 v[124:127], v[92:95], v[38:41], v[124:127]
    v_mfma_f32_16x16x32_bf16 v[128:131], v[92:95], v[42:45], v[128:131]
    v_mfma_f32_16x16x32_bf16 v[132:135], v[96:99], v[30:33], v[132:135]
    v_mfma_f32_16x16x32_bf16 v[136:139], v[96:99], v[34:37], v[136:139]
    v_mfma_f32_16x16x32_bf16 v[140:143], v[96:99], v[38:41], v[140:143]
    v_mfma_f32_16x16x32_bf16 v[144:147], v[96:99], v[42:45], v[144:147]
    s_waitcnt lgkmcnt(0)
    ds_read_b64_tr_b16 v[88:89], v22 offset:4096
    ds_read_b64_tr_b16 v[90:91], v22 offset:4608
    ds_read_b64_tr_b16 v[92:93], v23 offset:4096
    ds_read_b64_tr_b16 v[94:95], v23 offset:4608
    ds_read_b64_tr_b16 v[96:97], v24
    ds_read_b64_tr_b16 v[98:99], v25
    v_mfma_f32_16x16x32_bf16 v[148:151], v[76:79], v[30:33], v[148:151]
    v_mfma_f32_16x16x32_bf16 v[152:155], v[76:79], v[34:37], v[152:155]
    v_mfma_f32_16x16x32_bf16 v[156:159], v[76:79], v[38:41], v[156:159]
    v_mfma_f32_16x16x32_bf16 v[160:163], v[76:79], v[42:45], v[160:163]
    v_mfma_f32_16x16x32_bf16 v[164:167], v[80:83], v[30:33], v[164:167]
    v_mfma_f32_16x16x32_bf16 v[168:171], v[80:83], v[34:37], v[168:171]
    v_mfma_f32_16x16x32_bf16 v[172:175], v[80:83], v[38:41], v[172:175]
    v_mfma_f32_16x16x32_bf16 v[176:179], v[80:83], v[42:45], v[176:179]
    v_mfma_f32_16x16x32_bf16 v[180:183], v[84:87], v[30:33], v[180:183]
    v_mfma_f32_16x16x32_bf16 v[184:187], v[84:87], v[34:37], v[184:187]
    v_mfma_f32_16x16x32_bf16 v[188:191], v[84:87], v[38:41], v[188:191]
    v_mfma_f32_16x16x32_bf16 v[192:195], v[84:87], v[42:45], v[192:195]
    s_waitcnt lgkmcnt(0)
    s_waitcnt vmcnt(12)
    s_barrier
    v_add_u32 v14, 34816, v14
    v_add_u32 v20, 34816, v20
    v_add_u32 v21, 34816, v21
    v_add_u32 v22, 34816, v22
    v_add_u32 v23, 34816, v23
    v_add_u32 v24, 34816, v24
    v_add_u32 v25, 34816, v25
    ds_read_b128 v[60:63], v14 offset:0
    ds_read_b128 v[64:67], v14 offset:1024
    ds_read_b128 v[68:71], v14 offset:2048
    ds_read_b128 v[72:75], v14 offset:3072
    ds_read_b64_tr_b16 v[76:77], v20 offset:0
    ds_read_b64_tr_b16 v[78:79], v20 offset:512
    ds_read_b64_tr_b16 v[80:81], v21 offset:0
    ds_read_b64_tr_b16 v[82:83], v21 offset:512
    ds_read_b64_tr_b16 v[84:85], v22 offset:0
    ds_read_b64_tr_b16 v[86:87], v22 offset:512
    v_mfma_f32_16x16x32_bf16 v[196:199], v[88:91], v[30:33], v[196:199]
    v_mfma_f32_16x16x32_bf16 v[200:203], v[88:91], v[34:37], v[200:203]
    v_mfma_f32_16x16x32_bf16 v[204:207], v[88:91], v[38:41], v[204:207]
    v_mfma_f32_16x16x32_bf16 v[208:211], v[88:91], v[42:45], v[208:211]
    v_mfma_f32_16x16x32_bf16 v[212:215], v[92:95], v[30:33], v[212:215]
    v_mfma_f32_16x16x32_bf16 v[216:219], v[92:95], v[34:37], v[216:219]
    v_mfma_f32_16x16x32_bf16 v[220:223], v[92:95], v[38:41], v[220:223]
    v_mfma_f32_16x16x32_bf16 v[224:227], v[92:95], v[42:45], v[224:227]
    v_mfma_f32_16x16x32_bf16 v[228:231], v[96:99], v[30:33], v[228:231]
    v_mfma_f32_16x16x32_bf16 v[232:235], v[96:99], v[34:37], v[232:235]
    v_mfma_f32_16x16x32_bf16 v[236:239], v[96:99], v[38:41], v[236:239]
    v_mfma_f32_16x16x32_bf16 v[240:243], v[96:99], v[42:45], v[240:243]
    s_waitcnt lgkmcnt(0)
    ds_read_b64_tr_b16 v[88:89], v23 offset:0
    ds_read_b64_tr_b16 v[90:91], v23 offset:512
    ds_read_b64_tr_b16 v[92:93], v20 offset:4096
    ds_read_b64_tr_b16 v[94:95], v20 offset:4608
    ds_read_b64_tr_b16 v[96:97], v21 offset:4096
    ds_read_b64_tr_b16 v[98:99], v21 offset:4608
    s_add_u32 m0, s25, 34816
    s_nop 0
    buffer_load_dwordx4 v2, s[8:11], s26 offen lds
    s_add_u32 m0, s25, 43008
    s_nop 0
    buffer_load_dwordx4 v3, s[8:11], s26 offen lds
    s_add_u32 m0, s38, 34816
    s_add_u32 s28, s27, 128
    buffer_load_dwordx4 v4, s[12:15], s27 offen lds
    s_add_u32 m0, s38, 38912
    s_nop 0
    buffer_load_dwordx4 v4, s[12:15], s28 offen lds
    s_add_u32 m0, s39, 34816
    s_mov_b64 exec, 0xffff
    buffer_load_dwordx4 v5, s[12:15], s27 offen lds
    s_mov_b64 exec, -1
    s_add_u32 s26, s26, 64
    s_add_u32 s27, s27, 294912
    v_mfma_f32_16x16x32_bf16 v[100:103], v[76:79], v[60:63], v[100:103]
    v_mfma_f32_16x16x32_bf16 v[104:107], v[76:79], v[64:67], v[104:107]
    v_mfma_f32_16x16x32_bf16 v[108:111], v[76:79], v[68:71], v[108:111]
    v_mfma_f32_16x16x32_bf16 v[112:115], v[76:79], v[72:75], v[112:115]
    v_mfma_f32_16x16x32_bf16 v[116:119], v[80:83], v[60:63], v[116:119]
    v_mfma_f32_16x16x32_bf16 v[120:123], v[80:83], v[64:67], v[120:123]
    v_mfma_f32_16x16x32_bf16 v[124:127], v[80:83], v[68:71], v[124:127]
    v_mfma_f32_16x16x32_bf16 v[128:131], v[80:83], v[72:75], v[128:131]
    v_mfma_f32_16x16x32_bf16 v[132:135], v[84:87], v[60:63], v[132:135]
    v_mfma_f32_16x16x32_bf16 v[136:139], v[84:87], v[64:67], v[136:139]
    v_mfma_f32_16x16x32_bf16 v[140:143], v[84:87], v[68:71], v[140:143]
    v_mfma_f32_16x16x32_bf16 v[144:147], v[84:87], v[72:75], v[144:147]
    s_waitcnt lgkmcnt(0)
    ds_read_b64_tr_b16 v[76:77], v22 offset:4096
    ds_read_b64_tr_b16 v[78:79], v22 offset:4608
    ds_read_b64_tr_b16 v[80:81], v23 offset:4096
    ds_read_b64_tr_b16 v[82:83], v23 offset:4608
    ds_read_b64_tr_b16 v[84:85], v24
    ds_read_b64_tr_b16 v[86:87], v25
    v_mfma_f32_16x16x32_bf16 v[148:151], v[88:91], v[60:63], v[148:151]
    v_mfma_f32_16x16x32_bf16 v[152:155], v[88:91], v[64:67], v[152:155]
    v_mfma_f32_16x16x32_bf16 v[156:159], v[88:91], v[68:71], v[156:159]
    v_mfma_f32_16x16x32_bf16 v[160:163], v[88:91], v[72:75], v[160:163]
    v_mfma_f32_16x16x32_bf16 v[164:167], v[92:95], v[60:63], v[164:167]
    v_mfma_f32_16x16x32_bf16 v[168:171], v[92:95], v[64:67], v[168:171]
    v_mfma_f32_16x16x32_bf16 v[172:175], v[92:95], v[68:71], v[172:175]
    v_mfma_f32_16x16x32_bf16 v[176:179], v[92:95], v[72:75], v[176:179]
    v_mfma_f32_16x16x32_bf16 v[180:183], v[96:99], v[60:63], v[180:183]
    v_mfma_f32_16x16x32_bf16 v[184:187], v[96:99], v[64:67], v[184:187]
    v_mfma_f32_16x16x32_bf16 v[188:191], v[96:99], v[68:71], v[188:191]
    v_mfma_f32_16x16x32_bf16 v[192:195], v[96:99], v[72:75], v[192:195]
    s_waitcnt lgkmcnt(0)
    s_waitcnt vmcnt(10)
    s_barrier
    v_add_u32 v14, 34816, v14
    v_add_u32 v20, 34816, v20
    v_add_u32 v21, 34816, v21
    v_add_u32 v22, 34816, v22
    v_add_u32 v23, 34816, v23
    v_add_u32 v24, 34816, v24
    v_add_u32 v25, 34816, v25
    ds_read_b128 v[30:33], v14 offset:0
    ds_read_b128 v[34:37], v14 offset:1024
    ds_read_b128 v[38:41], v14 offset:2048
    ds_read_b128 v[42:45], v14 offset:3072
    ds_read_b64_tr_b16 v[88:89], v20 offset:0
    ds_read_b64_tr_b16 v[90:91], v20 offset:512
    ds_read_b64_tr_b16 v[92:93], v21 offset:0
    ds_read_b64_tr_b16 v[94:95], v21 offset:512
    ds_read_b64_tr_b16 v[96:97], v22 offset:0
    ds_read_b64_tr_b16 v[98:99], v22 offset:512
    v_mfma_f32_16x16x32_bf16 v[196:199], v[76:79], v[60:63], v[196:199]
    v_mfma_f32_16x16x32_bf16 v[200:203], v[76:79], v[64:67], v[200:203]
    v_mfma_f32_16x16x32_bf16 v[204:207], v[76:79], v[68:71], v[204:207]
    v_mfma_f32_16x16x32_bf16 v[208:211], v[76:79], v[72:75], v[208:211]
    v_mfma_f32_16x16x32_bf16 v[212:215], v[80:83], v[60:63], v[212:215]
    v_mfma_f32_16x16x32_bf16 v[216:219], v[80:83], v[64:67], v[216:219]
    v_mfma_f32_16x16x32_bf16 v[220:223], v[80:83], v[68:71], v[220:223]
    v_mfma_f32_16x16x32_bf16 v[224:227], v[80:83], v[72:75], v[224:227]
    v_mfma_f32_16x16x32_bf16 v[228:231], v[84:87], v[60:63], v[228:231]
    v_mfma_f32_16x16x32_bf16 v[232:235], v[84:87], v[64:67], v[232:235]
    v_mfma_f32_16x16x32_bf16 v[236:239], v[84:87], v[68:71], v[236:239]
    v_mfma_f32_16x16x32_bf16 v[240:243], v[84:87], v[72:75], v[240:243]
    s_mov_b32 s37, 0
gu_loop:
    s_waitcnt lgkmcnt(0)
    ds_read_b64_tr_b16 v[76:77], v23 offset:0
    ds_read_b64_tr_b16 v[78:79], v23 offset:512
    ds_read_b64_tr_b16 v[80:81], v20 offset:4096
    ds_read_b64_tr_b16 v[82:83], v20 offset:4608
    ds_read_b64_tr_b16 v[84:85], v21 offset:4096
    ds_read_b64_tr_b16 v[86:87], v21 offset:4608
    s_add_u32 m0, s25, 69632
    s_nop 0
    buffer_load_dwordx4 v2, s[8:11], s26 offen lds
    s_add_u32 m0, s25, 77824
    s_nop 0
    buffer_load_dwordx4 v3, s[8:11], s26 offen lds
    s_add_u32 m0, s38, 69632
    s_add_u32 s28, s27, 128
    buffer_load_dwordx4 v4, s[12:15], s27 offen lds
    s_add_u32 m0, s38, 73728
    s_nop 0
    buffer_load_dwordx4 v4, s[12:15], s28 offen lds
    s_add_u32 m0, s39, 69632
    s_mov_b64 exec, 0xffff
    buffer_load_dwordx4 v5, s[12:15], s27 offen lds
    s_mov_b64 exec, -1
    s_add_u32 s26, s26, 64
    s_add_u32 s27, s27, 294912
    v_mfma_f32_16x16x32_bf16 v[100:103], v[88:91], v[30:33], v[100:103]
    v_mfma_f32_16x16x32_bf16 v[104:107], v[88:91], v[34:37], v[104:107]
    v_mfma_f32_16x16x32_bf16 v[108:111], v[88:91], v[38:41], v[108:111]
    v_mfma_f32_16x16x32_bf16 v[112:115], v[88:91], v[42:45], v[112:115]
    v_mfma_f32_16x16x32_bf16 v[116:119], v[92:95], v[30:33], v[116:119]
    v_mfma_f32_16x16x32_bf16 v[120:123], v[92:95], v[34:37], v[120:123]
    v_mfma_f32_16x16x32_bf16 v[124:127], v[92:95], v[38:41], v[124:127]
    v_mfma_f32_16x16x32_bf16 v[128:131], v[92:95], v[42:45], v[128:131]
    v_mfma_f32_16x16x32_bf16 v[132:135], v[96:99], v[30:33], v[132:135]
    v_mfma_f32_16x16x32_bf16 v[136:139], v[96:99], v[34:37], v[136:139]
    v_mfma_f32_16x16x32_bf16 v[140:143], v[96:99], v[38:41], v[140:143]
    v_mfma_f32_16x16x32_bf16 v[144:147], v[96:99], v[42:45], v[144:147]
    s_waitcnt lgkmcnt(0)
    ds_read_b64_tr_b16 v[88:89], v22 offset:4096
    ds_read_b64_tr_b16 v[90:91], v22 offset:4608
    ds_read_b64_tr_b16 v[92:93], v23 offset:4096
    ds_read_b64_tr_b16 v[94:95], v23 offset:4608
    ds_read_b64_tr_b16 v[96:97], v24
    ds_read_b64_tr_b16 v[98:99], v25
    v_mfma_f32_16x16x32_bf16 v[148:151], v[76:79], v[30:33], v[148:151]
    v_mfma_f32_16x16x32_bf16 v[152:155], v[76:79], v[34:37], v[152:155]
    v_mfma_f32_16x16x32_bf16 v[156:159], v[76:79], v[38:41], v[156:159]
    v_mfma_f32_16x16x32_bf16 v[160:163], v[76:79], v[42:45], v[160:163]
    v_mfma_f32_16x16x32_bf16 v[164:167], v[80:83], v[30:33], v[164:167]
    v_mfma_f32_16x16x32_bf16 v[168:171], v[80:83], v[34:37], v[168:171]
    v_mfma_f32_16x16x32_bf16 v[172:175], v[80:83], v[38:41], v[172:175]
    v_mfma_f32_16x16x32_bf16 v[176:179], v[80:83], v[42:45], v[176:179]
    v_mfma_f32_16x16x32_bf16 v[180:183], v[84:87], v[30:33], v[180:183]
    v_mfma_f32_16x16x32_bf16 v[184:187], v[84:87], v[34:37], v[184:187]
    v_mfma_f32_16x16x32_bf16 v[188:191], v[84:87], v[38:41], v[188:191]
    v_mfma_f32_16x16x32_bf16 v[192:195], v[84:87], v[42:45], v[192:195]
    s_waitcnt lgkmcnt(0)
    s_waitcnt vmcnt(10)
    s_barrier
    v_subrev_u32 v14, 104448, v14
    v_subrev_u32 v20, 104448, v20
    v_subrev_u32 v21, 104448, v21
    v_subrev_u32 v22, 104448, v22
    v_subrev_u32 v23, 104448, v23
    v_subrev_u32 v24, 104448, v24
    v_subrev_u32 v25, 104448, v25
    ds_read_b128 v[60:63], v14 offset:0
    ds_read_b128 v[64:67], v14 offset:1024
    ds_read_b128 v[68:71], v14 offset:2048
    ds_read_b128 v[72:75], v14 offset:3072
    ds_read_b64_tr_b16 v[76:77], v20 offset:0
    ds_read_b64_tr_b16 v[78:79], v20 offset:512
    ds_read_b64_tr_b16 v[80:81], v21 offset:0
    ds_read_b64_tr_b16 v[82:83], v21 offset:512
    ds_read_b64_tr_b16 v[84:85], v22 offset:0
    ds_read_b64_tr_b16 v[86:87], v22 offset:512
    v_mfma_f32_16x16x32_bf16 v[196:199], v[88:91], v[30:33], v[196:199]
    v_mfma_f32_16x16x32_bf16 v[200:203], v[88:91], v[34:37], v[200:203]
    v_mfma_f32_16x16x32_bf16 v[204:207], v[88:91], v[38:41], v[204:207]
    v_mfma_f32_16x16x32_bf16 v[208:211], v[88:91], v[42:45], v[208:211]
    v_mfma_f32_16x16x32_bf16 v[212:215], v[92:95], v[30:33], v[212:215]
    v_mfma_f32_16x16x32_bf16 v[216:219], v[92:95], v[34:37], v[216:219]
    v_mfma_f32_16x16x32_bf16 v[220:223], v[92:95], v[38:41], v[220:223]
    v_mfma_f32_16x16x32_bf16 v[224:227], v[92:95], v[42:45], v[224:227]
    v_mfma_f32_16x16x32_bf16 v[228:231], v[96:99], v[30:33], v[228:231]
    v_mfma_f32_16x16x32_bf16 v[232:235], v[96:99], v[34:37], v[232:235]
    v_mfma_f32_16x16x32_bf16 v[236:239], v[96:99], v[38:41], v[236:239]
    v_mfma_f32_16x16x32_bf16 v[240:243], v[96:99], v[42:45], v[240:243]
    s_waitcnt lgkmcnt(0)
    ds_read_b64_tr_b16 v[88:89], v23 offset:0
    ds_read_b64_tr_b16 v[90:91], v23 offset:512
    ds_read_b64_tr_b16 v[92:93], v20 offset:4096
    ds_read_b64_tr_b16 v[94:95], v20 offset:4608
    ds_read_b64_tr_b16 v[96:97], v21 offset:4096
    ds_read_b64_tr_b16 v[98:99], v21 offset:4608
    s_add_u32 m0, s25, 104448
    s_nop 0
    buffer_load_dwordx4 v2, s[8:11], s26 offen lds
    s_add_u32 m0, s25, 112640
    s_nop 0
    buffer_load_dwordx4 v3, s[8:11], s26 offen lds
    s_add_u32 m0, s38, 104448
    s_add_u32 s28, s27, 128
    buffer_load_dwordx4 v4, s[12:15], s27 offen lds
    s_add_u32 m0, s38, 108544
    s_nop 0
    buffer_load_dwordx4 v4, s[12:15], s28 offen lds
    s_add_u32 m0, s39, 104448
    s_mov_b64 exec, 0xffff
    buffer_load_dwordx4 v5, s[12:15], s27 offen lds
    s_mov_b64 exec, -1
    s_add_u32 s26, s26, 64
    s_add_u32 s27, s27, 294912
    v_mfma_f32_16x16x32_bf16 v[100:103], v[76:79], v[60:63], v[100:103]
    v_mfma_f32_16x16x32_bf16 v[104:107], v[76:79], v[64:67], v[104:107]
    v_mfma_f32_16x16x32_bf16 v[108:111], v[76:79], v[68:71], v[108:111]
    v_mfma_f32_16x16x32_bf16 v[112:115], v[76:79], v[72:75], v[112:115]
    v_mfma_f32_16x16x32_bf16 v[116:119], v[80:83], v[60:63], v[116:119]
    v_mfma_f32_16x16x32_bf16 v[120:123], v[80:83], v[64:67], v[120:123]
    v_mfma_f32_16x16x32_bf16 v[124:127], v[80:83], v[68:71], v[124:127]
    v_mfma_f32_16x16x32_bf16 v[128:131], v[80:83], v[72:75], v[128:131]
    v_mfma_f32_16x16x32_bf16 v[132:135], v[84:87], v[60:63], v[132:135]
    v_mfma_f32_16x16x32_bf16 v[136:139], v[84:87], v[64:67], v[136:139]
    v_mfma_f32_16x16x32_bf16 v[140:143], v[84:87], v[68:71], v[140:143]
    v_mfma_f32_16x16x32_bf16 v[144:147], v[84:87], v[72:75], v[144:147]
    s_waitcnt lgkmcnt(0)
    ds_read_b64_tr_b16 v[76:77], v22 offset:4096
    ds_read_b64_tr_b16 v[78:79], v22 offset:4608
    ds_read_b64_tr_b16 v[80:81], v23 offset:4096
    ds_read_b64_tr_b16 v[82:83], v23 offset:4608
    ds_read_b64_tr_b16 v[84:85], v24
    ds_read_b64_tr_b16 v[86:87], v25
    v_mfma_f32_16x16x32_bf16 v[148:151], v[88:91], v[60:63], v[148:151]
    v_mfma_f32_16x16x32_bf16 v[152:155], v[88:91], v[64:67], v[152:155]
    v_mfma_f32_16x16x32_bf16 v[156:159], v[88:91], v[68:71], v[156:159]
    v_mfma_f32_16x16x32_bf16 v[160:163], v[88:91], v[72:75], v[160:163]
    v_mfma_f32_16x16x32_bf16 v[164:167], v[92:95], v[60:63], v[164:167]
    v_mfma_f32_16x16x32_bf16 v[168:171], v[92:95], v[64:67], v[168:171]
    v_mfma_f32_16x16x32_bf16 v[172:175], v[92:95], v[68:71], v[172:175]
    v_mfma_f32_16x16x32_bf16 v[176:179], v[92:95], v[72:75], v[176:179]
    v_mfma_f32_16x16x32_bf16 v[180:183], v[96:99], v[60:63], v[180:183]
    v_mfma_f32_16x16x32_bf16 v[184:187], v[96:99], v[64:67], v[184:187]
    v_mfma_f32_16x16x32_bf16 v[188:191], v[96:99], v[68:71], v[188:191]
    v_mfma_f32_16x16x32_bf16 v[192:195], v[96:99], v[72:75], v[192:195]
    s_waitcnt lgkmcnt(0)
    s_waitcnt vmcnt(10)
    s_barrier
    v_add_u32 v14, 34816, v14
    v_add_u32 v20, 34816, v20
    v_add_u32 v21, 34816, v21
    v_add_u32 v22, 34816, v22
    v_add_u32 v23, 34816, v23
    v_add_u32 v24, 34816, v24
    v_add_u32 v25, 34816, v25
    ds_read_b128 v[30:33], v14 offset:0
    ds_read_b128 v[34:37], v14 offset:1024
    ds_read_b128 v[38:41], v14 offset:2048
    ds_read_b128 v[42:45], v14 offset:3072
    ds_read_b64_tr_b16 v[88:89], v20 offset:0
    ds_read_b64_tr_b16 v[90:91], v20 offset:512
    ds_read_b64_tr_b16 v[92:93], v21 offset:0
    ds_read_b64_tr_b16 v[94:95], v21 offset:512
    ds_read_b64_tr_b16 v[96:97], v22 offset:0
    ds_read_b64_tr_b16 v[98:99], v22 offset:512
    v_mfma_f32_16x16x32_bf16 v[196:199], v[76:79], v[60:63], v[196:199]
    v_mfma_f32_16x16x32_bf16 v[200:203], v[76:79], v[64:67], v[200:203]
    v_mfma_f32_16x16x32_bf16 v[204:207], v[76:79], v[68:71], v[204:207]
    v_mfma_f32_16x16x32_bf16 v[208:211], v[76:79], v[72:75], v[208:211]
    v_mfma_f32_16x16x32_bf16 v[212:215], v[80:83], v[60:63], v[212:215]
    v_mfma_f32_16x16x32_bf16 v[216:219], v[80:83], v[64:67], v[216:219]
    v_mfma_f32_16x16x32_bf16 v[220:223], v[80:83], v[68:71], v[220:223]
    v_mfma_f32_16x16x32_bf16 v[224:227], v[80:83], v[72:75], v[224:227]
    v_mfma_f32_16x16x32_bf16 v[228:231], v[84:87], v[60:63], v[228:231]
    v_mfma_f32_16x16x32_bf16 v[232:235], v[84:87], v[64:67], v[232:235]
    v_mfma_f32_16x16x32_bf16 v[236:239], v[84:87], v[68:71], v[236:239]
    v_mfma_f32_16x16x32_bf16 v[240:243], v[84:87], v[72:75], v[240:243]
    s_waitcnt lgkmcnt(0)
    ds_read_b64_tr_b16 v[76:77], v23 offset:0
    ds_read_b64_tr_b16 v[78:79], v23 offset:512
    ds_read_b64_tr_b16 v[80:81], v20 offset:4096
    ds_read_b64_tr_b16 v[82:83], v20 offset:4608
    ds_read_b64_tr_b16 v[84:85], v21 offset:4096
    ds_read_b64_tr_b16 v[86:87], v21 offset:4608
    s_add_u32 m0, s25, 0
    s_nop 0
    buffer_load_dwordx4 v2, s[8:11], s26 offen lds
    s_add_u32 m0, s25, 8192
    s_nop 0
    buffer_load_dwordx4 v3, s[8:11], s26 offen lds
    s_add_u32 m0, s38, 0
    s_add_u32 s28, s27, 128
    buffer_load_dwordx4 v4, s[12:15], s27 offen lds
    s_add_u32 m0, s38, 4096
    s_nop 0
    buffer_load_dwordx4 v4, s[12:15], s28 offen lds
    s_add_u32 m0, s39, 0
    s_mov_b64 exec, 0xffff
    buffer_load_dwordx4 v5, s[12:15], s27 offen lds
    s_mov_b64 exec, -1
    s_add_u32 s26, s26, 64
    s_add_u32 s27, s27, 294912
    v_mfma_f32_16x16x32_bf16 v[100:103], v[88:91], v[30:33], v[100:103]
    v_mfma_f32_16x16x32_bf16 v[104:107], v[88:91], v[34:37], v[104:107]
    v_mfma_f32_16x16x32_bf16 v[108:111], v[88:91], v[38:41], v[108:111]
    v_mfma_f32_16x16x32_bf16 v[112:115], v[88:91], v[42:45], v[112:115]
    v_mfma_f32_16x16x32_bf16 v[116:119], v[92:95], v[30:33], v[116:119]
    v_mfma_f32_16x16x32_bf16 v[120:123], v[92:95], v[34:37], v[120:123]
    v_mfma_f32_16x16x32_bf16 v[124:127], v[92:95], v[38:41], v[124:127]
    v_mfma_f32_16x16x32_bf16 v[128:131], v[92:95], v[42:45], v[128:131]
    v_mfma_f32_16x16x32_bf16 v[132:135], v[96:99], v[30:33], v[132:135]
    v_mfma_f32_16x16x32_bf16 v[136:139], v[96:99], v[34:37], v[136:139]
    v_mfma_f32_16x16x32_bf16 v[140:143], v[96:99], v[38:41], v[140:143]
    v_mfma_f32_16x16x32_bf16 v[144:147], v[96:99], v[42:45], v[144:147]
    s_waitcnt lgkmcnt(0)
    ds_read_b64_tr_b16 v[88:89], v22 offset:4096
    ds_read_b64_tr_b16 v[90:91], v22 offset:4608
    ds_read_b64_tr_b16 v[92:93], v23 offset:4096
    ds_read_b64_tr_b16 v[94:95], v23 offset:4608
    ds_read_b64_tr_b16 v[96:97], v24
    ds_read_b64_tr_b16 v[98:99], v25
    v_mfma_f32_16x16x32_bf16 v[148:151], v[76:79], v[30:33], v[148:151]
    v_mfma_f32_16x16x32_bf16 v[152:155], v[76:79], v[34:37], v[152:155]
    v_mfma_f32_16x16x32_bf16 v[156:159], v[76:79], v[38:41], v[156:159]
    v_mfma_f32_16x16x32_bf16 v[160:163], v[76:79], v[42:45], v[160:163]
    v_mfma_f32_16x16x32_bf16 v[164:167], v[80:83], v[30:33], v[164:167]
    v_mfma_f32_16x16x32_bf16 v[168:171], v[80:83], v[34:37], v[168:171]
    v_mfma_f32_16x16x32_bf16 v[172:175], v[80:83], v[38:41], v[172:175]
    v_mfma_f32_16x16x32_bf16 v[176:179], v[80:83], v[42:45], v[176:179]
    v_mfma_f32_16x16x32_bf16 v[180:183], v[84:87], v[30:33], v[180:183]
    v_mfma_f32_16x16x32_bf16 v[184:187], v[84:87], v[34:37], v[184:187]
    v_mfma_f32_16x16x32_bf16 v[188:191], v[84:87], v[38:41], v[188:191]
    v_mfma_f32_16x16x32_bf16 v[192:195], v[84:87], v[42:45], v[192:195]
    s_waitcnt lgkmcnt(0)
    s_waitcnt vmcnt(10)
    s_barrier
    v_add_u32 v14, 34816, v14
    v_add_u32 v20, 34816, v20
    v_add_u32 v21, 34816, v21
    v_add_u32 v22, 34816, v22
    v_add_u32 v23, 34816, v23
    v_add_u32 v24, 34816, v24
    v_add_u32 v25, 34816, v25
    ds_read_b128 v[60:63], v14 offset:0
    ds_read_b128 v[64:67], v14 offset:1024
    ds_read_b128 v[68:71], v14 offset:2048
    ds_read_b128 v[72:75], v14 offset:3072
    ds_read_b64_tr_b16 v[76:77], v20 offset:0
    ds_read_b64_tr_b16 v[78:79], v20 offset:512
    ds_read_b64_tr_b16 v[80:81], v21 offset:0
    ds_read_b64_tr_b16 v[82:83], v21 offset:512
    ds_read_b64_tr_b16 v[84:85], v22 offset:0
    ds_read_b64_tr_b16 v[86:87], v22 offset:512
    v_mfma_f32_16x16x32_bf16 v[196:199], v[88:91], v[30:33], v[196:199]
    v_mfma_f32_16x16x32_bf16 v[200:203], v[88:91], v[34:37], v[200:203]
    v_mfma_f32_16x16x32_bf16 v[204:207], v[88:91], v[38:41], v[204:207]
    v_mfma_f32_16x16x32_bf16 v[208:211], v[88:91], v[42:45], v[208:211]
    v_mfma_f32_16x16x32_bf16 v[212:215], v[92:95], v[30:33], v[212:215]
    v_mfma_f32_16x16x32_bf16 v[216:219], v[92:95], v[34:37], v[216:219]
    v_mfma_f32_16x16x32_bf16 v[220:223], v[92:95], v[38:41], v[220:223]
    v_mfma_f32_16x16x32_bf16 v[224:227], v[92:95], v[42:45], v[224:227]
    v_mfma_f32_16x16x32_bf16 v[228:231], v[96:99], v[30:33], v[228:231]
    v_mfma_f32_16x16x32_bf16 v[232:235], v[96:99], v[34:37], v[232:235]
    v_mfma_f32_16x16x32_bf16 v[236:239], v[96:99], v[38:41], v[236:239]
    v_mfma_f32_16x16x32_bf16 v[240:243], v[96:99], v[42:45], v[240:243]
    s_waitcnt lgkmcnt(0)
    ds_read_b64_tr_b16 v[88:89], v23 offset:0
    ds_read_b64_tr_b16 v[90:91], v23 offset:512
    ds_read_b64_tr_b16 v[92:93], v20 offset:4096
    ds_read_b64_tr_b16 v[94:95], v20 offset:4608
    ds_read_b64_tr_b16 v[96:97], v21 offset:4096
    ds_read_b64_tr_b16 v[98:99], v21 offset:4608
    s_add_u32 m0, s25, 34816
    s_nop 0
    buffer_load_dwordx4 v2, s[8:11], s26 offen lds
    s_add_u32 m0, s25, 43008
    s_nop 0
    buffer_load_dwordx4 v3, s[8:11], s26 offen lds
    s_add_u32 m0, s38, 34816
    s_add_u32 s28, s27, 128
    buffer_load_dwordx4 v4, s[12:15], s27 offen lds
    s_add_u32 m0, s38, 38912
    s_nop 0
    buffer_load_dwordx4 v4, s[12:15], s28 offen lds
    s_add_u32 m0, s39, 34816
    s_mov_b64 exec, 0xffff
    buffer_load_dwordx4 v5, s[12:15], s27 offen lds
    s_mov_b64 exec, -1
    s_add_u32 s26, s26, 64
    s_add_u32 s27, s27, 294912
    v_mfma_f32_16x16x32_bf16 v[100:103], v[76:79], v[60:63], v[100:103]
    v_mfma_f32_16x16x32_bf16 v[104:107], v[76:79], v[64:67], v[104:107]
    v_mfma_f32_16x16x32_bf16 v[108:111], v[76:79], v[68:71], v[108:111]
    v_mfma_f32_16x16x32_bf16 v[112:115], v[76:79], v[72:75], v[112:115]
    v_mfma_f32_16x16x32_bf16 v[116:119], v[80:83], v[60:63], v[116:119]
    v_mfma_f32_16x16x32_bf16 v[120:123], v[80:83], v[64:67], v[120:123]
    v_mfma_f32_16x16x32_bf16 v[124:127], v[80:83], v[68:71], v[124:127]
    v_mfma_f32_16x16x32_bf16 v[128:131], v[80:83], v[72:75], v[128:131]
    v_mfma_f32_16x16x32_bf16 v[132:135], v[84:87], v[60:63], v[132:135]
    v_mfma_f32_16x16x32_bf16 v[136:139], v[84:87], v[64:67], v[136:139]
    v_mfma_f32_16x16x32_bf16 v[140:143], v[84:87], v[68:71], v[140:143]
    v_mfma_f32_16x16x32_bf16 v[144:147], v[84:87], v[72:75], v[144:147]
    s_waitcnt lgkmcnt(0)
    ds_read_b64_tr_b16 v[76:77], v22 offset:4096
    ds_read_b64_tr_b16 v[78:79], v22 offset:4608
    ds_read_b64_tr_b16 v[80:81], v23 offset:4096
    ds_read_b64_tr_b16 v[82:83], v23 offset:4608
    ds_read_b64_tr_b16 v[84:85], v24
    ds_read_b64_tr_b16 v[86:87], v25
    v_mfma_f32_16x16x32_bf16 v[148:151], v[88:91], v[60:63], v[148:151]
    v_mfma_f32_16x16x32_bf16 v[152:155], v[88:91], v[64:67], v[152:155]
    v_mfma_f32_16x16x32_bf16 v[156:159], v[88:91], v[68:71], v[156:159]
    v_mfma_f32_16x16x32_bf16 v[160:163], v[88:91], v[72:75], v[160:163]
    v_mfma_f32_16x16x32_bf16 v[164:167], v[92:95], v[60:63], v[164:167]
    v_mfma_f32_16x16x32_bf16 v[168:171], v[92:95], v[64:67], v[168:171]
    v_mfma_f32_16x16x32_bf16 v[172:175], v[92:95], v[68:71], v[172:175]
    v_mfma_f32_16x16x32_bf16 v[176:179], v[92:95], v[72:75], v[176:179]
    v_mfma_f32_16x16x32_bf16 v[180:183], v[96:99], v[60:63], v[180:183]
    v_mfma_f32_16x16x32_bf16 v[184:187], v[96:99], v[64:67], v[184:187]
    v_mfma_f32_16x16x32_bf16 v[188:191], v[96:99], v[68:71], v[188:191]
    v_mfma_f32_16x16x32_bf16 v[192:195], v[96:99], v[72:75], v[192:195]
    s_waitcnt lgkmcnt(0)
    s_waitcnt vmcnt(10)
    s_barrier
    v_add_u32 v14, 34816, v14
    v_add_u32 v20, 34816, v20
    v_add_u32 v21, 34816, v21
    v_add_u32 v22, 34816, v22
    v_add_u32 v23, 34816, v23
    v_add_u32 v24, 34816, v24
    v_add_u32 v25, 34816, v25
    ds_read_b128 v[30:33], v14 offset:0
    ds_read_b128 v[34:37], v14 offset:1024
    ds_read_b128 v[38:41], v14 offset:2048
    ds_read_b128 v[42:45], v14 offset:3072
    ds_read_b64_tr_b16 v[88:89], v20 offset:0
    ds_read_b64_tr_b16 v[90:91], v20 offset:512
    ds_read_b64_tr_b16 v[92:93], v21 offset:0
    ds_read_b64_tr_b16 v[94:95], v21 offset:512
    ds_read_b64_tr_b16 v[96:97], v22 offset:0
    ds_read_b64_tr_b16 v[98:99], v22 offset:512
    v_mfma_f32_16x16x32_bf16 v[196:199], v[76:79], v[60:63], v[196:199]
    v_mfma_f32_16x16x32_bf16 v[200:203], v[76:79], v[64:67], v[200:203]
    v_mfma_f32_16x16x32_bf16 v[204:207], v[76:79], v[68:71], v[204:207]
    v_mfma_f32_16x16x32_bf16 v[208:211], v[76:79], v[72:75], v[208:211]
    v_mfma_f32_16x16x32_bf16 v[212:215], v[80:83], v[60:63], v[212:215]
    v_mfma_f32_16x16x32_bf16 v[216:219], v[80:83], v[64:67], v[216:219]
    v_mfma_f32_16x16x32_bf16 v[220:223], v[80:83], v[68:71], v[220:223]
    v_mfma_f32_16x16x32_bf16 v[224:227], v[80:83], v[72:75], v[224:227]
    v_mfma_f32_16x16x32_bf16 v[228:231], v[84:87], v[60:63], v[228:231]
    v_mfma_f32_16x16x32_bf16 v[232:235], v[84:87], v[64:67], v[232:235]
    v_mfma_f32_16x16x32_bf16 v[236:239], v[84:87], v[68:71], v[236:239]
    v_mfma_f32_16x16x32_bf16 v[240:243], v[84:87], v[72:75], v[240:243]
    s_add_u32 s37, s37, 1
    s_cmp_lt_u32 s37, 3
    s_cbranch_scc1 gu_loop
    s_waitcnt lgkmcnt(0)
    ds_read_b64_tr_b16 v[76:77], v23 offset:0
    ds_read_b64_tr_b16 v[78:79], v23 offset:512
    ds_read_b64_tr_b16 v[80:81], v20 offset:4096
    ds_read_b64_tr_b16 v[82:83], v20 offset:4608
    ds_read_b64_tr_b16 v[84:85], v21 offset:4096
    ds_read_b64_tr_b16 v[86:87], v21 offset:4608
    v_mfma_f32_16x16x32_bf16 v[100:103], v[88:91], v[30:33], v[100:103]
    v_mfma_f32_16x16x32_bf16 v[104:107], v[88:91], v[34:37], v[104:107]
    v_mfma_f32_16x16x32_bf16 v[108:111], v[88:91], v[38:41], v[108:111]
    v_mfma_f32_16x16x32_bf16 v[112:115], v[88:91], v[42:45], v[112:115]
    v_mfma_f32_16x16x32_bf16 v[116:119], v[92:95], v[30:33], v[116:119]
    v_mfma_f32_16x16x32_bf16 v[120:123], v[92:95], v[34:37], v[120:123]
    v_mfma_f32_16x16x32_bf16 v[124:127], v[92:95], v[38:41], v[124:127]
    v_mfma_f32_16x16x32_bf16 v[128:131], v[92:95], v[42:45], v[128:131]
    v_mfma_f32_16x16x32_bf16 v[132:135], v[96:99], v[30:33], v[132:135]
    v_mfma_f32_16x16x32_bf16 v[136:139], v[96:99], v[34:37], v[136:139]
    v_mfma_f32_16x16x32_bf16 v[140:143], v[96:99], v[38:41], v[140:143]
    v_mfma_f32_16x16x32_bf16 v[144:147], v[96:99], v[42:45], v[144:147]
    s_waitcnt lgkmcnt(0)
    ds_read_b64_tr_b16 v[88:89], v22 offset:4096
    ds_read_b64_tr_b16 v[90:91], v22 offset:4608
    ds_read_b64_tr_b16 v[92:93], v23 offset:4096
    ds_read_b64_tr_b16 v[94:95], v23 offset:4608
    ds_read_b64_tr_b16 v[96:97], v24
    ds_read_b64_tr_b16 v[98:99], v25
    v_mfma_f32_16x16x32_bf16 v[148:151], v[76:79], v[30:33], v[148:151]
    v_mfma_f32_16x16x32_bf16 v[152:155], v[76:79], v[34:37], v[152:155]
    v_mfma_f32_16x16x32_bf16 v[156:159], v[76:79], v[38:41], v[156:159]
    v_mfma_f32_16x16x32_bf16 v[160:163], v[76:79], v[42:45], v[160:163]
    v_mfma_f32_16x16x32_bf16 v[164:167], v[80:83], v[30:33], v[164:167]
    v_mfma_f32_16x16x32_bf16 v[168:171], v[80:83], v[34:37], v[168:171]
    v_mfma_f32_16x16x32_bf16 v[172:175], v[80:83], v[38:41], v[172:175]
    v_mfma_f32_16x16x32_bf16 v[176:179], v[80:83], v[42:45], v[176:179]
    v_mfma_f32_16x16x32_bf16 v[180:183], v[84:87], v[30:33], v[180:183]
    v_mfma_f32_16x16x32_bf16 v[184:187], v[84:87], v[34:37], v[184:187]
    v_mfma_f32_16x16x32_bf16 v[188:191], v[84:87], v[38:41], v[188:191]
    v_mfma_f32_16x16x32_bf16 v[192:195], v[84:87], v[42:45], v[192:195]
    s_waitcnt lgkmcnt(0)
    s_waitcnt vmcnt(5)
    s_barrier
    v_subrev_u32 v14, 104448, v14
    v_subrev_u32 v20, 104448, v20
    v_subrev_u32 v21, 104448, v21
    v_subrev_u32 v22, 104448, v22
    v_subrev_u32 v23, 104448, v23
    v_subrev_u32 v24, 104448, v24
    v_subrev_u32 v25, 104448, v25
    ds_read_b128 v[60:63], v14 offset:0
    ds_read_b128 v[64:67], v14 offset:1024
    ds_read_b128 v[68:71], v14 offset:2048
    ds_read_b128 v[72:75], v14 offset:3072
    ds_read_b64_tr_b16 v[76:77], v20 offset:0
    ds_read_b64_tr_b16 v[78:79], v20 offset:512
    ds_read_b64_tr_b16 v[80:81], v21 offset:0
    ds_read_b64_tr_b16 v[82:83], v21 offset:512
    ds_read_b64_tr_b16 v[84:85], v22 offset:0
    ds_read_b64_tr_b16 v[86:87], v22 offset:512
    v_mfma_f32_16x16x32_bf16 v[196:199], v[88:91], v[30:33], v[196:199]
    v_mfma_f32_16x16x32_bf16 v[200:203], v[88:91], v[34:37], v[200:203]
    v_mfma_f32_16x16x32_bf16 v[204:207], v[88:91], v[38:41], v[204:207]
    v_mfma_f32_16x16x32_bf16 v[208:211], v[88:91], v[42:45], v[208:211]
    v_mfma_f32_16x16x32_bf16 v[212:215], v[92:95], v[30:33], v[212:215]
    v_mfma_f32_16x16x32_bf16 v[216:219], v[92:95], v[34:37], v[216:219]
    v_mfma_f32_16x16x32_bf16 v[220:223], v[92:95], v[38:41], v[220:223]
    v_mfma_f32_16x16x32_bf16 v[224:227], v[92:95], v[42:45], v[224:227]
    v_mfma_f32_16x16x32_bf16 v[228:231], v[96:99], v[30:33], v[228:231]
    v_mfma_f32_16x16x32_bf16 v[232:235], v[96:99], v[34:37], v[232:235]
    v_mfma_f32_16x16x32_bf16 v[236:239], v[96:99], v[38:41], v[236:239]
    v_mfma_f32_16x16x32_bf16 v[240:243], v[96:99], v[42:45], v[240:243]
    s_waitcnt lgkmcnt(0)
    ds_read_b64_tr_b16 v[88:89], v23 offset:0
    ds_read_b64_tr_b16 v[90:91], v23 offset:512
    ds_read_b64_tr_b16 v[92:93], v20 offset:4096
    ds_read_b64_tr_b16 v[94:95], v20 offset:4608
    ds_read_b64_tr_b16 v[96:97], v21 offset:4096
    ds_read_b64_tr_b16 v[98:99], v21 offset:4608
    v_mfma_f32_16x16x32_bf16 v[100:103], v[76:79], v[60:63], v[100:103]
    v_mfma_f32_16x16x32_bf16 v[104:107], v[76:79], v[64:67], v[104:107]
    v_mfma_f32_16x16x32_bf16 v[108:111], v[76:79], v[68:71], v[108:111]
    v_mfma_f32_16x16x32_bf16 v[112:115], v[76:79], v[72:75], v[112:115]
    v_mfma_f32_16x16x32_bf16 v[116:119], v[80:83], v[60:63], v[116:119]
    v_mfma_f32_16x16x32_bf16 v[120:123], v[80:83], v[64:67], v[120:123]
    v_mfma_f32_16x16x32_bf16 v[124:127], v[80:83], v[68:71], v[124:127]
    v_mfma_f32_16x16x32_bf16 v[128:131], v[80:83], v[72:75], v[128:131]
    v_mfma_f32_16x16x32_bf16 v[132:135], v[84:87], v[60:63], v[132:135]
    v_mfma_f32_16x16x32_bf16 v[136:139], v[84:87], v[64:67], v[136:139]
    v_mfma_f32_16x16x32_bf16 v[140:143], v[84:87], v[68:71], v[140:143]
    v_mfma_f32_16x16x32_bf16 v[144:147], v[84:87], v[72:75], v[144:147]
    s_waitcnt lgkmcnt(0)
    ds_read_b64_tr_b16 v[76:77], v22 offset:4096
    ds_read_b64_tr_b16 v[78:79], v22 offset:4608
    ds_read_b64_tr_b16 v[80:81], v23 offset:4096
    ds_read_b64_tr_b16 v[82:83], v23 offset:4608
    ds_read_b64_tr_b16 v[84:85], v24
    ds_read_b64_tr_b16 v[86:87], v25
    v_mfma_f32_16x16x32_bf16 v[148:151], v[88:91], v[60:63], v[148:151]
    v_mfma_f32_16x16x32_bf16 v[152:155], v[88:91], v[64:67], v[152:155]
    v_mfma_f32_16x16x32_bf16 v[156:159], v[88:91], v[68:71], v[156:159]
    v_mfma_f32_16x16x32_bf16 v[160:163], v[88:91], v[72:75], v[160:163]
    v_mfma_f32_16x16x32_bf16 v[164:167], v[92:95], v[60:63], v[164:167]
    v_mfma_f32_16x16x32_bf16 v[168:171], v[92:95], v[64:67], v[168:171]
    v_mfma_f32_16x16x32_bf16 v[172:175], v[92:95], v[68:71], v[172:175]
    v_mfma_f32_16x16x32_bf16 v[176:179], v[92:95], v[72:75], v[176:179]
    v_mfma_f32_16x16x32_bf16 v[180:183], v[96:99], v[60:63], v[180:183]
    v_mfma_f32_16x16x32_bf16 v[184:187], v[96:99], v[64:67], v[184:187]
    v_mfma_f32_16x16x32_bf16 v[188:191], v[96:99], v[68:71], v[188:191]
    v_mfma_f32_16x16x32_bf16 v[192:195], v[96:99], v[72:75], v[192:195]
    s_waitcnt lgkmcnt(0)
    s_waitcnt vmcnt(0)
    s_barrier
    v_add_u32 v14, 34816, v14
    v_add_u32 v20, 34816, v20
    v_add_u32 v21, 34816, v21
    v_add_u32 v22, 34816, v22
    v_add_u32 v23, 34816, v23
    v_add_u32 v24, 34816, v24
    v_add_u32 v25, 34816, v25
    ds_read_b128 v[30:33], v14 offset:0
    ds_read_b128 v[34:37], v14 offset:1024
    ds_read_b128 v[38:41], v14 offset:2048
    ds_read_b128 v[42:45], v14 offset:3072
    ds_read_b64_tr_b16 v[88:89], v20 offset:0
    ds_read_b64_tr_b16 v[90:91], v20 offset:512
    ds_read_b64_tr_b16 v[92:93], v21 offset:0
    ds_read_b64_tr_b16 v[94:95], v21 offset:512
    ds_read_b64_tr_b16 v[96:97], v22 offset:0
    ds_read_b64_tr_b16 v[98:99], v22 offset:512
    v_mfma_f32_16x16x32_bf16 v[196:199], v[76:79], v[60:63], v[196:199]
    v_mfma_f32_16x16x32_bf16 v[200:203], v[76:79], v[64:67], v[200:203]
    v_mfma_f32_16x16x32_bf16 v[204:207], v[76:79], v[68:71], v[204:207]
    v_mfma_f32_16x16x32_bf16 v[208:211], v[76:79], v[72:75], v[208:211]
    v_mfma_f32_16x16x32_bf16 v[212:215], v[80:83], v[60:63], v[212:215]
    v_mfma_f32_16x16x32_bf16 v[216:219], v[80:83], v[64:67], v[216:219]
    v_mfma_f32_16x16x32_bf16 v[220:223], v[80:83], v[68:71], v[220:223]
    v_mfma_f32_16x16x32_bf16 v[224:227], v[80:83], v[72:75], v[224:227]
    v_mfma_f32_16x16x32_bf16 v[228:231], v[84:87], v[60:63], v[228:231]
    v_mfma_f32_16x16x32_bf16 v[232:235], v[84:87], v[64:67], v[232:235]
    v_mfma_f32_16x16x32_bf16 v[236:239], v[84:87], v[68:71], v[236:239]
    v_mfma_f32_16x16x32_bf16 v[240:243], v[84:87], v[72:75], v[240:243]
    s_waitcnt lgkmcnt(0)
    ds_read_b64_tr_b16 v[76:77], v23 offset:0
    ds_read_b64_tr_b16 v[78:79], v23 offset:512
    ds_read_b64_tr_b16 v[80:81], v20 offset:4096
    ds_read_b64_tr_b16 v[82:83], v20 offset:4608
    ds_read_b64_tr_b16 v[84:85], v21 offset:4096
    ds_read_b64_tr_b16 v[86:87], v21 offset:4608
    v_mfma_f32_16x16x32_bf16 v[100:103], v[88:91], v[30:33], v[100:103]
    v_mfma_f32_16x16x32_bf16 v[104:107], v[88:91], v[34:37], v[104:107]
    v_mfma_f32_16x16x32_bf16 v[108:111], v[88:91], v[38:41], v[108:111]
    v_mfma_f32_16x16x32_bf16 v[112:115], v[88:91], v[42:45], v[112:115]
    v_mfma_f32_16x16x32_bf16 v[116:119], v[92:95], v[30:33], v[116:119]
    v_mfma_f32_16x16x32_bf16 v[120:123], v[92:95], v[34:37], v[120:123]
    v_mfma_f32_16x16x32_bf16 v[124:127], v[92:95], v[38:41], v[124:127]
    v_mfma_f32_16x16x32_bf16 v[128:131], v[92:95], v[42:45], v[128:131]
    v_mfma_f32_16x16x32_bf16 v[132:135], v[96:99], v[30:33], v[132:135]
    v_mfma_f32_16x16x32_bf16 v[136:139], v[96:99], v[34:37], v[136:139]
    v_mfma_f32_16x16x32_bf16 v[140:143], v[96:99], v[38:41], v[140:143]
    v_mfma_f32_16x16x32_bf16 v[144:147], v[96:99], v[42:45], v[144:147]
    s_waitcnt lgkmcnt(0)
    ds_read_b64_tr_b16 v[88:89], v22 offset:4096
    ds_read_b64_tr_b16 v[90:91], v22 offset:4608
    ds_read_b64_tr_b16 v[92:93], v23 offset:4096
    ds_read_b64_tr_b16 v[94:95], v23 offset:4608
    ds_read_b64_tr_b16 v[96:97], v24
    ds_read_b64_tr_b16 v[98:99], v25
    v_mfma_f32_16x16x32_bf16 v[148:151], v[76:79], v[30:33], v[148:151]
    v_mfma_f32_16x16x32_bf16 v[152:155], v[76:79], v[34:37], v[152:155]
    v_mfma_f32_16x16x32_bf16 v[156:159], v[76:79], v[38:41], v[156:159]
    v_mfma_f32_16x16x32_bf16 v[160:163], v[76:79], v[42:45], v[160:163]
    v_mfma_f32_16x16x32_bf16 v[164:167], v[80:83], v[30:33], v[164:167]
    v_mfma_f32_16x16x32_bf16 v[168:171], v[80:83], v[34:37], v[168:171]
    v_mfma_f32_16x16x32_bf16 v[172:175], v[80:83], v[38:41], v[172:175]
    v_mfma_f32_16x16x32_bf16 v[176:179], v[80:83], v[42:45], v[176:179]
    v_mfma_f32_16x16x32_bf16 v[180:183], v[84:87], v[30:33], v[180:183]
    v_mfma_f32_16x16x32_bf16 v[184:187], v[84:87], v[34:37], v[184:187]
    v_mfma_f32_16x16x32_bf16 v[188:191], v[84:87], v[38:41], v[188:191]
    v_mfma_f32_16x16x32_bf16 v[192:195], v[84:87], v[42:45], v[192:195]
    s_waitcnt lgkmcnt(0)
    v_mfma_f32_16x16x32_bf16 v[196:199], v[88:91], v[30:33], v[196:199]
    v_mfma_f32_16x16x32_bf16 v[200:203], v[88:91], v[34:37], v[200:203]
    v_mfma_f32_16x16x32_bf16 v[204:207], v[88:91], v[38:41], v[204:207]
    v_mfma_f32_16x16x32_bf16 v[208:211], v[88:91], v[42:45], v[208:211]
    v_mfma_f32_16x16x32_bf16 v[212:215], v[92:95], v[30:33], v[212:215]
    v_mfma_f32_16x16x32_bf16 v[216:219], v[92:95], v[34:37], v[216:219]
    v_mfma_f32_16x16x32_bf16 v[220:223], v[92:95], v[38:41], v[220:223]
    v_mfma_f32_16x16x32_bf16 v[224:227], v[92:95], v[42:45], v[224:227]
    v_mfma_f32_16x16x32_bf16 v[228:231], v[96:99], v[30:33], v[228:231]
    v_mfma_f32_16x16x32_bf16 v[232:235], v[96:99], v[34:37], v[232:235]
    v_mfma_f32_16x16x32_bf16 v[236:239], v[96:99], v[38:41], v[236:239]
    v_mfma_f32_16x16x32_bf16 v[240:243], v[96:99], v[42:45], v[240:243]
    s_lshl_b32 s46, s2, 3
    s_add_u32 s46, s46, s24
    s_lshl_b32 s46, s46, 6
    v_add_u32 v6, s46, v0
    v_lshlrev_b32 v6, 7, v6
    buffer_load_dword v56, v6, s[72:75], 0 offen
    buffer_load_dword v57, v6, s[76:79], 0 offen
    buffer_load_dword v58, v6, s[80:83], 0 offen
    s_nop 15
    s_nop 7
    s_barrier
    v_and_b32 v10, 15, v0
    s_lshl_b32 s26, s29, 6
    v_add_u32 v10, s26, v10
    v_mul_u32_u24 v10, 304, v10
    v_lshrrev_b32 v11, 4, v0
    v_lshl_add_u32 v10, v11, 3, v10
    s_mul_i32 s26, s33, 77824
    v_add_u32 v10, s26, v10
    v_cvt_pk_bf16_f32 v60, v100, v101
    v_cvt_pk_bf16_f32 v61, v102, v103
    ds_write_b64 v10, v[60:61] offset:0
    v_cvt_pk_bf16_f32 v62, v104, v105
    v_cvt_pk_bf16_f32 v63, v106, v107
    ds_write_b64 v10, v[62:63] offset:4864
    v_cvt_pk_bf16_f32 v64, v108, v109
    v_cvt_pk_bf16_f32 v65, v110, v111
    ds_write_b64 v10, v[64:65] offset:9728
    v_cvt_pk_bf16_f32 v66, v112, v113
    v_cvt_pk_bf16_f32 v67, v114, v115
    ds_write_b64 v10, v[66:67] offset:14592
    v_cvt_pk_bf16_f32 v68, v116, v117
    v_cvt_pk_bf16_f32 v69, v118, v119
    ds_write_b64 v10, v[68:69] offset:32
    v_cvt_pk_bf16_f32 v70, v120, v121
    v_cvt_pk_bf16_f32 v71, v122, v123
    ds_write_b64 v10, v[70:71] offset:4896
    v_cvt_pk_bf16_f32 v72, v124, v125
    v_cvt_pk_bf16_f32 v73, v126, v127
    ds_write_b64 v10, v[72:73] offset:9760
    v_cvt_pk_bf16_f32 v74, v128, v129
    v_cvt_pk_bf16_f32 v75, v130, v131
    ds_write_b64 v10, v[74:75] offset:14624
    v_cvt_pk_bf16_f32 v60, v132, v133
    v_cvt_pk_bf16_f32 v61, v134, v135
    ds_write_b64 v10, v[60:61] offset:64
    v_cvt_pk_bf16_f32 v62, v136, v137
    v_cvt_pk_bf16_f32 v63, v138, v139
    ds_write_b64 v10, v[62:63] offset:4928
    v_cvt_pk_bf16_f32 v64, v140, v141
    v_cvt_pk_bf16_f32 v65, v142, v143
    ds_write_b64 v10, v[64:65] offset:9792
    v_cvt_pk_bf16_f32 v66, v144, v145
    v_cvt_pk_bf16_f32 v67, v146, v147
    ds_write_b64 v10, v[66:67] offset:14656
    v_cvt_pk_bf16_f32 v68, v148, v149
    v_cvt_pk_bf16_f32 v69, v150, v151
    ds_write_b64 v10, v[68:69] offset:96
    v_cvt_pk_bf16_f32 v70, v152, v153
    v_cvt_pk_bf16_f32 v71, v154, v155
    ds_write_b64 v10, v[70:71] offset:4960
    v_cvt_pk_bf16_f32 v72, v156, v157
    v_cvt_pk_bf16_f32 v73, v158, v159
    ds_write_b64 v10, v[72:73] offset:9824
    v_cvt_pk_bf16_f32 v74, v160, v161
    v_cvt_pk_bf16_f32 v75, v162, v163
    ds_write_b64 v10, v[74:75] offset:14688
    v_cvt_pk_bf16_f32 v60, v164, v165
    v_cvt_pk_bf16_f32 v61, v166, v167
    ds_write_b64 v10, v[60:61] offset:128
    v_cvt_pk_bf16_f32 v62, v168, v169
    v_cvt_pk_bf16_f32 v63, v170, v171
    ds_write_b64 v10, v[62:63] offset:4992
    v_cvt_pk_bf16_f32 v64, v172, v173
    v_cvt_pk_bf16_f32 v65, v174, v175
    ds_write_b64 v10, v[64:65] offset:9856
    v_cvt_pk_bf16_f32 v66, v176, v177
    v_cvt_pk_bf16_f32 v67, v178, v179
    ds_write_b64 v10, v[66:67] offset:14720
    v_cvt_pk_bf16_f32 v68, v180, v181
    v_cvt_pk_bf16_f32 v69, v182, v183
    ds_write_b64 v10, v[68:69] offset:160
    v_cvt_pk_bf16_f32 v70, v184, v185
    v_cvt_pk_bf16_f32 v71, v186, v187
    ds_write_b64 v10, v[70:71] offset:5024
    v_cvt_pk_bf16_f32 v72, v188, v189
    v_cvt_pk_bf16_f32 v73, v190, v191
    ds_write_b64 v10, v[72:73] offset:9888
    v_cvt_pk_bf16_f32 v74, v192, v193
    v_cvt_pk_bf16_f32 v75, v194, v195
    ds_write_b64 v10, v[74:75] offset:14752
    v_cvt_pk_bf16_f32 v60, v196, v197
    v_cvt_pk_bf16_f32 v61, v198, v199
    ds_write_b64 v10, v[60:61] offset:192
    v_cvt_pk_bf16_f32 v62, v200, v201
    v_cvt_pk_bf16_f32 v63, v202, v203
    ds_write_b64 v10, v[62:63] offset:5056
    v_cvt_pk_bf16_f32 v64, v204, v205
    v_cvt_pk_bf16_f32 v65, v206, v207
    ds_write_b64 v10, v[64:65] offset:9920
    v_cvt_pk_bf16_f32 v66, v208, v209
    v_cvt_pk_bf16_f32 v67, v210, v211
    ds_write_b64 v10, v[66:67] offset:14784
    v_cvt_pk_bf16_f32 v68, v212, v213
    v_cvt_pk_bf16_f32 v69, v214, v215
    ds_write_b64 v10, v[68:69] offset:224
    v_cvt_pk_bf16_f32 v70, v216, v217
    v_cvt_pk_bf16_f32 v71, v218, v219
    ds_write_b64 v10, v[70:71] offset:5088
    v_cvt_pk_bf16_f32 v72, v220, v221
    v_cvt_pk_bf16_f32 v73, v222, v223
    ds_write_b64 v10, v[72:73] offset:9952
    v_cvt_pk_bf16_f32 v74, v224, v225
    v_cvt_pk_bf16_f32 v75, v226, v227
    ds_write_b64 v10, v[74:75] offset:14816
    v_cvt_pk_bf16_f32 v60, v228, v229
    v_cvt_pk_bf16_f32 v61, v230, v231
    ds_write_b64 v10, v[60:61] offset:256
    v_cvt_pk_bf16_f32 v62, v232, v233
    v_cvt_pk_bf16_f32 v63, v234, v235
    ds_write_b64 v10, v[62:63] offset:5120
    v_cvt_pk_bf16_f32 v64, v236, v237
    v_cvt_pk_bf16_f32 v65, v238, v239
    ds_write_b64 v10, v[64:65] offset:9984
    v_cvt_pk_bf16_f32 v66, v240, v241
    v_cvt_pk_bf16_f32 v67, v242, v243
    ds_write_b64 v10, v[66:67] offset:14848
    s_waitcnt lgkmcnt(0)
    s_barrier
    s_lshl_b32 s26, s24, 6
    v_add_u32 v10, s26, v0
    s_mov_b32 s34, 3641
    s_mul_i32 s26, s30, 2359296
    s_mul_i32 s27, s31, 288
    s_add_u32 s26, s26, s27
    s_mov_b32 s27, 9216
    v_add_u32 v11, 0, v10
    v_mul_lo_u32 v12, v11, s34
    v_lshrrev_b32 v12, 16, v12
    v_mul_u32_u24 v13, 18, v12
    v_sub_u32 v13, v11, v13
    v_mul_u32_u24 v11, 304, v12
    v_lshl_add_u32 v11, v13, 4, v11
    ds_read_b128 v[100:103], v11
    v_add_u32 v11, 77824, v11
    ds_read_b128 v[104:107], v11
    v_mul_lo_u32 v12, v12, s27
    v_lshl_add_u32 v180, v13, 4, v12
    v_add_u32 v11, 512, v10
    v_mul_lo_u32 v12, v11, s34
    v_lshrrev_b32 v12, 16, v12
    v_mul_u32_u24 v13, 18, v12
    v_sub_u32 v13, v11, v13
    v_mul_u32_u24 v11, 304, v12
    v_lshl_add_u32 v11, v13, 4, v11
    ds_read_b128 v[108:111], v11
    v_add_u32 v11, 77824, v11
    ds_read_b128 v[112:115], v11
    v_mul_lo_u32 v12, v12, s27
    v_lshl_add_u32 v181, v13, 4, v12
    v_add_u32 v11, 1024, v10
    v_mul_lo_u32 v12, v11, s34
    v_lshrrev_b32 v12, 16, v12
    v_mul_u32_u24 v13, 18, v12
    v_sub_u32 v13, v11, v13
    v_mul_u32_u24 v11, 304, v12
    v_lshl_add_u32 v11, v13, 4, v11
    ds_read_b128 v[116:119], v11
    v_add_u32 v11, 77824, v11
    ds_read_b128 v[120:123], v11
    v_mul_lo_u32 v12, v12, s27
    v_lshl_add_u32 v182, v13, 4, v12
    v_add_u32 v11, 1536, v10
    v_mul_lo_u32 v12, v11, s34
    v_lshrrev_b32 v12, 16, v12
    v_mul_u32_u24 v13, 18, v12
    v_sub_u32 v13, v11, v13
    v_mul_u32_u24 v11, 304, v12
    v_lshl_add_u32 v11, v13, 4, v11
    ds_read_b128 v[124:127], v11
    v_add_u32 v11, 77824, v11
    ds_read_b128 v[128:131], v11
    v_mul_lo_u32 v12, v12, s27
    v_lshl_add_u32 v183, v13, 4, v12
    v_add_u32 v11, 2048, v10
    v_mul_lo_u32 v12, v11, s34
    v_lshrrev_b32 v12, 16, v12
    v_mul_u32_u24 v13, 18, v12
    v_sub_u32 v13, v11, v13
    v_mul_u32_u24 v11, 304, v12
    v_lshl_add_u32 v11, v13, 4, v11
    ds_read_b128 v[132:135], v11
    v_add_u32 v11, 77824, v11
    ds_read_b128 v[136:139], v11
    v_mul_lo_u32 v12, v12, s27
    v_lshl_add_u32 v184, v13, 4, v12
    v_add_u32 v11, 2560, v10
    v_mul_lo_u32 v12, v11, s34
    v_lshrrev_b32 v12, 16, v12
    v_mul_u32_u24 v13, 18, v12
    v_sub_u32 v13, v11, v13
    v_mul_u32_u24 v11, 304, v12
    v_lshl_add_u32 v11, v13, 4, v11
    ds_read_b128 v[140:143], v11
    v_add_u32 v11, 77824, v11
    ds_read_b128 v[144:147], v11
    v_mul_lo_u32 v12, v12, s27
    v_lshl_add_u32 v185, v13, 4, v12
    v_add_u32 v11, 3072, v10
    v_mul_lo_u32 v12, v11, s34
    v_lshrrev_b32 v12, 16, v12
    v_mul_u32_u24 v13, 18, v12
    v_sub_u32 v13, v11, v13
    v_mul_u32_u24 v11, 304, v12
    v_lshl_add_u32 v11, v13, 4, v11
    ds_read_b128 v[148:151], v11
    v_add_u32 v11, 77824, v11
    ds_read_b128 v[152:155], v11
    v_mul_lo_u32 v12, v12, s27
    v_lshl_add_u32 v186, v13, 4, v12
    v_add_u32 v11, 3584, v10
    v_mul_lo_u32 v12, v11, s34
    v_lshrrev_b32 v12, 16, v12
    v_mul_u32_u24 v13, 18, v12
    v_sub_u32 v13, v11, v13
    v_mul_u32_u24 v11, 304, v12
    v_lshl_add_u32 v11, v13, 4, v11
    ds_read_b128 v[156:159], v11
    v_add_u32 v11, 77824, v11
    ds_read_b128 v[160:163], v11
    v_mul_lo_u32 v12, v12, s27
    v_lshl_add_u32 v187, v13, 4, v12
    v_add_u32 v11, 4096, v10
    v_mul_lo_u32 v12, v11, s34
    v_lshrrev_b32 v12, 16, v12
    v_mul_u32_u24 v13, 18, v12
    v_sub_u32 v13, v11, v13
    v_mul_u32_u24 v11, 304, v12
    v_lshl_add_u32 v11, v13, 4, v11
    ds_read_b128 v[164:167], v11
    v_add_u32 v11, 77824, v11
    ds_read_b128 v[168:171], v11
    v_mul_lo_u32 v12, v12, s27
    v_lshl_add_u32 v188, v13, 4, v12
    s_waitcnt lgkmcnt(15)
    v_lshlrev_b32 v20, 16, v100
    v_and_b32 v21, 0xffff0000, v100
    v_lshlrev_b32 v22, 16, v104
    v_and_b32 v23, 0xffff0000, v104
    v_mul_f32 v20, v20, v22
    v_mul_f32 v21, v21, v23
    v_cvt_pk_bf16_f32 v60, v20, v21
    v_lshlrev_b32 v20, 16, v101
    v_and_b32 v21, 0xffff0000, v101
    v_lshlrev_b32 v22, 16, v105
    v_and_b32 v23, 0xffff0000, v105
    v_mul_f32 v20, v20, v22
    v_mul_f32 v21, v21, v23
    v_cvt_pk_bf16_f32 v61, v20, v21
    v_lshlrev_b32 v20, 16, v102
    v_and_b32 v21, 0xffff0000, v102
    v_lshlrev_b32 v22, 16, v106
    v_and_b32 v23, 0xffff0000, v106
    v_mul_f32 v20, v20, v22
    v_mul_f32 v21, v21, v23
    v_cvt_pk_bf16_f32 v62, v20, v21
    v_lshlrev_b32 v20, 16, v103
    v_and_b32 v21, 0xffff0000, v103
    v_lshlrev_b32 v22, 16, v107
    v_and_b32 v23, 0xffff0000, v107
    v_mul_f32 v20, v20, v22
    v_mul_f32 v21, v21, v23
    v_cvt_pk_bf16_f32 v63, v20, v21
    buffer_store_dwordx4 v[60:63], v180, s[20:23], s26 offen
    s_waitcnt lgkmcnt(14)
    v_lshlrev_b32 v20, 16, v108
    v_and_b32 v21, 0xffff0000, v108
    v_lshlrev_b32 v22, 16, v112
    v_and_b32 v23, 0xffff0000, v112
    v_mul_f32 v20, v20, v22
    v_mul_f32 v21, v21, v23
    v_cvt_pk_bf16_f32 v64, v20, v21
    v_lshlrev_b32 v20, 16, v109
    v_and_b32 v21, 0xffff0000, v109
    v_lshlrev_b32 v22, 16, v113
    v_and_b32 v23, 0xffff0000, v113
    v_mul_f32 v20, v20, v22
    v_mul_f32 v21, v21, v23
    v_cvt_pk_bf16_f32 v65, v20, v21
    v_lshlrev_b32 v20, 16, v110
    v_and_b32 v21, 0xffff0000, v110
    v_lshlrev_b32 v22, 16, v114
    v_and_b32 v23, 0xffff0000, v114
    v_mul_f32 v20, v20, v22
    v_mul_f32 v21, v21, v23
    v_cvt_pk_bf16_f32 v66, v20, v21
    v_lshlrev_b32 v20, 16, v111
    v_and_b32 v21, 0xffff0000, v111
    v_lshlrev_b32 v22, 16, v115
    v_and_b32 v23, 0xffff0000, v115
    v_mul_f32 v20, v20, v22
    v_mul_f32 v21, v21, v23
    v_cvt_pk_bf16_f32 v67, v20, v21
    buffer_store_dwordx4 v[64:67], v181, s[20:23], s26 offen
    s_waitcnt lgkmcnt(12)
    v_lshlrev_b32 v20, 16, v116
    v_and_b32 v21, 0xffff0000, v116
    v_lshlrev_b32 v22, 16, v120
    v_and_b32 v23, 0xffff0000, v120
    v_mul_f32 v20, v20, v22
    v_mul_f32 v21, v21, v23
    v_cvt_pk_bf16_f32 v68, v20, v21
    v_lshlrev_b32 v20, 16, v117
    v_and_b32 v21, 0xffff0000, v117
    v_lshlrev_b32 v22, 16, v121
    v_and_b32 v23, 0xffff0000, v121
    v_mul_f32 v20, v20, v22
    v_mul_f32 v21, v21, v23
    v_cvt_pk_bf16_f32 v69, v20, v21
    v_lshlrev_b32 v20, 16, v118
    v_and_b32 v21, 0xffff0000, v118
    v_lshlrev_b32 v22, 16, v122
    v_and_b32 v23, 0xffff0000, v122
    v_mul_f32 v20, v20, v22
    v_mul_f32 v21, v21, v23
    v_cvt_pk_bf16_f32 v70, v20, v21
    v_lshlrev_b32 v20, 16, v119
    v_and_b32 v21, 0xffff0000, v119
    v_lshlrev_b32 v22, 16, v123
    v_and_b32 v23, 0xffff0000, v123
    v_mul_f32 v20, v20, v22
    v_mul_f32 v21, v21, v23
    v_cvt_pk_bf16_f32 v71, v20, v21
    buffer_store_dwordx4 v[68:71], v182, s[20:23], s26 offen
    s_waitcnt lgkmcnt(10)
    v_lshlrev_b32 v20, 16, v124
    v_and_b32 v21, 0xffff0000, v124
    v_lshlrev_b32 v22, 16, v128
    v_and_b32 v23, 0xffff0000, v128
    v_mul_f32 v20, v20, v22
    v_mul_f32 v21, v21, v23
    v_cvt_pk_bf16_f32 v72, v20, v21
    v_lshlrev_b32 v20, 16, v125
    v_and_b32 v21, 0xffff0000, v125
    v_lshlrev_b32 v22, 16, v129
    v_and_b32 v23, 0xffff0000, v129
    v_mul_f32 v20, v20, v22
    v_mul_f32 v21, v21, v23
    v_cvt_pk_bf16_f32 v73, v20, v21
    v_lshlrev_b32 v20, 16, v126
    v_and_b32 v21, 0xffff0000, v126
    v_lshlrev_b32 v22, 16, v130
    v_and_b32 v23, 0xffff0000, v130
    v_mul_f32 v20, v20, v22
    v_mul_f32 v21, v21, v23
    v_cvt_pk_bf16_f32 v74, v20, v21
    v_lshlrev_b32 v20, 16, v127
    v_and_b32 v21, 0xffff0000, v127
    v_lshlrev_b32 v22, 16, v131
    v_and_b32 v23, 0xffff0000, v131
    v_mul_f32 v20, v20, v22
    v_mul_f32 v21, v21, v23
    v_cvt_pk_bf16_f32 v75, v20, v21
    buffer_store_dwordx4 v[72:75], v183, s[20:23], s26 offen
    s_waitcnt lgkmcnt(8)
    v_lshlrev_b32 v20, 16, v132
    v_and_b32 v21, 0xffff0000, v132
    v_lshlrev_b32 v22, 16, v136
    v_and_b32 v23, 0xffff0000, v136
    v_mul_f32 v20, v20, v22
    v_mul_f32 v21, v21, v23
    v_cvt_pk_bf16_f32 v76, v20, v21
    v_lshlrev_b32 v20, 16, v133
    v_and_b32 v21, 0xffff0000, v133
    v_lshlrev_b32 v22, 16, v137
    v_and_b32 v23, 0xffff0000, v137
    v_mul_f32 v20, v20, v22
    v_mul_f32 v21, v21, v23
    v_cvt_pk_bf16_f32 v77, v20, v21
    v_lshlrev_b32 v20, 16, v134
    v_and_b32 v21, 0xffff0000, v134
    v_lshlrev_b32 v22, 16, v138
    v_and_b32 v23, 0xffff0000, v138
    v_mul_f32 v20, v20, v22
    v_mul_f32 v21, v21, v23
    v_cvt_pk_bf16_f32 v78, v20, v21
    v_lshlrev_b32 v20, 16, v135
    v_and_b32 v21, 0xffff0000, v135
    v_lshlrev_b32 v22, 16, v139
    v_and_b32 v23, 0xffff0000, v139
    v_mul_f32 v20, v20, v22
    v_mul_f32 v21, v21, v23
    v_cvt_pk_bf16_f32 v79, v20, v21
    buffer_store_dwordx4 v[76:79], v184, s[20:23], s26 offen
    s_waitcnt lgkmcnt(6)
    v_lshlrev_b32 v20, 16, v140
    v_and_b32 v21, 0xffff0000, v140
    v_lshlrev_b32 v22, 16, v144
    v_and_b32 v23, 0xffff0000, v144
    v_mul_f32 v20, v20, v22
    v_mul_f32 v21, v21, v23
    v_cvt_pk_bf16_f32 v80, v20, v21
    v_lshlrev_b32 v20, 16, v141
    v_and_b32 v21, 0xffff0000, v141
    v_lshlrev_b32 v22, 16, v145
    v_and_b32 v23, 0xffff0000, v145
    v_mul_f32 v20, v20, v22
    v_mul_f32 v21, v21, v23
    v_cvt_pk_bf16_f32 v81, v20, v21
    v_lshlrev_b32 v20, 16, v142
    v_and_b32 v21, 0xffff0000, v142
    v_lshlrev_b32 v22, 16, v146
    v_and_b32 v23, 0xffff0000, v146
    v_mul_f32 v20, v20, v22
    v_mul_f32 v21, v21, v23
    v_cvt_pk_bf16_f32 v82, v20, v21
    v_lshlrev_b32 v20, 16, v143
    v_and_b32 v21, 0xffff0000, v143
    v_lshlrev_b32 v22, 16, v147
    v_and_b32 v23, 0xffff0000, v147
    v_mul_f32 v20, v20, v22
    v_mul_f32 v21, v21, v23
    v_cvt_pk_bf16_f32 v83, v20, v21
    buffer_store_dwordx4 v[80:83], v185, s[20:23], s26 offen
    s_waitcnt lgkmcnt(4)
    v_lshlrev_b32 v20, 16, v148
    v_and_b32 v21, 0xffff0000, v148
    v_lshlrev_b32 v22, 16, v152
    v_and_b32 v23, 0xffff0000, v152
    v_mul_f32 v20, v20, v22
    v_mul_f32 v21, v21, v23
    v_cvt_pk_bf16_f32 v84, v20, v21
    v_lshlrev_b32 v20, 16, v149
    v_and_b32 v21, 0xffff0000, v149
    v_lshlrev_b32 v22, 16, v153
    v_and_b32 v23, 0xffff0000, v153
    v_mul_f32 v20, v20, v22
    v_mul_f32 v21, v21, v23
    v_cvt_pk_bf16_f32 v85, v20, v21
    v_lshlrev_b32 v20, 16, v150
    v_and_b32 v21, 0xffff0000, v150
    v_lshlrev_b32 v22, 16, v154
    v_and_b32 v23, 0xffff0000, v154
    v_mul_f32 v20, v20, v22
    v_mul_f32 v21, v21, v23
    v_cvt_pk_bf16_f32 v86, v20, v21
    v_lshlrev_b32 v20, 16, v151
    v_and_b32 v21, 0xffff0000, v151
    v_lshlrev_b32 v22, 16, v155
    v_and_b32 v23, 0xffff0000, v155
    v_mul_f32 v20, v20, v22
    v_mul_f32 v21, v21, v23
    v_cvt_pk_bf16_f32 v87, v20, v21
    buffer_store_dwordx4 v[84:87], v186, s[20:23], s26 offen
    s_waitcnt lgkmcnt(2)
    v_lshlrev_b32 v20, 16, v156
    v_and_b32 v21, 0xffff0000, v156
    v_lshlrev_b32 v22, 16, v160
    v_and_b32 v23, 0xffff0000, v160
    v_mul_f32 v20, v20, v22
    v_mul_f32 v21, v21, v23
    v_cvt_pk_bf16_f32 v88, v20, v21
    v_lshlrev_b32 v20, 16, v157
    v_and_b32 v21, 0xffff0000, v157
    v_lshlrev_b32 v22, 16, v161
    v_and_b32 v23, 0xffff0000, v161
    v_mul_f32 v20, v20, v22
    v_mul_f32 v21, v21, v23
    v_cvt_pk_bf16_f32 v89, v20, v21
    v_lshlrev_b32 v20, 16, v158
    v_and_b32 v21, 0xffff0000, v158
    v_lshlrev_b32 v22, 16, v162
    v_and_b32 v23, 0xffff0000, v162
    v_mul_f32 v20, v20, v22
    v_mul_f32 v21, v21, v23
    v_cvt_pk_bf16_f32 v90, v20, v21
    v_lshlrev_b32 v20, 16, v159
    v_and_b32 v21, 0xffff0000, v159
    v_lshlrev_b32 v22, 16, v163
    v_and_b32 v23, 0xffff0000, v163
    v_mul_f32 v20, v20, v22
    v_mul_f32 v21, v21, v23
    v_cvt_pk_bf16_f32 v91, v20, v21
    buffer_store_dwordx4 v[88:91], v187, s[20:23], s26 offen
    s_waitcnt lgkmcnt(0)
    v_lshlrev_b32 v20, 16, v164
    v_and_b32 v21, 0xffff0000, v164
    v_lshlrev_b32 v22, 16, v168
    v_and_b32 v23, 0xffff0000, v168
    v_mul_f32 v20, v20, v22
    v_mul_f32 v21, v21, v23
    v_cvt_pk_bf16_f32 v92, v20, v21
    v_lshlrev_b32 v20, 16, v165
    v_and_b32 v21, 0xffff0000, v165
    v_lshlrev_b32 v22, 16, v169
    v_and_b32 v23, 0xffff0000, v169
    v_mul_f32 v20, v20, v22
    v_mul_f32 v21, v21, v23
    v_cvt_pk_bf16_f32 v93, v20, v21
    v_lshlrev_b32 v20, 16, v166
    v_and_b32 v21, 0xffff0000, v166
    v_lshlrev_b32 v22, 16, v170
    v_and_b32 v23, 0xffff0000, v170
    v_mul_f32 v20, v20, v22
    v_mul_f32 v21, v21, v23
    v_cvt_pk_bf16_f32 v94, v20, v21
    v_lshlrev_b32 v20, 16, v167
    v_and_b32 v21, 0xffff0000, v167
    v_lshlrev_b32 v22, 16, v171
    v_and_b32 v23, 0xffff0000, v171
    v_mul_f32 v20, v20, v22
    v_mul_f32 v21, v21, v23
    v_cvt_pk_bf16_f32 v95, v20, v21
    buffer_store_dwordx4 v[92:95], v188, s[20:23], s26 offen
gu_done:
    s_endpgm
qkv_kernel_body:
    s_cmp_ge_u32 s2, 192
    s_cbranch_scc1 qkv_done
    s_load_dwordx4 s[4:7], s[0:1], 0
    s_load_dwordx2 s[44:45], s[0:1], 80
    v_lshrrev_b32 v1, 6, v0
    s_nop 0
    v_readfirstlane_b32 s24, v1
    v_and_b32 v0, 63, v0
    s_and_b32 s30, s2, 7
    s_mul_i32 s30, s30, 24
    s_lshr_b32 s31, s2, 3
    s_add_u32 s30, s30, s31
    s_lshr_b32 s31, s30, 4
    s_and_b32 s30, s30, 15
    s_waitcnt lgkmcnt(0)
    s_mov_b32 s8, s4
    s_mov_b32 s9, s5
    s_mov_b32 s10, 2359296
    s_mov_b32 s11, 0x00020000
    s_mov_b32 s12, s6
    s_mov_b32 s13, s7
    s_mov_b32 s14, 1990656
    s_mov_b32 s15, 0x00020000
    s_mov_b32 s20, s44
    s_mov_b32 s21, s45
    s_mov_b32 s22, 8388608
    s_mov_b32 s23, 0x00020000
    s_and_b32 s29, s24, 3
    s_lshr_b32 s33, s24, 2
    s_and_b32 s34, s24, 3
    v_lshrrev_b32 v10, 2, v0
    v_lshrrev_b32 v11, 4, v0
    v_sub_u32 v11, 4, v11
    v_and_b32 v11, 3, v11
    v_and_b32 v12, 3, v0
    v_xor_b32 v12, v12, v11
    s_lshl_b32 s26, s24, 4
    v_add_u32 v10, s26, v10
    s_mov_b32 s26, 1152
    v_mul_lo_u32 v10, v10, s26
    v_lshl_add_u32 v2, v12, 4, v10
    v_add_u32 v3, 73728, v2
    v_lshrrev_b32 v10, 3, v0
    v_bfe_u32 v11, v0, 4, 1
    s_and_b32 s26, s34, 1
    s_lshl_b32 s26, s26, 1
    v_or_b32 v11, s26, v11
    v_bfe_u32 v12, v0, 1, 2
    v_xor_b32 v12, v12, v11
    v_and_b32 v13, 1, v0
    v_lshlrev_b32 v13, 4, v13
    v_lshl_add_u32 v13, v12, 5, v13
    s_lshl_b32 s26, s34, 3
    v_add_u32 v10, s26, v10
    s_mov_b32 s26, 3456
    v_mul_lo_u32 v10, v10, s26
    v_add_u32 v4, v10, v13
    v_lshrrev_b32 v10, 1, v0
    s_lshl_b32 s26, s34, 3
    v_add_u32 v10, s26, v10
    s_and_b32 s26, s34, 1
    s_lshl_b32 s26, s26, 2
    v_xor_b32 v10, s26, v10
    s_mov_b32 s26, 3456
    v_mul_lo_u32 v10, v10, s26
    v_and_b32 v11, 1, v0
    v_lshl_add_u32 v10, v11, 4, v10
    v_add_u32 v5, 256, v10
    v_bfe_u32 v10, v0, 2, 2
    v_sub_u32 v10, 4, v10
    v_and_b32 v10, 3, v10
    v_lshrrev_b32 v11, 4, v0
    v_xor_b32 v10, v10, v11
    v_and_b32 v11, 15, v0
    s_mul_i32 s26, s29, 32
    v_add_u32 v11, s26, v11
    v_lshlrev_b32 v11, 6, v11
    v_lshl_add_u32 v14, v10, 4, v11
    s_mul_i32 s26, s33, 9216
    s_add_u32 s26, s26, 8192
    v_lshrrev_b32 v10, 4, v0
    v_bfe_u32 v11, v0, 2, 2
    v_lshl_add_u32 v11, v10, 3, v11
    v_and_b32 v12, 3, v0
    v_lshlrev_b32 v13, 7, v11
    v_lshl_add_u32 v13, v12, 3, v13
    v_add_u32 v13, s26, v13
    v_bfe_u32 v6, v0, 3, 1
    v_and_b32 v7, 1, v10
    v_lshl_or_b32 v6, v7, 1, v6
    v_xor_b32 v8, 0, v6
    v_lshl_add_u32 v16, v8, 5, v13
    v_xor_b32 v8, 1, v6
    v_lshl_add_u32 v17, v8, 5, v13
    v_xor_b32 v8, 2, v6
    v_lshl_add_u32 v18, v8, 5, v13
    v_xor_b32 v8, 3, v6
    v_lshl_add_u32 v19, v8, 5, v13
    v_lshlrev_b32 v13, 5, v11
    v_lshl_add_u32 v13, v12, 3, v13
    v_add_u32 v13, s26, v13
    v_add_u32 v13, 8192, v13
    v_lshl_add_u32 v20, v7, 7, v13
    v_xor_b32 v7, 1, v7
    v_lshl_add_u32 v21, v7, 7, v13
    s_lshl_b32 s25, s24, 10
    s_mul_i32 s38, s33, 9216
    s_add_u32 s38, s38, 8192
    s_lshl_b32 s26, s34, 8
    s_add_u32 s39, s38, s26
    s_add_u32 s39, s39, 8192
    s_lshl_b32 s26, s34, 10
    s_add_u32 s38, s38, s26
    s_mul_i32 s26, s30, 147456
    s_mul_i32 s27, s31, 288
    v_mov_b32 v54, 0
    v_mov_b32 v55, 0
    v_mov_b32 v56, 0
    v_mov_b32 v57, 0
    v_mov_b32 v58, 0
    v_mov_b32 v59, 0
    v_mov_b32 v60, 0
    v_mov_b32 v61, 0
    v_mov_b32 v62, 0
    v_mov_b32 v63, 0
    v_mov_b32 v64, 0
    v_mov_b32 v65, 0
    v_mov_b32 v66, 0
    v_mov_b32 v67, 0
    v_mov_b32 v68, 0
    v_mov_b32 v69, 0
    v_mov_b32 v70, 0
    v_mov_b32 v71, 0
    v_mov_b32 v72, 0
    v_mov_b32 v73, 0
    v_mov_b32 v74, 0
    v_mov_b32 v75, 0
    v_mov_b32 v76, 0
    v_mov_b32 v77, 0
    v_mov_b32 v78, 0
    v_mov_b32 v79, 0
    v_mov_b32 v80, 0
    v_mov_b32 v81, 0
    v_mov_b32 v82, 0
    v_mov_b32 v83, 0
    v_mov_b32 v84, 0
    v_mov_b32 v85, 0
    v_mov_b32 v86, 0
    v_mov_b32 v87, 0
    v_mov_b32 v88, 0
    v_mov_b32 v89, 0
    v_mov_b32 v90, 0
    v_mov_b32 v91, 0
    v_mov_b32 v92, 0
    v_mov_b32 v93, 0
    v_mov_b32 v94, 0
    v_mov_b32 v95, 0
    v_mov_b32 v96, 0
    v_mov_b32 v97, 0
    v_mov_b32 v98, 0
    v_mov_b32 v99, 0
    v_mov_b32 v100, 0
    v_mov_b32 v101, 0
    v_mov_b32 v102, 0
    v_mov_b32 v103, 0
    v_mov_b32 v104, 0
    v_mov_b32 v105, 0
    v_mov_b32 v106, 0
    v_mov_b32 v107, 0
    v_mov_b32 v108, 0
    v_mov_b32 v109, 0
    v_mov_b32 v110, 0
    v_mov_b32 v111, 0
    v_mov_b32 v112, 0
    v_mov_b32 v113, 0
    v_mov_b32 v114, 0
    v_mov_b32 v115, 0
    v_mov_b32 v116, 0
    v_mov_b32 v117, 0
    v_mov_b32 v118, 0
    v_mov_b32 v119, 0
    v_mov_b32 v120, 0
    v_mov_b32 v121, 0
    v_mov_b32 v122, 0
    v_mov_b32 v123, 0
    v_mov_b32 v124, 0
    v_mov_b32 v125, 0
    s_cmp_ge_u32 s31, 8
    s_cbranch_scc1 qkv_vpath
    s_add_u32 m0, s25, 0
    s_nop 0
    buffer_load_dwordx4 v2, s[8:11], s26 offen lds
    s_add_u32 m0, s25, 4096
    s_nop 0
    buffer_load_dwordx4 v3, s[8:11], s26 offen lds
    s_add_u32 m0, s38, 0
    s_add_u32 s28, s27, 128
    buffer_load_dwordx4 v4, s[12:15], s27 offen lds
    s_add_u32 m0, s38, 4096
    s_nop 0
    buffer_load_dwordx4 v4, s[12:15], s28 offen lds
    s_add_u32 m0, s39, 0
    s_mov_b64 exec, 0xffff
    buffer_load_dwordx4 v5, s[12:15], s27 offen lds
    s_mov_b64 exec, -1
    s_add_u32 s26, s26, 64
    s_add_u32 s27, s27, 110592
    s_add_u32 m0, s25, 17408
    s_nop 0
    buffer_load_dwordx4 v2, s[8:11], s26 offen lds
    s_add_u32 m0, s25, 21504
    s_nop 0
    buffer_load_dwordx4 v3, s[8:11], s26 offen lds
    s_add_u32 m0, s38, 17408
    s_add_u32 s28, s27, 128
    buffer_load_dwordx4 v4, s[12:15], s27 offen lds
    s_add_u32 m0, s38, 21504
    s_nop 0
    buffer_load_dwordx4 v4, s[12:15], s28 offen lds
    s_add_u32 m0, s39, 17408
    s_mov_b64 exec, 0xffff
    buffer_load_dwordx4 v5, s[12:15], s27 offen lds
    s_mov_b64 exec, -1
    s_add_u32 s26, s26, 64
    s_add_u32 s27, s27, 110592
    s_add_u32 m0, s25, 34816
    s_nop 0
    buffer_load_dwordx4 v2, s[8:11], s26 offen lds
    s_add_u32 m0, s25, 38912
    s_nop 0
    buffer_load_dwordx4 v3, s[8:11], s26 offen lds
    s_add_u32 m0, s38, 34816
    s_add_u32 s28, s27, 128
    buffer_load_dwordx4 v4, s[12:15], s27 offen lds
    s_add_u32 m0, s38, 38912
    s_nop 0
    buffer_load_dwordx4 v4, s[12:15], s28 offen lds
    s_add_u32 m0, s39, 34816
    s_mov_b64 exec, 0xffff
    buffer_load_dwordx4 v5, s[12:15], s27 offen lds
    s_mov_b64 exec, -1
    s_add_u32 s26, s26, 64
    s_add_u32 s27, s27, 110592
    s_add_u32 m0, s25, 52224
    s_nop 0
    buffer_load_dwordx4 v2, s[8:11], s26 offen lds
    s_add_u32 m0, s25, 56320
    s_nop 0
    buffer_load_dwordx4 v3, s[8:11], s26 offen lds
    s_add_u32 m0, s38, 52224
    s_add_u32 s28, s27, 128
    buffer_load_dwordx4 v4, s[12:15], s27 offen lds
    s_add_u32 m0, s38, 56320
    s_nop 0
    buffer_load_dwordx4 v4, s[12:15], s28 offen lds
    s_add_u32 m0, s39, 52224
    s_mov_b64 exec, 0xffff
    buffer_load_dwordx4 v5, s[12:15], s27 offen lds
    s_mov_b64 exec, -1
    s_add_u32 s26, s26, 64
    s_add_u32 s27, s27, 110592
    s_add_u32 m0, s25, 69632
    s_nop 0
    buffer_load_dwordx4 v2, s[8:11], s26 offen lds
    s_add_u32 m0, s25, 73728
    s_nop 0
    buffer_load_dwordx4 v3, s[8:11], s26 offen lds
    s_add_u32 m0, s38, 69632
    s_add_u32 s28, s27, 128
    buffer_load_dwordx4 v4, s[12:15], s27 offen lds
    s_add_u32 m0, s38, 73728
    s_nop 0
    buffer_load_dwordx4 v4, s[12:15], s28 offen lds
    s_add_u32 m0, s39, 69632
    s_mov_b64 exec, 0xffff
    buffer_load_dwordx4 v5, s[12:15], s27 offen lds
    s_mov_b64 exec, -1
    s_add_u32 s26, s26, 64
    s_add_u32 s27, s27, 110592
    s_waitcnt vmcnt(20)
    s_barrier
    ds_read_b128 v[6:9], v14 offset:0
    ds_read_b128 v[10:13], v14 offset:1024
    ds_read_b64_tr_b16 v[30:31], v16 offset:0
    ds_read_b64_tr_b16 v[32:33], v16 offset:512
    ds_read_b64_tr_b16 v[34:35], v17 offset:0
    ds_read_b64_tr_b16 v[36:37], v17 offset:512
    ds_read_b64_tr_b16 v[38:39], v18 offset:0
    ds_read_b64_tr_b16 v[40:41], v18 offset:512
    s_waitcnt lgkmcnt(0)
    ds_read_b64_tr_b16 v[42:43], v19 offset:0
    ds_read_b64_tr_b16 v[44:45], v19 offset:512
    ds_read_b64_tr_b16 v[46:47], v16 offset:4096
    ds_read_b64_tr_b16 v[48:49], v16 offset:4608
    ds_read_b64_tr_b16 v[50:51], v17 offset:4096
    ds_read_b64_tr_b16 v[52:53], v17 offset:4608
    s_add_u32 m0, s25, 87040
    s_nop 0
    buffer_load_dwordx4 v2, s[8:11], s26 offen lds
    s_add_u32 m0, s25, 91136
    s_nop 0
    buffer_load_dwordx4 v3, s[8:11], s26 offen lds
    s_add_u32 m0, s38, 87040
    s_add_u32 s28, s27, 128
    buffer_load_dwordx4 v4, s[12:15], s27 offen lds
    s_add_u32 m0, s38, 91136
    s_nop 0
    buffer_load_dwordx4 v4, s[12:15], s28 offen lds
    s_add_u32 m0, s39, 87040
    s_mov_b64 exec, 0xffff
    buffer_load_dwordx4 v5, s[12:15], s27 offen lds
    s_mov_b64 exec, -1
    s_add_u32 s26, s26, 64
    s_add_u32 s27, s27, 110592
    v_mfma_f32_16x16x32_bf16 v[54:57], v[30:33], v[6:9], v[54:57]
    v_mfma_f32_16x16x32_bf16 v[58:61], v[30:33], v[10:13], v[58:61]
    v_mfma_f32_16x16x32_bf16 v[62:65], v[34:37], v[6:9], v[62:65]
    v_mfma_f32_16x16x32_bf16 v[66:69], v[34:37], v[10:13], v[66:69]
    v_mfma_f32_16x16x32_bf16 v[70:73], v[38:41], v[6:9], v[70:73]
    v_mfma_f32_16x16x32_bf16 v[74:77], v[38:41], v[10:13], v[74:77]
    s_waitcnt lgkmcnt(0)
    ds_read_b64_tr_b16 v[30:31], v18 offset:4096
    ds_read_b64_tr_b16 v[32:33], v18 offset:4608
    ds_read_b64_tr_b16 v[34:35], v19 offset:4096
    ds_read_b64_tr_b16 v[36:37], v19 offset:4608
    ds_read_b64_tr_b16 v[38:39], v20
    ds_read_b64_tr_b16 v[40:41], v21
    v_mfma_f32_16x16x32_bf16 v[78:81], v[42:45], v[6:9], v[78:81]
    v_mfma_f32_16x16x32_bf16 v[82:85], v[42:45], v[10:13], v[82:85]
    v_mfma_f32_16x16x32_bf16 v[86:89], v[46:49], v[6:9], v[86:89]
    v_mfma_f32_16x16x32_bf16 v[90:93], v[46:49], v[10:13], v[90:93]
    v_mfma_f32_16x16x32_bf16 v[94:97], v[50:53], v[6:9], v[94:97]
    v_mfma_f32_16x16x32_bf16 v[98:101], v[50:53], v[10:13], v[98:101]
    s_waitcnt lgkmcnt(0)
    s_waitcnt vmcnt(20)
    s_barrier
    v_add_u32 v14, 17408, v14
    v_add_u32 v16, 17408, v16
    v_add_u32 v17, 17408, v17
    v_add_u32 v18, 17408, v18
    v_add_u32 v19, 17408, v19
    v_add_u32 v20, 17408, v20
    v_add_u32 v21, 17408, v21
    ds_read_b128 v[22:25], v14 offset:0
    ds_read_b128 v[26:29], v14 offset:1024
    ds_read_b64_tr_b16 v[42:43], v16 offset:0
    ds_read_b64_tr_b16 v[44:45], v16 offset:512
    ds_read_b64_tr_b16 v[46:47], v17 offset:0
    ds_read_b64_tr_b16 v[48:49], v17 offset:512
    ds_read_b64_tr_b16 v[50:51], v18 offset:0
    ds_read_b64_tr_b16 v[52:53], v18 offset:512
    v_mfma_f32_16x16x32_bf16 v[102:105], v[30:33], v[6:9], v[102:105]
    v_mfma_f32_16x16x32_bf16 v[106:109], v[30:33], v[10:13], v[106:109]
    v_mfma_f32_16x16x32_bf16 v[110:113], v[34:37], v[6:9], v[110:113]
    v_mfma_f32_16x16x32_bf16 v[114:117], v[34:37], v[10:13], v[114:117]
    v_mfma_f32_16x16x32_bf16 v[118:121], v[38:41], v[6:9], v[118:121]
    v_mfma_f32_16x16x32_bf16 v[122:125], v[38:41], v[10:13], v[122:125]
    s_waitcnt lgkmcnt(0)
    ds_read_b64_tr_b16 v[30:31], v19 offset:0
    ds_read_b64_tr_b16 v[32:33], v19 offset:512
    ds_read_b64_tr_b16 v[34:35], v16 offset:4096
    ds_read_b64_tr_b16 v[36:37], v16 offset:4608
    ds_read_b64_tr_b16 v[38:39], v17 offset:4096
    ds_read_b64_tr_b16 v[40:41], v17 offset:4608
    s_add_u32 m0, s25, 0
    s_nop 0
    buffer_load_dwordx4 v2, s[8:11], s26 offen lds
    s_add_u32 m0, s25, 4096
    s_nop 0
    buffer_load_dwordx4 v3, s[8:11], s26 offen lds
    s_add_u32 m0, s38, 0
    s_add_u32 s28, s27, 128
    buffer_load_dwordx4 v4, s[12:15], s27 offen lds
    s_add_u32 m0, s38, 4096
    s_nop 0
    buffer_load_dwordx4 v4, s[12:15], s28 offen lds
    s_add_u32 m0, s39, 0
    s_mov_b64 exec, 0xffff
    buffer_load_dwordx4 v5, s[12:15], s27 offen lds
    s_mov_b64 exec, -1
    s_add_u32 s26, s26, 64
    s_add_u32 s27, s27, 110592
    v_mfma_f32_16x16x32_bf16 v[54:57], v[42:45], v[22:25], v[54:57]
    v_mfma_f32_16x16x32_bf16 v[58:61], v[42:45], v[26:29], v[58:61]
    v_mfma_f32_16x16x32_bf16 v[62:65], v[46:49], v[22:25], v[62:65]
    v_mfma_f32_16x16x32_bf16 v[66:69], v[46:49], v[26:29], v[66:69]
    v_mfma_f32_16x16x32_bf16 v[70:73], v[50:53], v[22:25], v[70:73]
    v_mfma_f32_16x16x32_bf16 v[74:77], v[50:53], v[26:29], v[74:77]
    s_waitcnt lgkmcnt(0)
    ds_read_b64_tr_b16 v[42:43], v18 offset:4096
    ds_read_b64_tr_b16 v[44:45], v18 offset:4608
    ds_read_b64_tr_b16 v[46:47], v19 offset:4096
    ds_read_b64_tr_b16 v[48:49], v19 offset:4608
    ds_read_b64_tr_b16 v[50:51], v20
    ds_read_b64_tr_b16 v[52:53], v21
    v_mfma_f32_16x16x32_bf16 v[78:81], v[30:33], v[22:25], v[78:81]
    v_mfma_f32_16x16x32_bf16 v[82:85], v[30:33], v[26:29], v[82:85]
    v_mfma_f32_16x16x32_bf16 v[86:89], v[34:37], v[22:25], v[86:89]
    v_mfma_f32_16x16x32_bf16 v[90:93], v[34:37], v[26:29], v[90:93]
    v_mfma_f32_16x16x32_bf16 v[94:97], v[38:41], v[22:25], v[94:97]
    v_mfma_f32_16x16x32_bf16 v[98:101], v[38:41], v[26:29], v[98:101]
    s_waitcnt lgkmcnt(0)
    s_waitcnt vmcnt(20)
    s_barrier
    v_add_u32 v14, 17408, v14
    v_add_u32 v16, 17408, v16
    v_add_u32 v17, 17408, v17
    v_add_u32 v18, 17408, v18
    v_add_u32 v19, 17408, v19
    v_add_u32 v20, 17408, v20
    v_add_u32 v21, 17408, v21
    ds_read_b128 v[6:9], v14 offset:0
    ds_read_b128 v[10:13], v14 offset:1024
    ds_read_b64_tr_b16 v[30:31], v16 offset:0
    ds_read_b64_tr_b16 v[32:33], v16 offset:512
    ds_read_b64_tr_b16 v[34:35], v17 offset:0
    ds_read_b64_tr_b16 v[36:37], v17 offset:512
    ds_read_b64_tr_b16 v[38:39], v18 offset:0
    ds_read_b64_tr_b16 v[40:41], v18 offset:512
    v_mfma_f32_16x16x32_bf16 v[102:105], v[42:45], v[22:25], v[102:105]
    v_mfma_f32_16x16x32_bf16 v[106:109], v[42:45], v[26:29], v[106:109]
    v_mfma_f32_16x16x32_bf16 v[110:113], v[46:49], v[22:25], v[110:113]
    v_mfma_f32_16x16x32_bf16 v[114:117], v[46:49], v[26:29], v[114:117]
    v_mfma_f32_16x16x32_bf16 v[118:121], v[50:53], v[22:25], v[118:121]
    v_mfma_f32_16x16x32_bf16 v[122:125], v[50:53], v[26:29], v[122:125]
    s_waitcnt lgkmcnt(0)
    ds_read_b64_tr_b16 v[42:43], v19 offset:0
    ds_read_b64_tr_b16 v[44:45], v19 offset:512
    ds_read_b64_tr_b16 v[46:47], v16 offset:4096
    ds_read_b64_tr_b16 v[48:49], v16 offset:4608
    ds_read_b64_tr_b16 v[50:51], v17 offset:4096
    ds_read_b64_tr_b16 v[52:53], v17 offset:4608
    s_add_u32 m0, s25, 17408
    s_nop 0
    buffer_load_dwordx4 v2, s[8:11], s26 offen lds
    s_add_u32 m0, s25, 21504
    s_nop 0
    buffer_load_dwordx4 v3, s[8:11], s26 offen lds
    s_add_u32 m0, s38, 17408
    s_add_u32 s28, s27, 128
    buffer_load_dwordx4 v4, s[12:15], s27 offen lds
    s_add_u32 m0, s38, 21504
    s_nop 0
    buffer_load_dwordx4 v4, s[12:15], s28 offen lds
    s_add_u32 m0, s39, 17408
    s_mov_b64 exec, 0xffff
    buffer_load_dwordx4 v5, s[12:15], s27 offen lds
    s_mov_b64 exec, -1
    s_add_u32 s26, s26, 64
    s_add_u32 s27, s27, 110592
    v_mfma_f32_16x16x32_bf16 v[54:57], v[30:33], v[6:9], v[54:57]
    v_mfma_f32_16x16x32_bf16 v[58:61], v[30:33], v[10:13], v[58:61]
    v_mfma_f32_16x16x32_bf16 v[62:65], v[34:37], v[6:9], v[62:65]
    v_mfma_f32_16x16x32_bf16 v[66:69], v[34:37], v[10:13], v[66:69]
    v_mfma_f32_16x16x32_bf16 v[70:73], v[38:41], v[6:9], v[70:73]
    v_mfma_f32_16x16x32_bf16 v[74:77], v[38:41], v[10:13], v[74:77]
    s_waitcnt lgkmcnt(0)
    ds_read_b64_tr_b16 v[30:31], v18 offset:4096
    ds_read_b64_tr_b16 v[32:33], v18 offset:4608
    ds_read_b64_tr_b16 v[34:35], v19 offset:4096
    ds_read_b64_tr_b16 v[36:37], v19 offset:4608
    ds_read_b64_tr_b16 v[38:39], v20
    ds_read_b64_tr_b16 v[40:41], v21
    v_mfma_f32_16x16x32_bf16 v[78:81], v[42:45], v[6:9], v[78:81]
    v_mfma_f32_16x16x32_bf16 v[82:85], v[42:45], v[10:13], v[82:85]
    v_mfma_f32_16x16x32_bf16 v[86:89], v[46:49], v[6:9], v[86:89]
    v_mfma_f32_16x16x32_bf16 v[90:93], v[46:49], v[10:13], v[90:93]
    v_mfma_f32_16x16x32_bf16 v[94:97], v[50:53], v[6:9], v[94:97]
    v_mfma_f32_16x16x32_bf16 v[98:101], v[50:53], v[10:13], v[98:101]
    s_waitcnt lgkmcnt(0)
    s_waitcnt vmcnt(20)
    s_barrier
    v_add_u32 v14, 17408, v14
    v_add_u32 v16, 17408, v16
    v_add_u32 v17, 17408, v17
    v_add_u32 v18, 17408, v18
    v_add_u32 v19, 17408, v19
    v_add_u32 v20, 17408, v20
    v_add_u32 v21, 17408, v21
    ds_read_b128 v[22:25], v14 offset:0
    ds_read_b128 v[26:29], v14 offset:1024
    ds_read_b64_tr_b16 v[42:43], v16 offset:0
    ds_read_b64_tr_b16 v[44:45], v16 offset:512
    ds_read_b64_tr_b16 v[46:47], v17 offset:0
    ds_read_b64_tr_b16 v[48:49], v17 offset:512
    ds_read_b64_tr_b16 v[50:51], v18 offset:0
    ds_read_b64_tr_b16 v[52:53], v18 offset:512
    v_mfma_f32_16x16x32_bf16 v[102:105], v[30:33], v[6:9], v[102:105]
    v_mfma_f32_16x16x32_bf16 v[106:109], v[30:33], v[10:13], v[106:109]
    v_mfma_f32_16x16x32_bf16 v[110:113], v[34:37], v[6:9], v[110:113]
    v_mfma_f32_16x16x32_bf16 v[114:117], v[34:37], v[10:13], v[114:117]
    v_mfma_f32_16x16x32_bf16 v[118:121], v[38:41], v[6:9], v[118:121]
    v_mfma_f32_16x16x32_bf16 v[122:125], v[38:41], v[10:13], v[122:125]
    s_waitcnt lgkmcnt(0)
    ds_read_b64_tr_b16 v[30:31], v19 offset:0
    ds_read_b64_tr_b16 v[32:33], v19 offset:512
    ds_read_b64_tr_b16 v[34:35], v16 offset:4096
    ds_read_b64_tr_b16 v[36:37], v16 offset:4608
    ds_read_b64_tr_b16 v[38:39], v17 offset:4096
    ds_read_b64_tr_b16 v[40:41], v17 offset:4608
    s_add_u32 m0, s25, 34816
    s_nop 0
    buffer_load_dwordx4 v2, s[8:11], s26 offen lds
    s_add_u32 m0, s25, 38912
    s_nop 0
    buffer_load_dwordx4 v3, s[8:11], s26 offen lds
    s_add_u32 m0, s38, 34816
    s_add_u32 s28, s27, 128
    buffer_load_dwordx4 v4, s[12:15], s27 offen lds
    s_add_u32 m0, s38, 38912
    s_nop 0
    buffer_load_dwordx4 v4, s[12:15], s28 offen lds
    s_add_u32 m0, s39, 34816
    s_mov_b64 exec, 0xffff
    buffer_load_dwordx4 v5, s[12:15], s27 offen lds
    s_mov_b64 exec, -1
    s_add_u32 s26, s26, 64
    s_add_u32 s27, s27, 110592
    v_mfma_f32_16x16x32_bf16 v[54:57], v[42:45], v[22:25], v[54:57]
    v_mfma_f32_16x16x32_bf16 v[58:61], v[42:45], v[26:29], v[58:61]
    v_mfma_f32_16x16x32_bf16 v[62:65], v[46:49], v[22:25], v[62:65]
    v_mfma_f32_16x16x32_bf16 v[66:69], v[46:49], v[26:29], v[66:69]
    v_mfma_f32_16x16x32_bf16 v[70:73], v[50:53], v[22:25], v[70:73]
    v_mfma_f32_16x16x32_bf16 v[74:77], v[50:53], v[26:29], v[74:77]
    s_waitcnt lgkmcnt(0)
    ds_read_b64_tr_b16 v[42:43], v18 offset:4096
    ds_read_b64_tr_b16 v[44:45], v18 offset:4608
    ds_read_b64_tr_b16 v[46:47], v19 offset:4096
    ds_read_b64_tr_b16 v[48:49], v19 offset:4608
    ds_read_b64_tr_b16 v[50:51], v20
    ds_read_b64_tr_b16 v[52:53], v21
    v_mfma_f32_16x16x32_bf16 v[78:81], v[30:33], v[22:25], v[78:81]
    v_mfma_f32_16x16x32_bf16 v[82:85], v[30:33], v[26:29], v[82:85]
    v_mfma_f32_16x16x32_bf16 v[86:89], v[34:37], v[22:25], v[86:89]
    v_mfma_f32_16x16x32_bf16 v[90:93], v[34:37], v[26:29], v[90:93]
    v_mfma_f32_16x16x32_bf16 v[94:97], v[38:41], v[22:25], v[94:97]
    v_mfma_f32_16x16x32_bf16 v[98:101], v[38:41], v[26:29], v[98:101]
    s_waitcnt lgkmcnt(0)
    s_waitcnt vmcnt(20)
    s_barrier
    v_add_u32 v14, 17408, v14
    v_add_u32 v16, 17408, v16
    v_add_u32 v17, 17408, v17
    v_add_u32 v18, 17408, v18
    v_add_u32 v19, 17408, v19
    v_add_u32 v20, 17408, v20
    v_add_u32 v21, 17408, v21
    ds_read_b128 v[6:9], v14 offset:0
    ds_read_b128 v[10:13], v14 offset:1024
    ds_read_b64_tr_b16 v[30:31], v16 offset:0
    ds_read_b64_tr_b16 v[32:33], v16 offset:512
    ds_read_b64_tr_b16 v[34:35], v17 offset:0
    ds_read_b64_tr_b16 v[36:37], v17 offset:512
    ds_read_b64_tr_b16 v[38:39], v18 offset:0
    ds_read_b64_tr_b16 v[40:41], v18 offset:512
    v_mfma_f32_16x16x32_bf16 v[102:105], v[42:45], v[22:25], v[102:105]
    v_mfma_f32_16x16x32_bf16 v[106:109], v[42:45], v[26:29], v[106:109]
    v_mfma_f32_16x16x32_bf16 v[110:113], v[46:49], v[22:25], v[110:113]
    v_mfma_f32_16x16x32_bf16 v[114:117], v[46:49], v[26:29], v[114:117]
    v_mfma_f32_16x16x32_bf16 v[118:121], v[50:53], v[22:25], v[118:121]
    v_mfma_f32_16x16x32_bf16 v[122:125], v[50:53], v[26:29], v[122:125]
    s_waitcnt lgkmcnt(0)
    ds_read_b64_tr_b16 v[42:43], v19 offset:0
    ds_read_b64_tr_b16 v[44:45], v19 offset:512
    ds_read_b64_tr_b16 v[46:47], v16 offset:4096
    ds_read_b64_tr_b16 v[48:49], v16 offset:4608
    ds_read_b64_tr_b16 v[50:51], v17 offset:4096
    ds_read_b64_tr_b16 v[52:53], v17 offset:4608
    s_add_u32 m0, s25, 52224
    s_nop 0
    buffer_load_dwordx4 v2, s[8:11], s26 offen lds
    s_add_u32 m0, s25, 56320
    s_nop 0
    buffer_load_dwordx4 v3, s[8:11], s26 offen lds
    s_add_u32 m0, s38, 52224
    s_add_u32 s28, s27, 128
    buffer_load_dwordx4 v4, s[12:15], s27 offen lds
    s_add_u32 m0, s38, 56320
    s_nop 0
    buffer_load_dwordx4 v4, s[12:15], s28 offen lds
    s_add_u32 m0, s39, 52224
    s_mov_b64 exec, 0xffff
    buffer_load_dwordx4 v5, s[12:15], s27 offen lds
    s_mov_b64 exec, -1
    s_add_u32 s26, s26, 64
    s_add_u32 s27, s27, 110592
    v_mfma_f32_16x16x32_bf16 v[54:57], v[30:33], v[6:9], v[54:57]
    v_mfma_f32_16x16x32_bf16 v[58:61], v[30:33], v[10:13], v[58:61]
    v_mfma_f32_16x16x32_bf16 v[62:65], v[34:37], v[6:9], v[62:65]
    v_mfma_f32_16x16x32_bf16 v[66:69], v[34:37], v[10:13], v[66:69]
    v_mfma_f32_16x16x32_bf16 v[70:73], v[38:41], v[6:9], v[70:73]
    v_mfma_f32_16x16x32_bf16 v[74:77], v[38:41], v[10:13], v[74:77]
    s_waitcnt lgkmcnt(0)
    ds_read_b64_tr_b16 v[30:31], v18 offset:4096
    ds_read_b64_tr_b16 v[32:33], v18 offset:4608
    ds_read_b64_tr_b16 v[34:35], v19 offset:4096
    ds_read_b64_tr_b16 v[36:37], v19 offset:4608
    ds_read_b64_tr_b16 v[38:39], v20
    ds_read_b64_tr_b16 v[40:41], v21
    v_mfma_f32_16x16x32_bf16 v[78:81], v[42:45], v[6:9], v[78:81]
    v_mfma_f32_16x16x32_bf16 v[82:85], v[42:45], v[10:13], v[82:85]
    v_mfma_f32_16x16x32_bf16 v[86:89], v[46:49], v[6:9], v[86:89]
    v_mfma_f32_16x16x32_bf16 v[90:93], v[46:49], v[10:13], v[90:93]
    v_mfma_f32_16x16x32_bf16 v[94:97], v[50:53], v[6:9], v[94:97]
    v_mfma_f32_16x16x32_bf16 v[98:101], v[50:53], v[10:13], v[98:101]
    s_waitcnt lgkmcnt(0)
    s_waitcnt vmcnt(20)
    s_barrier
    v_add_u32 v14, 17408, v14
    v_add_u32 v16, 17408, v16
    v_add_u32 v17, 17408, v17
    v_add_u32 v18, 17408, v18
    v_add_u32 v19, 17408, v19
    v_add_u32 v20, 17408, v20
    v_add_u32 v21, 17408, v21
    ds_read_b128 v[22:25], v14 offset:0
    ds_read_b128 v[26:29], v14 offset:1024
    ds_read_b64_tr_b16 v[42:43], v16 offset:0
    ds_read_b64_tr_b16 v[44:45], v16 offset:512
    ds_read_b64_tr_b16 v[46:47], v17 offset:0
    ds_read_b64_tr_b16 v[48:49], v17 offset:512
    ds_read_b64_tr_b16 v[50:51], v18 offset:0
    ds_read_b64_tr_b16 v[52:53], v18 offset:512
    v_mfma_f32_16x16x32_bf16 v[102:105], v[30:33], v[6:9], v[102:105]
    v_mfma_f32_16x16x32_bf16 v[106:109], v[30:33], v[10:13], v[106:109]
    v_mfma_f32_16x16x32_bf16 v[110:113], v[34:37], v[6:9], v[110:113]
    v_mfma_f32_16x16x32_bf16 v[114:117], v[34:37], v[10:13], v[114:117]
    v_mfma_f32_16x16x32_bf16 v[118:121], v[38:41], v[6:9], v[118:121]
    v_mfma_f32_16x16x32_bf16 v[122:125], v[38:41], v[10:13], v[122:125]
    s_waitcnt lgkmcnt(0)
    ds_read_b64_tr_b16 v[30:31], v19 offset:0
    ds_read_b64_tr_b16 v[32:33], v19 offset:512
    ds_read_b64_tr_b16 v[34:35], v16 offset:4096
    ds_read_b64_tr_b16 v[36:37], v16 offset:4608
    ds_read_b64_tr_b16 v[38:39], v17 offset:4096
    ds_read_b64_tr_b16 v[40:41], v17 offset:4608
    s_add_u32 m0, s25, 69632
    s_nop 0
    buffer_load_dwordx4 v2, s[8:11], s26 offen lds
    s_add_u32 m0, s25, 73728
    s_nop 0
    buffer_load_dwordx4 v3, s[8:11], s26 offen lds
    s_add_u32 m0, s38, 69632
    s_add_u32 s28, s27, 128
    buffer_load_dwordx4 v4, s[12:15], s27 offen lds
    s_add_u32 m0, s38, 73728
    s_nop 0
    buffer_load_dwordx4 v4, s[12:15], s28 offen lds
    s_add_u32 m0, s39, 69632
    s_mov_b64 exec, 0xffff
    buffer_load_dwordx4 v5, s[12:15], s27 offen lds
    s_mov_b64 exec, -1
    s_add_u32 s26, s26, 64
    s_add_u32 s27, s27, 110592
    v_mfma_f32_16x16x32_bf16 v[54:57], v[42:45], v[22:25], v[54:57]
    v_mfma_f32_16x16x32_bf16 v[58:61], v[42:45], v[26:29], v[58:61]
    v_mfma_f32_16x16x32_bf16 v[62:65], v[46:49], v[22:25], v[62:65]
    v_mfma_f32_16x16x32_bf16 v[66:69], v[46:49], v[26:29], v[66:69]
    v_mfma_f32_16x16x32_bf16 v[70:73], v[50:53], v[22:25], v[70:73]
    v_mfma_f32_16x16x32_bf16 v[74:77], v[50:53], v[26:29], v[74:77]
    s_waitcnt lgkmcnt(0)
    ds_read_b64_tr_b16 v[42:43], v18 offset:4096
    ds_read_b64_tr_b16 v[44:45], v18 offset:4608
    ds_read_b64_tr_b16 v[46:47], v19 offset:4096
    ds_read_b64_tr_b16 v[48:49], v19 offset:4608
    ds_read_b64_tr_b16 v[50:51], v20
    ds_read_b64_tr_b16 v[52:53], v21
    v_mfma_f32_16x16x32_bf16 v[78:81], v[30:33], v[22:25], v[78:81]
    v_mfma_f32_16x16x32_bf16 v[82:85], v[30:33], v[26:29], v[82:85]
    v_mfma_f32_16x16x32_bf16 v[86:89], v[34:37], v[22:25], v[86:89]
    v_mfma_f32_16x16x32_bf16 v[90:93], v[34:37], v[26:29], v[90:93]
    v_mfma_f32_16x16x32_bf16 v[94:97], v[38:41], v[22:25], v[94:97]
    v_mfma_f32_16x16x32_bf16 v[98:101], v[38:41], v[26:29], v[98:101]
    s_waitcnt lgkmcnt(0)
    s_waitcnt vmcnt(20)
    s_barrier
    v_subrev_u32 v14, 87040, v14
    v_subrev_u32 v16, 87040, v16
    v_subrev_u32 v17, 87040, v17
    v_subrev_u32 v18, 87040, v18
    v_subrev_u32 v19, 87040, v19
    v_subrev_u32 v20, 87040, v20
    v_subrev_u32 v21, 87040, v21
    ds_read_b128 v[6:9], v14 offset:0
    ds_read_b128 v[10:13], v14 offset:1024
    ds_read_b64_tr_b16 v[30:31], v16 offset:0
    ds_read_b64_tr_b16 v[32:33], v16 offset:512
    ds_read_b64_tr_b16 v[34:35], v17 offset:0
    ds_read_b64_tr_b16 v[36:37], v17 offset:512
    ds_read_b64_tr_b16 v[38:39], v18 offset:0
    ds_read_b64_tr_b16 v[40:41], v18 offset:512
    v_mfma_f32_16x16x32_bf16 v[102:105], v[42:45], v[22:25], v[102:105]
    v_mfma_f32_16x16x32_bf16 v[106:109], v[42:45], v[26:29], v[106:109]
    v_mfma_f32_16x16x32_bf16 v[110:113], v[46:49], v[22:25], v[110:113]
    v_mfma_f32_16x16x32_bf16 v[114:117], v[46:49], v[26:29], v[114:117]
    v_mfma_f32_16x16x32_bf16 v[118:121], v[50:53], v[22:25], v[118:121]
    v_mfma_f32_16x16x32_bf16 v[122:125], v[50:53], v[26:29], v[122:125]
    s_waitcnt lgkmcnt(0)
    ds_read_b64_tr_b16 v[42:43], v19 offset:0
    ds_read_b64_tr_b16 v[44:45], v19 offset:512
    ds_read_b64_tr_b16 v[46:47], v16 offset:4096
    ds_read_b64_tr_b16 v[48:49], v16 offset:4608
    ds_read_b64_tr_b16 v[50:51], v17 offset:4096
    ds_read_b64_tr_b16 v[52:53], v17 offset:4608
    s_add_u32 m0, s25, 87040
    s_nop 0
    buffer_load_dwordx4 v2, s[8:11], s26 offen lds
    s_add_u32 m0, s25, 91136
    s_nop 0
    buffer_load_dwordx4 v3, s[8:11], s26 offen lds
    s_add_u32 m0, s38, 87040
    s_add_u32 s28, s27, 128
    buffer_load_dwordx4 v4, s[12:15], s27 offen lds
    s_add_u32 m0, s38, 91136
    s_nop 0
    buffer_load_dwordx4 v4, s[12:15], s28 offen lds
    s_add_u32 m0, s39, 87040
    s_mov_b64 exec, 0xffff
    buffer_load_dwordx4 v5, s[12:15], s27 offen lds
    s_mov_b64 exec, -1
    s_add_u32 s26, s26, 64
    s_add_u32 s27, s27, 110592
    v_mfma_f32_16x16x32_bf16 v[54:57], v[30:33], v[6:9], v[54:57]
    v_mfma_f32_16x16x32_bf16 v[58:61], v[30:33], v[10:13], v[58:61]
    v_mfma_f32_16x16x32_bf16 v[62:65], v[34:37], v[6:9], v[62:65]
    v_mfma_f32_16x16x32_bf16 v[66:69], v[34:37], v[10:13], v[66:69]
    v_mfma_f32_16x16x32_bf16 v[70:73], v[38:41], v[6:9], v[70:73]
    v_mfma_f32_16x16x32_bf16 v[74:77], v[38:41], v[10:13], v[74:77]
    s_waitcnt lgkmcnt(0)
    ds_read_b64_tr_b16 v[30:31], v18 offset:4096
    ds_read_b64_tr_b16 v[32:33], v18 offset:4608
    ds_read_b64_tr_b16 v[34:35], v19 offset:4096
    ds_read_b64_tr_b16 v[36:37], v19 offset:4608
    ds_read_b64_tr_b16 v[38:39], v20
    ds_read_b64_tr_b16 v[40:41], v21
    v_mfma_f32_16x16x32_bf16 v[78:81], v[42:45], v[6:9], v[78:81]
    v_mfma_f32_16x16x32_bf16 v[82:85], v[42:45], v[10:13], v[82:85]
    v_mfma_f32_16x16x32_bf16 v[86:89], v[46:49], v[6:9], v[86:89]
    v_mfma_f32_16x16x32_bf16 v[90:93], v[46:49], v[10:13], v[90:93]
    v_mfma_f32_16x16x32_bf16 v[94:97], v[50:53], v[6:9], v[94:97]
    v_mfma_f32_16x16x32_bf16 v[98:101], v[50:53], v[10:13], v[98:101]
    s_waitcnt lgkmcnt(0)
    s_waitcnt vmcnt(20)
    s_barrier
    v_add_u32 v14, 17408, v14
    v_add_u32 v16, 17408, v16
    v_add_u32 v17, 17408, v17
    v_add_u32 v18, 17408, v18
    v_add_u32 v19, 17408, v19
    v_add_u32 v20, 17408, v20
    v_add_u32 v21, 17408, v21
    ds_read_b128 v[22:25], v14 offset:0
    ds_read_b128 v[26:29], v14 offset:1024
    ds_read_b64_tr_b16 v[42:43], v16 offset:0
    ds_read_b64_tr_b16 v[44:45], v16 offset:512
    ds_read_b64_tr_b16 v[46:47], v17 offset:0
    ds_read_b64_tr_b16 v[48:49], v17 offset:512
    ds_read_b64_tr_b16 v[50:51], v18 offset:0
    ds_read_b64_tr_b16 v[52:53], v18 offset:512
    v_mfma_f32_16x16x32_bf16 v[102:105], v[30:33], v[6:9], v[102:105]
    v_mfma_f32_16x16x32_bf16 v[106:109], v[30:33], v[10:13], v[106:109]
    v_mfma_f32_16x16x32_bf16 v[110:113], v[34:37], v[6:9], v[110:113]
    v_mfma_f32_16x16x32_bf16 v[114:117], v[34:37], v[10:13], v[114:117]
    v_mfma_f32_16x16x32_bf16 v[118:121], v[38:41], v[6:9], v[118:121]
    v_mfma_f32_16x16x32_bf16 v[122:125], v[38:41], v[10:13], v[122:125]
    s_mov_b32 s37, 0
qkvqk_loop:
    s_waitcnt lgkmcnt(0)
    ds_read_b64_tr_b16 v[30:31], v19 offset:0
    ds_read_b64_tr_b16 v[32:33], v19 offset:512
    ds_read_b64_tr_b16 v[34:35], v16 offset:4096
    ds_read_b64_tr_b16 v[36:37], v16 offset:4608
    ds_read_b64_tr_b16 v[38:39], v17 offset:4096
    ds_read_b64_tr_b16 v[40:41], v17 offset:4608
    s_add_u32 m0, s25, 0
    s_nop 0
    buffer_load_dwordx4 v2, s[8:11], s26 offen lds
    s_add_u32 m0, s25, 4096
    s_nop 0
    buffer_load_dwordx4 v3, s[8:11], s26 offen lds
    s_add_u32 m0, s38, 0
    s_add_u32 s28, s27, 128
    buffer_load_dwordx4 v4, s[12:15], s27 offen lds
    s_add_u32 m0, s38, 4096
    s_nop 0
    buffer_load_dwordx4 v4, s[12:15], s28 offen lds
    s_add_u32 m0, s39, 0
    s_mov_b64 exec, 0xffff
    buffer_load_dwordx4 v5, s[12:15], s27 offen lds
    s_mov_b64 exec, -1
    s_add_u32 s26, s26, 64
    s_add_u32 s27, s27, 110592
    v_mfma_f32_16x16x32_bf16 v[54:57], v[42:45], v[22:25], v[54:57]
    v_mfma_f32_16x16x32_bf16 v[58:61], v[42:45], v[26:29], v[58:61]
    v_mfma_f32_16x16x32_bf16 v[62:65], v[46:49], v[22:25], v[62:65]
    v_mfma_f32_16x16x32_bf16 v[66:69], v[46:49], v[26:29], v[66:69]
    v_mfma_f32_16x16x32_bf16 v[70:73], v[50:53], v[22:25], v[70:73]
    v_mfma_f32_16x16x32_bf16 v[74:77], v[50:53], v[26:29], v[74:77]
    s_waitcnt lgkmcnt(0)
    ds_read_b64_tr_b16 v[42:43], v18 offset:4096
    ds_read_b64_tr_b16 v[44:45], v18 offset:4608
    ds_read_b64_tr_b16 v[46:47], v19 offset:4096
    ds_read_b64_tr_b16 v[48:49], v19 offset:4608
    ds_read_b64_tr_b16 v[50:51], v20
    ds_read_b64_tr_b16 v[52:53], v21
    v_mfma_f32_16x16x32_bf16 v[78:81], v[30:33], v[22:25], v[78:81]
    v_mfma_f32_16x16x32_bf16 v[82:85], v[30:33], v[26:29], v[82:85]
    v_mfma_f32_16x16x32_bf16 v[86:89], v[34:37], v[22:25], v[86:89]
    v_mfma_f32_16x16x32_bf16 v[90:93], v[34:37], v[26:29], v[90:93]
    v_mfma_f32_16x16x32_bf16 v[94:97], v[38:41], v[22:25], v[94:97]
    v_mfma_f32_16x16x32_bf16 v[98:101], v[38:41], v[26:29], v[98:101]
    s_waitcnt lgkmcnt(0)
    s_waitcnt vmcnt(20)
    s_barrier
    v_add_u32 v14, 17408, v14
    v_add_u32 v16, 17408, v16
    v_add_u32 v17, 17408, v17
    v_add_u32 v18, 17408, v18
    v_add_u32 v19, 17408, v19
    v_add_u32 v20, 17408, v20
    v_add_u32 v21, 17408, v21
    ds_read_b128 v[6:9], v14 offset:0
    ds_read_b128 v[10:13], v14 offset:1024
    ds_read_b64_tr_b16 v[30:31], v16 offset:0
    ds_read_b64_tr_b16 v[32:33], v16 offset:512
    ds_read_b64_tr_b16 v[34:35], v17 offset:0
    ds_read_b64_tr_b16 v[36:37], v17 offset:512
    ds_read_b64_tr_b16 v[38:39], v18 offset:0
    ds_read_b64_tr_b16 v[40:41], v18 offset:512
    v_mfma_f32_16x16x32_bf16 v[102:105], v[42:45], v[22:25], v[102:105]
    v_mfma_f32_16x16x32_bf16 v[106:109], v[42:45], v[26:29], v[106:109]
    v_mfma_f32_16x16x32_bf16 v[110:113], v[46:49], v[22:25], v[110:113]
    v_mfma_f32_16x16x32_bf16 v[114:117], v[46:49], v[26:29], v[114:117]
    v_mfma_f32_16x16x32_bf16 v[118:121], v[50:53], v[22:25], v[118:121]
    v_mfma_f32_16x16x32_bf16 v[122:125], v[50:53], v[26:29], v[122:125]
    s_waitcnt lgkmcnt(0)
    ds_read_b64_tr_b16 v[42:43], v19 offset:0
    ds_read_b64_tr_b16 v[44:45], v19 offset:512
    ds_read_b64_tr_b16 v[46:47], v16 offset:4096
    ds_read_b64_tr_b16 v[48:49], v16 offset:4608
    ds_read_b64_tr_b16 v[50:51], v17 offset:4096
    ds_read_b64_tr_b16 v[52:53], v17 offset:4608
    s_add_u32 m0, s25, 17408
    s_nop 0
    buffer_load_dwordx4 v2, s[8:11], s26 offen lds
    s_add_u32 m0, s25, 21504
    s_nop 0
    buffer_load_dwordx4 v3, s[8:11], s26 offen lds
    s_add_u32 m0, s38, 17408
    s_add_u32 s28, s27, 128
    buffer_load_dwordx4 v4, s[12:15], s27 offen lds
    s_add_u32 m0, s38, 21504
    s_nop 0
    buffer_load_dwordx4 v4, s[12:15], s28 offen lds
    s_add_u32 m0, s39, 17408
    s_mov_b64 exec, 0xffff
    buffer_load_dwordx4 v5, s[12:15], s27 offen lds
    s_mov_b64 exec, -1
    s_add_u32 s26, s26, 64
    s_add_u32 s27, s27, 110592
    v_mfma_f32_16x16x32_bf16 v[54:57], v[30:33], v[6:9], v[54:57]
    v_mfma_f32_16x16x32_bf16 v[58:61], v[30:33], v[10:13], v[58:61]
    v_mfma_f32_16x16x32_bf16 v[62:65], v[34:37], v[6:9], v[62:65]
    v_mfma_f32_16x16x32_bf16 v[66:69], v[34:37], v[10:13], v[66:69]
    v_mfma_f32_16x16x32_bf16 v[70:73], v[38:41], v[6:9], v[70:73]
    v_mfma_f32_16x16x32_bf16 v[74:77], v[38:41], v[10:13], v[74:77]
    s_waitcnt lgkmcnt(0)
    ds_read_b64_tr_b16 v[30:31], v18 offset:4096
    ds_read_b64_tr_b16 v[32:33], v18 offset:4608
    ds_read_b64_tr_b16 v[34:35], v19 offset:4096
    ds_read_b64_tr_b16 v[36:37], v19 offset:4608
    ds_read_b64_tr_b16 v[38:39], v20
    ds_read_b64_tr_b16 v[40:41], v21
    v_mfma_f32_16x16x32_bf16 v[78:81], v[42:45], v[6:9], v[78:81]
    v_mfma_f32_16x16x32_bf16 v[82:85], v[42:45], v[10:13], v[82:85]
    v_mfma_f32_16x16x32_bf16 v[86:89], v[46:49], v[6:9], v[86:89]
    v_mfma_f32_16x16x32_bf16 v[90:93], v[46:49], v[10:13], v[90:93]
    v_mfma_f32_16x16x32_bf16 v[94:97], v[50:53], v[6:9], v[94:97]
    v_mfma_f32_16x16x32_bf16 v[98:101], v[50:53], v[10:13], v[98:101]
    s_waitcnt lgkmcnt(0)
    s_waitcnt vmcnt(20)
    s_barrier
    v_add_u32 v14, 17408, v14
    v_add_u32 v16, 17408, v16
    v_add_u32 v17, 17408, v17
    v_add_u32 v18, 17408, v18
    v_add_u32 v19, 17408, v19
    v_add_u32 v20, 17408, v20
    v_add_u32 v21, 17408, v21
    ds_read_b128 v[22:25], v14 offset:0
    ds_read_b128 v[26:29], v14 offset:1024
    ds_read_b64_tr_b16 v[42:43], v16 offset:0
    ds_read_b64_tr_b16 v[44:45], v16 offset:512
    ds_read_b64_tr_b16 v[46:47], v17 offset:0
    ds_read_b64_tr_b16 v[48:49], v17 offset:512
    ds_read_b64_tr_b16 v[50:51], v18 offset:0
    ds_read_b64_tr_b16 v[52:53], v18 offset:512
    v_mfma_f32_16x16x32_bf16 v[102:105], v[30:33], v[6:9], v[102:105]
    v_mfma_f32_16x16x32_bf16 v[106:109], v[30:33], v[10:13], v[106:109]
    v_mfma_f32_16x16x32_bf16 v[110:113], v[34:37], v[6:9], v[110:113]
    v_mfma_f32_16x16x32_bf16 v[114:117], v[34:37], v[10:13], v[114:117]
    v_mfma_f32_16x16x32_bf16 v[118:121], v[38:41], v[6:9], v[118:121]
    v_mfma_f32_16x16x32_bf16 v[122:125], v[38:41], v[10:13], v[122:125]
    s_waitcnt lgkmcnt(0)
    ds_read_b64_tr_b16 v[30:31], v19 offset:0
    ds_read_b64_tr_b16 v[32:33], v19 offset:512
    ds_read_b64_tr_b16 v[34:35], v16 offset:4096
    ds_read_b64_tr_b16 v[36:37], v16 offset:4608
    ds_read_b64_tr_b16 v[38:39], v17 offset:4096
    ds_read_b64_tr_b16 v[40:41], v17 offset:4608
    s_add_u32 m0, s25, 34816
    s_nop 0
    buffer_load_dwordx4 v2, s[8:11], s26 offen lds
    s_add_u32 m0, s25, 38912
    s_nop 0
    buffer_load_dwordx4 v3, s[8:11], s26 offen lds
    s_add_u32 m0, s38, 34816
    s_add_u32 s28, s27, 128
    buffer_load_dwordx4 v4, s[12:15], s27 offen lds
    s_add_u32 m0, s38, 38912
    s_nop 0
    buffer_load_dwordx4 v4, s[12:15], s28 offen lds
    s_add_u32 m0, s39, 34816
    s_mov_b64 exec, 0xffff
    buffer_load_dwordx4 v5, s[12:15], s27 offen lds
    s_mov_b64 exec, -1
    s_add_u32 s26, s26, 64
    s_add_u32 s27, s27, 110592
    v_mfma_f32_16x16x32_bf16 v[54:57], v[42:45], v[22:25], v[54:57]
    v_mfma_f32_16x16x32_bf16 v[58:61], v[42:45], v[26:29], v[58:61]
    v_mfma_f32_16x16x32_bf16 v[62:65], v[46:49], v[22:25], v[62:65]
    v_mfma_f32_16x16x32_bf16 v[66:69], v[46:49], v[26:29], v[66:69]
    v_mfma_f32_16x16x32_bf16 v[70:73], v[50:53], v[22:25], v[70:73]
    v_mfma_f32_16x16x32_bf16 v[74:77], v[50:53], v[26:29], v[74:77]
    s_waitcnt lgkmcnt(0)
    ds_read_b64_tr_b16 v[42:43], v18 offset:4096
    ds_read_b64_tr_b16 v[44:45], v18 offset:4608
    ds_read_b64_tr_b16 v[46:47], v19 offset:4096
    ds_read_b64_tr_b16 v[48:49], v19 offset:4608
    ds_read_b64_tr_b16 v[50:51], v20
    ds_read_b64_tr_b16 v[52:53], v21
    v_mfma_f32_16x16x32_bf16 v[78:81], v[30:33], v[22:25], v[78:81]
    v_mfma_f32_16x16x32_bf16 v[82:85], v[30:33], v[26:29], v[82:85]
    v_mfma_f32_16x16x32_bf16 v[86:89], v[34:37], v[22:25], v[86:89]
    v_mfma_f32_16x16x32_bf16 v[90:93], v[34:37], v[26:29], v[90:93]
    v_mfma_f32_16x16x32_bf16 v[94:97], v[38:41], v[22:25], v[94:97]
    v_mfma_f32_16x16x32_bf16 v[98:101], v[38:41], v[26:29], v[98:101]
    s_waitcnt lgkmcnt(0)
    s_waitcnt vmcnt(20)
    s_barrier
    v_add_u32 v14, 17408, v14
    v_add_u32 v16, 17408, v16
    v_add_u32 v17, 17408, v17
    v_add_u32 v18, 17408, v18
    v_add_u32 v19, 17408, v19
    v_add_u32 v20, 17408, v20
    v_add_u32 v21, 17408, v21
    ds_read_b128 v[6:9], v14 offset:0
    ds_read_b128 v[10:13], v14 offset:1024
    ds_read_b64_tr_b16 v[30:31], v16 offset:0
    ds_read_b64_tr_b16 v[32:33], v16 offset:512
    ds_read_b64_tr_b16 v[34:35], v17 offset:0
    ds_read_b64_tr_b16 v[36:37], v17 offset:512
    ds_read_b64_tr_b16 v[38:39], v18 offset:0
    ds_read_b64_tr_b16 v[40:41], v18 offset:512
    v_mfma_f32_16x16x32_bf16 v[102:105], v[42:45], v[22:25], v[102:105]
    v_mfma_f32_16x16x32_bf16 v[106:109], v[42:45], v[26:29], v[106:109]
    v_mfma_f32_16x16x32_bf16 v[110:113], v[46:49], v[22:25], v[110:113]
    v_mfma_f32_16x16x32_bf16 v[114:117], v[46:49], v[26:29], v[114:117]
    v_mfma_f32_16x16x32_bf16 v[118:121], v[50:53], v[22:25], v[118:121]
    v_mfma_f32_16x16x32_bf16 v[122:125], v[50:53], v[26:29], v[122:125]
    s_waitcnt lgkmcnt(0)
    ds_read_b64_tr_b16 v[42:43], v19 offset:0
    ds_read_b64_tr_b16 v[44:45], v19 offset:512
    ds_read_b64_tr_b16 v[46:47], v16 offset:4096
    ds_read_b64_tr_b16 v[48:49], v16 offset:4608
    ds_read_b64_tr_b16 v[50:51], v17 offset:4096
    ds_read_b64_tr_b16 v[52:53], v17 offset:4608
    s_add_u32 m0, s25, 52224
    s_nop 0
    buffer_load_dwordx4 v2, s[8:11], s26 offen lds
    s_add_u32 m0, s25, 56320
    s_nop 0
    buffer_load_dwordx4 v3, s[8:11], s26 offen lds
    s_add_u32 m0, s38, 52224
    s_add_u32 s28, s27, 128
    buffer_load_dwordx4 v4, s[12:15], s27 offen lds
    s_add_u32 m0, s38, 56320
    s_nop 0
    buffer_load_dwordx4 v4, s[12:15], s28 offen lds
    s_add_u32 m0, s39, 52224
    s_mov_b64 exec, 0xffff
    buffer_load_dwordx4 v5, s[12:15], s27 offen lds
    s_mov_b64 exec, -1
    s_add_u32 s26, s26, 64
    s_add_u32 s27, s27, 110592
    v_mfma_f32_16x16x32_bf16 v[54:57], v[30:33], v[6:9], v[54:57]
    v_mfma_f32_16x16x32_bf16 v[58:61], v[30:33], v[10:13], v[58:61]
    v_mfma_f32_16x16x32_bf16 v[62:65], v[34:37], v[6:9], v[62:65]
    v_mfma_f32_16x16x32_bf16 v[66:69], v[34:37], v[10:13], v[66:69]
    v_mfma_f32_16x16x32_bf16 v[70:73], v[38:41], v[6:9], v[70:73]
    v_mfma_f32_16x16x32_bf16 v[74:77], v[38:41], v[10:13], v[74:77]
    s_waitcnt lgkmcnt(0)
    ds_read_b64_tr_b16 v[30:31], v18 offset:4096
    ds_read_b64_tr_b16 v[32:33], v18 offset:4608
    ds_read_b64_tr_b16 v[34:35], v19 offset:4096
    ds_read_b64_tr_b16 v[36:37], v19 offset:4608
    ds_read_b64_tr_b16 v[38:39], v20
    ds_read_b64_tr_b16 v[40:41], v21
    v_mfma_f32_16x16x32_bf16 v[78:81], v[42:45], v[6:9], v[78:81]
    v_mfma_f32_16x16x32_bf16 v[82:85], v[42:45], v[10:13], v[82:85]
    v_mfma_f32_16x16x32_bf16 v[86:89], v[46:49], v[6:9], v[86:89]
    v_mfma_f32_16x16x32_bf16 v[90:93], v[46:49], v[10:13], v[90:93]
    v_mfma_f32_16x16x32_bf16 v[94:97], v[50:53], v[6:9], v[94:97]
    v_mfma_f32_16x16x32_bf16 v[98:101], v[50:53], v[10:13], v[98:101]
    s_waitcnt lgkmcnt(0)
    s_waitcnt vmcnt(20)
    s_barrier
    v_add_u32 v14, 17408, v14
    v_add_u32 v16, 17408, v16
    v_add_u32 v17, 17408, v17
    v_add_u32 v18, 17408, v18
    v_add_u32 v19, 17408, v19
    v_add_u32 v20, 17408, v20
    v_add_u32 v21, 17408, v21
    ds_read_b128 v[22:25], v14 offset:0
    ds_read_b128 v[26:29], v14 offset:1024
    ds_read_b64_tr_b16 v[42:43], v16 offset:0
    ds_read_b64_tr_b16 v[44:45], v16 offset:512
    ds_read_b64_tr_b16 v[46:47], v17 offset:0
    ds_read_b64_tr_b16 v[48:49], v17 offset:512
    ds_read_b64_tr_b16 v[50:51], v18 offset:0
    ds_read_b64_tr_b16 v[52:53], v18 offset:512
    v_mfma_f32_16x16x32_bf16 v[102:105], v[30:33], v[6:9], v[102:105]
    v_mfma_f32_16x16x32_bf16 v[106:109], v[30:33], v[10:13], v[106:109]
    v_mfma_f32_16x16x32_bf16 v[110:113], v[34:37], v[6:9], v[110:113]
    v_mfma_f32_16x16x32_bf16 v[114:117], v[34:37], v[10:13], v[114:117]
    v_mfma_f32_16x16x32_bf16 v[118:121], v[38:41], v[6:9], v[118:121]
    v_mfma_f32_16x16x32_bf16 v[122:125], v[38:41], v[10:13], v[122:125]
    s_waitcnt lgkmcnt(0)
    ds_read_b64_tr_b16 v[30:31], v19 offset:0
    ds_read_b64_tr_b16 v[32:33], v19 offset:512
    ds_read_b64_tr_b16 v[34:35], v16 offset:4096
    ds_read_b64_tr_b16 v[36:37], v16 offset:4608
    ds_read_b64_tr_b16 v[38:39], v17 offset:4096
    ds_read_b64_tr_b16 v[40:41], v17 offset:4608
    s_add_u32 m0, s25, 69632
    s_nop 0
    buffer_load_dwordx4 v2, s[8:11], s26 offen lds
    s_add_u32 m0, s25, 73728
    s_nop 0
    buffer_load_dwordx4 v3, s[8:11], s26 offen lds
    s_add_u32 m0, s38, 69632
    s_add_u32 s28, s27, 128
    buffer_load_dwordx4 v4, s[12:15], s27 offen lds
    s_add_u32 m0, s38, 73728
    s_nop 0
    buffer_load_dwordx4 v4, s[12:15], s28 offen lds
    s_add_u32 m0, s39, 69632
    s_mov_b64 exec, 0xffff
    buffer_load_dwordx4 v5, s[12:15], s27 offen lds
    s_mov_b64 exec, -1
    s_add_u32 s26, s26, 64
    s_add_u32 s27, s27, 110592
    v_mfma_f32_16x16x32_bf16 v[54:57], v[42:45], v[22:25], v[54:57]
    v_mfma_f32_16x16x32_bf16 v[58:61], v[42:45], v[26:29], v[58:61]
    v_mfma_f32_16x16x32_bf16 v[62:65], v[46:49], v[22:25], v[62:65]
    v_mfma_f32_16x16x32_bf16 v[66:69], v[46:49], v[26:29], v[66:69]
    v_mfma_f32_16x16x32_bf16 v[70:73], v[50:53], v[22:25], v[70:73]
    v_mfma_f32_16x16x32_bf16 v[74:77], v[50:53], v[26:29], v[74:77]
    s_waitcnt lgkmcnt(0)
    ds_read_b64_tr_b16 v[42:43], v18 offset:4096
    ds_read_b64_tr_b16 v[44:45], v18 offset:4608
    ds_read_b64_tr_b16 v[46:47], v19 offset:4096
    ds_read_b64_tr_b16 v[48:49], v19 offset:4608
    ds_read_b64_tr_b16 v[50:51], v20
    ds_read_b64_tr_b16 v[52:53], v21
    v_mfma_f32_16x16x32_bf16 v[78:81], v[30:33], v[22:25], v[78:81]
    v_mfma_f32_16x16x32_bf16 v[82:85], v[30:33], v[26:29], v[82:85]
    v_mfma_f32_16x16x32_bf16 v[86:89], v[34:37], v[22:25], v[86:89]
    v_mfma_f32_16x16x32_bf16 v[90:93], v[34:37], v[26:29], v[90:93]
    v_mfma_f32_16x16x32_bf16 v[94:97], v[38:41], v[22:25], v[94:97]
    v_mfma_f32_16x16x32_bf16 v[98:101], v[38:41], v[26:29], v[98:101]
    s_waitcnt lgkmcnt(0)
    s_waitcnt vmcnt(20)
    s_barrier
    v_subrev_u32 v14, 87040, v14
    v_subrev_u32 v16, 87040, v16
    v_subrev_u32 v17, 87040, v17
    v_subrev_u32 v18, 87040, v18
    v_subrev_u32 v19, 87040, v19
    v_subrev_u32 v20, 87040, v20
    v_subrev_u32 v21, 87040, v21
    ds_read_b128 v[6:9], v14 offset:0
    ds_read_b128 v[10:13], v14 offset:1024
    ds_read_b64_tr_b16 v[30:31], v16 offset:0
    ds_read_b64_tr_b16 v[32:33], v16 offset:512
    ds_read_b64_tr_b16 v[34:35], v17 offset:0
    ds_read_b64_tr_b16 v[36:37], v17 offset:512
    ds_read_b64_tr_b16 v[38:39], v18 offset:0
    ds_read_b64_tr_b16 v[40:41], v18 offset:512
    v_mfma_f32_16x16x32_bf16 v[102:105], v[42:45], v[22:25], v[102:105]
    v_mfma_f32_16x16x32_bf16 v[106:109], v[42:45], v[26:29], v[106:109]
    v_mfma_f32_16x16x32_bf16 v[110:113], v[46:49], v[22:25], v[110:113]
    v_mfma_f32_16x16x32_bf16 v[114:117], v[46:49], v[26:29], v[114:117]
    v_mfma_f32_16x16x32_bf16 v[118:121], v[50:53], v[22:25], v[118:121]
    v_mfma_f32_16x16x32_bf16 v[122:125], v[50:53], v[26:29], v[122:125]
    s_waitcnt lgkmcnt(0)
    ds_read_b64_tr_b16 v[42:43], v19 offset:0
    ds_read_b64_tr_b16 v[44:45], v19 offset:512
    ds_read_b64_tr_b16 v[46:47], v16 offset:4096
    ds_read_b64_tr_b16 v[48:49], v16 offset:4608
    ds_read_b64_tr_b16 v[50:51], v17 offset:4096
    ds_read_b64_tr_b16 v[52:53], v17 offset:4608
    s_add_u32 m0, s25, 87040
    s_nop 0
    buffer_load_dwordx4 v2, s[8:11], s26 offen lds
    s_add_u32 m0, s25, 91136
    s_nop 0
    buffer_load_dwordx4 v3, s[8:11], s26 offen lds
    s_add_u32 m0, s38, 87040
    s_add_u32 s28, s27, 128
    buffer_load_dwordx4 v4, s[12:15], s27 offen lds
    s_add_u32 m0, s38, 91136
    s_nop 0
    buffer_load_dwordx4 v4, s[12:15], s28 offen lds
    s_add_u32 m0, s39, 87040
    s_mov_b64 exec, 0xffff
    buffer_load_dwordx4 v5, s[12:15], s27 offen lds
    s_mov_b64 exec, -1
    s_add_u32 s26, s26, 64
    s_add_u32 s27, s27, 110592
    v_mfma_f32_16x16x32_bf16 v[54:57], v[30:33], v[6:9], v[54:57]
    v_mfma_f32_16x16x32_bf16 v[58:61], v[30:33], v[10:13], v[58:61]
    v_mfma_f32_16x16x32_bf16 v[62:65], v[34:37], v[6:9], v[62:65]
    v_mfma_f32_16x16x32_bf16 v[66:69], v[34:37], v[10:13], v[66:69]
    v_mfma_f32_16x16x32_bf16 v[70:73], v[38:41], v[6:9], v[70:73]
    v_mfma_f32_16x16x32_bf16 v[74:77], v[38:41], v[10:13], v[74:77]
    s_waitcnt lgkmcnt(0)
    ds_read_b64_tr_b16 v[30:31], v18 offset:4096
    ds_read_b64_tr_b16 v[32:33], v18 offset:4608
    ds_read_b64_tr_b16 v[34:35], v19 offset:4096
    ds_read_b64_tr_b16 v[36:37], v19 offset:4608
    ds_read_b64_tr_b16 v[38:39], v20
    ds_read_b64_tr_b16 v[40:41], v21
    v_mfma_f32_16x16x32_bf16 v[78:81], v[42:45], v[6:9], v[78:81]
    v_mfma_f32_16x16x32_bf16 v[82:85], v[42:45], v[10:13], v[82:85]
    v_mfma_f32_16x16x32_bf16 v[86:89], v[46:49], v[6:9], v[86:89]
    v_mfma_f32_16x16x32_bf16 v[90:93], v[46:49], v[10:13], v[90:93]
    v_mfma_f32_16x16x32_bf16 v[94:97], v[50:53], v[6:9], v[94:97]
    v_mfma_f32_16x16x32_bf16 v[98:101], v[50:53], v[10:13], v[98:101]
    s_waitcnt lgkmcnt(0)
    s_waitcnt vmcnt(20)
    s_barrier
    v_add_u32 v14, 17408, v14
    v_add_u32 v16, 17408, v16
    v_add_u32 v17, 17408, v17
    v_add_u32 v18, 17408, v18
    v_add_u32 v19, 17408, v19
    v_add_u32 v20, 17408, v20
    v_add_u32 v21, 17408, v21
    ds_read_b128 v[22:25], v14 offset:0
    ds_read_b128 v[26:29], v14 offset:1024
    ds_read_b64_tr_b16 v[42:43], v16 offset:0
    ds_read_b64_tr_b16 v[44:45], v16 offset:512
    ds_read_b64_tr_b16 v[46:47], v17 offset:0
    ds_read_b64_tr_b16 v[48:49], v17 offset:512
    ds_read_b64_tr_b16 v[50:51], v18 offset:0
    ds_read_b64_tr_b16 v[52:53], v18 offset:512
    v_mfma_f32_16x16x32_bf16 v[102:105], v[30:33], v[6:9], v[102:105]
    v_mfma_f32_16x16x32_bf16 v[106:109], v[30:33], v[10:13], v[106:109]
    v_mfma_f32_16x16x32_bf16 v[110:113], v[34:37], v[6:9], v[110:113]
    v_mfma_f32_16x16x32_bf16 v[114:117], v[34:37], v[10:13], v[114:117]
    v_mfma_f32_16x16x32_bf16 v[118:121], v[38:41], v[6:9], v[118:121]
    v_mfma_f32_16x16x32_bf16 v[122:125], v[38:41], v[10:13], v[122:125]
    s_add_u32 s37, s37, 1
    s_cmp_lt_u32 s37, 1
    s_cbranch_scc1 qkvqk_loop
    s_waitcnt lgkmcnt(0)
    ds_read_b64_tr_b16 v[30:31], v19 offset:0
    ds_read_b64_tr_b16 v[32:33], v19 offset:512
    ds_read_b64_tr_b16 v[34:35], v16 offset:4096
    ds_read_b64_tr_b16 v[36:37], v16 offset:4608
    ds_read_b64_tr_b16 v[38:39], v17 offset:4096
    ds_read_b64_tr_b16 v[40:41], v17 offset:4608
    v_mfma_f32_16x16x32_bf16 v[54:57], v[42:45], v[22:25], v[54:57]
    v_mfma_f32_16x16x32_bf16 v[58:61], v[42:45], v[26:29], v[58:61]
    v_mfma_f32_16x16x32_bf16 v[62:65], v[46:49], v[22:25], v[62:65]
    v_mfma_f32_16x16x32_bf16 v[66:69], v[46:49], v[26:29], v[66:69]
    v_mfma_f32_16x16x32_bf16 v[70:73], v[50:53], v[22:25], v[70:73]
    v_mfma_f32_16x16x32_bf16 v[74:77], v[50:53], v[26:29], v[74:77]
    s_waitcnt lgkmcnt(0)
    ds_read_b64_tr_b16 v[42:43], v18 offset:4096
    ds_read_b64_tr_b16 v[44:45], v18 offset:4608
    ds_read_b64_tr_b16 v[46:47], v19 offset:4096
    ds_read_b64_tr_b16 v[48:49], v19 offset:4608
    ds_read_b64_tr_b16 v[50:51], v20
    ds_read_b64_tr_b16 v[52:53], v21
    v_mfma_f32_16x16x32_bf16 v[78:81], v[30:33], v[22:25], v[78:81]
    v_mfma_f32_16x16x32_bf16 v[82:85], v[30:33], v[26:29], v[82:85]
    v_mfma_f32_16x16x32_bf16 v[86:89], v[34:37], v[22:25], v[86:89]
    v_mfma_f32_16x16x32_bf16 v[90:93], v[34:37], v[26:29], v[90:93]
    v_mfma_f32_16x16x32_bf16 v[94:97], v[38:41], v[22:25], v[94:97]
    v_mfma_f32_16x16x32_bf16 v[98:101], v[38:41], v[26:29], v[98:101]
    s_waitcnt lgkmcnt(0)
    s_waitcnt vmcnt(15)
    s_barrier
    v_add_u32 v14, 17408, v14
    v_add_u32 v16, 17408, v16
    v_add_u32 v17, 17408, v17
    v_add_u32 v18, 17408, v18
    v_add_u32 v19, 17408, v19
    v_add_u32 v20, 17408, v20
    v_add_u32 v21, 17408, v21
    ds_read_b128 v[6:9], v14 offset:0
    ds_read_b128 v[10:13], v14 offset:1024
    ds_read_b64_tr_b16 v[30:31], v16 offset:0
    ds_read_b64_tr_b16 v[32:33], v16 offset:512
    ds_read_b64_tr_b16 v[34:35], v17 offset:0
    ds_read_b64_tr_b16 v[36:37], v17 offset:512
    ds_read_b64_tr_b16 v[38:39], v18 offset:0
    ds_read_b64_tr_b16 v[40:41], v18 offset:512
    v_mfma_f32_16x16x32_bf16 v[102:105], v[42:45], v[22:25], v[102:105]
    v_mfma_f32_16x16x32_bf16 v[106:109], v[42:45], v[26:29], v[106:109]
    v_mfma_f32_16x16x32_bf16 v[110:113], v[46:49], v[22:25], v[110:113]
    v_mfma_f32_16x16x32_bf16 v[114:117], v[46:49], v[26:29], v[114:117]
    v_mfma_f32_16x16x32_bf16 v[118:121], v[50:53], v[22:25], v[118:121]
    v_mfma_f32_16x16x32_bf16 v[122:125], v[50:53], v[26:29], v[122:125]
    s_waitcnt lgkmcnt(0)
    ds_read_b64_tr_b16 v[42:43], v19 offset:0
    ds_read_b64_tr_b16 v[44:45], v19 offset:512
    ds_read_b64_tr_b16 v[46:47], v16 offset:4096
    ds_read_b64_tr_b16 v[48:49], v16 offset:4608
    ds_read_b64_tr_b16 v[50:51], v17 offset:4096
    ds_read_b64_tr_b16 v[52:53], v17 offset:4608
    v_mfma_f32_16x16x32_bf16 v[54:57], v[30:33], v[6:9], v[54:57]
    v_mfma_f32_16x16x32_bf16 v[58:61], v[30:33], v[10:13], v[58:61]
    v_mfma_f32_16x16x32_bf16 v[62:65], v[34:37], v[6:9], v[62:65]
    v_mfma_f32_16x16x32_bf16 v[66:69], v[34:37], v[10:13], v[66:69]
    v_mfma_f32_16x16x32_bf16 v[70:73], v[38:41], v[6:9], v[70:73]
    v_mfma_f32_16x16x32_bf16 v[74:77], v[38:41], v[10:13], v[74:77]
    s_waitcnt lgkmcnt(0)
    ds_read_b64_tr_b16 v[30:31], v18 offset:4096
    ds_read_b64_tr_b16 v[32:33], v18 offset:4608
    ds_read_b64_tr_b16 v[34:35], v19 offset:4096
    ds_read_b64_tr_b16 v[36:37], v19 offset:4608
    ds_read_b64_tr_b16 v[38:39], v20
    ds_read_b64_tr_b16 v[40:41], v21
    v_mfma_f32_16x16x32_bf16 v[78:81], v[42:45], v[6:9], v[78:81]
    v_mfma_f32_16x16x32_bf16 v[82:85], v[42:45], v[10:13], v[82:85]
    v_mfma_f32_16x16x32_bf16 v[86:89], v[46:49], v[6:9], v[86:89]
    v_mfma_f32_16x16x32_bf16 v[90:93], v[46:49], v[10:13], v[90:93]
    v_mfma_f32_16x16x32_bf16 v[94:97], v[50:53], v[6:9], v[94:97]
    v_mfma_f32_16x16x32_bf16 v[98:101], v[50:53], v[10:13], v[98:101]
    s_waitcnt lgkmcnt(0)
    s_waitcnt vmcnt(10)
    s_barrier
    v_add_u32 v14, 17408, v14
    v_add_u32 v16, 17408, v16
    v_add_u32 v17, 17408, v17
    v_add_u32 v18, 17408, v18
    v_add_u32 v19, 17408, v19
    v_add_u32 v20, 17408, v20
    v_add_u32 v21, 17408, v21
    ds_read_b128 v[22:25], v14 offset:0
    ds_read_b128 v[26:29], v14 offset:1024
    ds_read_b64_tr_b16 v[42:43], v16 offset:0
    ds_read_b64_tr_b16 v[44:45], v16 offset:512
    ds_read_b64_tr_b16 v[46:47], v17 offset:0
    ds_read_b64_tr_b16 v[48:49], v17 offset:512
    ds_read_b64_tr_b16 v[50:51], v18 offset:0
    ds_read_b64_tr_b16 v[52:53], v18 offset:512
    v_mfma_f32_16x16x32_bf16 v[102:105], v[30:33], v[6:9], v[102:105]
    v_mfma_f32_16x16x32_bf16 v[106:109], v[30:33], v[10:13], v[106:109]
    v_mfma_f32_16x16x32_bf16 v[110:113], v[34:37], v[6:9], v[110:113]
    v_mfma_f32_16x16x32_bf16 v[114:117], v[34:37], v[10:13], v[114:117]
    v_mfma_f32_16x16x32_bf16 v[118:121], v[38:41], v[6:9], v[118:121]
    v_mfma_f32_16x16x32_bf16 v[122:125], v[38:41], v[10:13], v[122:125]
    s_waitcnt lgkmcnt(0)
    ds_read_b64_tr_b16 v[30:31], v19 offset:0
    ds_read_b64_tr_b16 v[32:33], v19 offset:512
    ds_read_b64_tr_b16 v[34:35], v16 offset:4096
    ds_read_b64_tr_b16 v[36:37], v16 offset:4608
    ds_read_b64_tr_b16 v[38:39], v17 offset:4096
    ds_read_b64_tr_b16 v[40:41], v17 offset:4608
    v_mfma_f32_16x16x32_bf16 v[54:57], v[42:45], v[22:25], v[54:57]
    v_mfma_f32_16x16x32_bf16 v[58:61], v[42:45], v[26:29], v[58:61]
    v_mfma_f32_16x16x32_bf16 v[62:65], v[46:49], v[22:25], v[62:65]
    v_mfma_f32_16x16x32_bf16 v[66:69], v[46:49], v[26:29], v[66:69]
    v_mfma_f32_16x16x32_bf16 v[70:73], v[50:53], v[22:25], v[70:73]
    v_mfma_f32_16x16x32_bf16 v[74:77], v[50:53], v[26:29], v[74:77]
    s_waitcnt lgkmcnt(0)
    ds_read_b64_tr_b16 v[42:43], v18 offset:4096
    ds_read_b64_tr_b16 v[44:45], v18 offset:4608
    ds_read_b64_tr_b16 v[46:47], v19 offset:4096
    ds_read_b64_tr_b16 v[48:49], v19 offset:4608
    ds_read_b64_tr_b16 v[50:51], v20
    ds_read_b64_tr_b16 v[52:53], v21
    v_mfma_f32_16x16x32_bf16 v[78:81], v[30:33], v[22:25], v[78:81]
    v_mfma_f32_16x16x32_bf16 v[82:85], v[30:33], v[26:29], v[82:85]
    v_mfma_f32_16x16x32_bf16 v[86:89], v[34:37], v[22:25], v[86:89]
    v_mfma_f32_16x16x32_bf16 v[90:93], v[34:37], v[26:29], v[90:93]
    v_mfma_f32_16x16x32_bf16 v[94:97], v[38:41], v[22:25], v[94:97]
    v_mfma_f32_16x16x32_bf16 v[98:101], v[38:41], v[26:29], v[98:101]
    s_waitcnt lgkmcnt(0)
    s_waitcnt vmcnt(5)
    s_barrier
    v_add_u32 v14, 17408, v14
    v_add_u32 v16, 17408, v16
    v_add_u32 v17, 17408, v17
    v_add_u32 v18, 17408, v18
    v_add_u32 v19, 17408, v19
    v_add_u32 v20, 17408, v20
    v_add_u32 v21, 17408, v21
    ds_read_b128 v[6:9], v14 offset:0
    ds_read_b128 v[10:13], v14 offset:1024
    ds_read_b64_tr_b16 v[30:31], v16 offset:0
    ds_read_b64_tr_b16 v[32:33], v16 offset:512
    ds_read_b64_tr_b16 v[34:35], v17 offset:0
    ds_read_b64_tr_b16 v[36:37], v17 offset:512
    ds_read_b64_tr_b16 v[38:39], v18 offset:0
    ds_read_b64_tr_b16 v[40:41], v18 offset:512
    v_mfma_f32_16x16x32_bf16 v[102:105], v[42:45], v[22:25], v[102:105]
    v_mfma_f32_16x16x32_bf16 v[106:109], v[42:45], v[26:29], v[106:109]
    v_mfma_f32_16x16x32_bf16 v[110:113], v[46:49], v[22:25], v[110:113]
    v_mfma_f32_16x16x32_bf16 v[114:117], v[46:49], v[26:29], v[114:117]
    v_mfma_f32_16x16x32_bf16 v[118:121], v[50:53], v[22:25], v[118:121]
    v_mfma_f32_16x16x32_bf16 v[122:125], v[50:53], v[26:29], v[122:125]
    s_waitcnt lgkmcnt(0)
    ds_read_b64_tr_b16 v[42:43], v19 offset:0
    ds_read_b64_tr_b16 v[44:45], v19 offset:512
    ds_read_b64_tr_b16 v[46:47], v16 offset:4096
    ds_read_b64_tr_b16 v[48:49], v16 offset:4608
    ds_read_b64_tr_b16 v[50:51], v17 offset:4096
    ds_read_b64_tr_b16 v[52:53], v17 offset:4608
    v_mfma_f32_16x16x32_bf16 v[54:57], v[30:33], v[6:9], v[54:57]
    v_mfma_f32_16x16x32_bf16 v[58:61], v[30:33], v[10:13], v[58:61]
    v_mfma_f32_16x16x32_bf16 v[62:65], v[34:37], v[6:9], v[62:65]
    v_mfma_f32_16x16x32_bf16 v[66:69], v[34:37], v[10:13], v[66:69]
    v_mfma_f32_16x16x32_bf16 v[70:73], v[38:41], v[6:9], v[70:73]
    v_mfma_f32_16x16x32_bf16 v[74:77], v[38:41], v[10:13], v[74:77]
    s_waitcnt lgkmcnt(0)
    ds_read_b64_tr_b16 v[30:31], v18 offset:4096
    ds_read_b64_tr_b16 v[32:33], v18 offset:4608
    ds_read_b64_tr_b16 v[34:35], v19 offset:4096
    ds_read_b64_tr_b16 v[36:37], v19 offset:4608
    ds_read_b64_tr_b16 v[38:39], v20
    ds_read_b64_tr_b16 v[40:41], v21
    v_mfma_f32_16x16x32_bf16 v[78:81], v[42:45], v[6:9], v[78:81]
    v_mfma_f32_16x16x32_bf16 v[82:85], v[42:45], v[10:13], v[82:85]
    v_mfma_f32_16x16x32_bf16 v[86:89], v[46:49], v[6:9], v[86:89]
    v_mfma_f32_16x16x32_bf16 v[90:93], v[46:49], v[10:13], v[90:93]
    v_mfma_f32_16x16x32_bf16 v[94:97], v[50:53], v[6:9], v[94:97]
    v_mfma_f32_16x16x32_bf16 v[98:101], v[50:53], v[10:13], v[98:101]
    s_waitcnt lgkmcnt(0)
    s_waitcnt vmcnt(0)
    s_barrier
    v_add_u32 v14, 17408, v14
    v_add_u32 v16, 17408, v16
    v_add_u32 v17, 17408, v17
    v_add_u32 v18, 17408, v18
    v_add_u32 v19, 17408, v19
    v_add_u32 v20, 17408, v20
    v_add_u32 v21, 17408, v21
    ds_read_b128 v[22:25], v14 offset:0
    ds_read_b128 v[26:29], v14 offset:1024
    ds_read_b64_tr_b16 v[42:43], v16 offset:0
    ds_read_b64_tr_b16 v[44:45], v16 offset:512
    ds_read_b64_tr_b16 v[46:47], v17 offset:0
    ds_read_b64_tr_b16 v[48:49], v17 offset:512
    ds_read_b64_tr_b16 v[50:51], v18 offset:0
    ds_read_b64_tr_b16 v[52:53], v18 offset:512
    v_mfma_f32_16x16x32_bf16 v[102:105], v[30:33], v[6:9], v[102:105]
    v_mfma_f32_16x16x32_bf16 v[106:109], v[30:33], v[10:13], v[106:109]
    v_mfma_f32_16x16x32_bf16 v[110:113], v[34:37], v[6:9], v[110:113]
    v_mfma_f32_16x16x32_bf16 v[114:117], v[34:37], v[10:13], v[114:117]
    v_mfma_f32_16x16x32_bf16 v[118:121], v[38:41], v[6:9], v[118:121]
    v_mfma_f32_16x16x32_bf16 v[122:125], v[38:41], v[10:13], v[122:125]
    s_waitcnt lgkmcnt(0)
    ds_read_b64_tr_b16 v[30:31], v19 offset:0
    ds_read_b64_tr_b16 v[32:33], v19 offset:512
    ds_read_b64_tr_b16 v[34:35], v16 offset:4096
    ds_read_b64_tr_b16 v[36:37], v16 offset:4608
    ds_read_b64_tr_b16 v[38:39], v17 offset:4096
    ds_read_b64_tr_b16 v[40:41], v17 offset:4608
    v_mfma_f32_16x16x32_bf16 v[54:57], v[42:45], v[22:25], v[54:57]
    v_mfma_f32_16x16x32_bf16 v[58:61], v[42:45], v[26:29], v[58:61]
    v_mfma_f32_16x16x32_bf16 v[62:65], v[46:49], v[22:25], v[62:65]
    v_mfma_f32_16x16x32_bf16 v[66:69], v[46:49], v[26:29], v[66:69]
    v_mfma_f32_16x16x32_bf16 v[70:73], v[50:53], v[22:25], v[70:73]
    v_mfma_f32_16x16x32_bf16 v[74:77], v[50:53], v[26:29], v[74:77]
    s_waitcnt lgkmcnt(0)
    ds_read_b64_tr_b16 v[42:43], v18 offset:4096
    ds_read_b64_tr_b16 v[44:45], v18 offset:4608
    ds_read_b64_tr_b16 v[46:47], v19 offset:4096
    ds_read_b64_tr_b16 v[48:49], v19 offset:4608
    ds_read_b64_tr_b16 v[50:51], v20
    ds_read_b64_tr_b16 v[52:53], v21
    v_mfma_f32_16x16x32_bf16 v[78:81], v[30:33], v[22:25], v[78:81]
    v_mfma_f32_16x16x32_bf16 v[82:85], v[30:33], v[26:29], v[82:85]
    v_mfma_f32_16x16x32_bf16 v[86:89], v[34:37], v[22:25], v[86:89]
    v_mfma_f32_16x16x32_bf16 v[90:93], v[34:37], v[26:29], v[90:93]
    v_mfma_f32_16x16x32_bf16 v[94:97], v[38:41], v[22:25], v[94:97]
    v_mfma_f32_16x16x32_bf16 v[98:101], v[38:41], v[26:29], v[98:101]
    s_waitcnt lgkmcnt(0)
    v_mfma_f32_16x16x32_bf16 v[102:105], v[42:45], v[22:25], v[102:105]
    v_mfma_f32_16x16x32_bf16 v[106:109], v[42:45], v[26:29], v[106:109]
    v_mfma_f32_16x16x32_bf16 v[110:113], v[46:49], v[22:25], v[110:113]
    v_mfma_f32_16x16x32_bf16 v[114:117], v[46:49], v[26:29], v[114:117]
    v_mfma_f32_16x16x32_bf16 v[118:121], v[50:53], v[22:25], v[118:121]
    v_mfma_f32_16x16x32_bf16 v[122:125], v[50:53], v[26:29], v[122:125]
    s_nop 15
    s_nop 7
    s_lshr_b32 s26, s31, 2
    s_and_b32 s27, s31, 3
    s_mul_i32 s27, s27, 144
    s_lshl_b32 s28, s29, 5
    s_lshl_b32 s33, s30, 7
    s_add_u32 s28, s28, s33
    s_mul_i32 s26, s26, 2359296
    s_mov_b32 s33, 0x3eae1a93
    s_mov_b32 s34, 1.0
    s_cmp_eq_u32 s26, 0
    s_cselect_b32 s33, s33, s34
    s_mov_b32 s34, 3641
    v_and_b32 v10, 15, v0
    v_add_u32 v10, s28, v10
    v_lshrrev_b32 v11, 4, v0
    v_lshlrev_b32 v11, 2, v11
    v_add_u32 v11, s27, v11
    v_add_u32 v12, 0, v11
    v_mul_lo_u32 v13, v12, s34
    v_lshrrev_b32 v13, 16, v13
    v_mul_u32_u24 v2, 18, v13
    v_sub_u32 v12, v12, v2
    v_lshrrev_b32 v2, 3, v12
    v_lshl_add_u32 v2, v13, 1, v2
    v_lshlrev_b32 v2, 15, v2
    v_and_b32 v3, 7, v12
    v_lshl_add_u32 v2, v3, 1, v2
    v_lshlrev_b32 v3, 13, v13
    v_add_u32 v3, 2097152, v3
    v_cmp_lt_u32 vcc, 15, v12
    v_mov_b32 v4, 4
    v_mov_b32 v5, 2
    v_cndmask_b32 v2, v2, v3, vcc
    v_cndmask_b32 v4, v4, v5, vcc
    v_mul_f32 v20, s33, v54
    v_mul_f32 v21, s33, v55
    v_cvt_pk_bf16_f32 v20, v20, v21
    v_add_u32 v22, 0, v10
    v_lshlrev_b32 v22, v4, v22
    v_add_u32 v22, v22, v2
    buffer_store_dword v20, v22, s[20:23], s26 offen
    v_mul_f32 v24, s33, v58
    v_mul_f32 v25, s33, v59
    v_cvt_pk_bf16_f32 v24, v24, v25
    v_add_u32 v26, 16, v10
    v_lshlrev_b32 v26, v4, v26
    v_add_u32 v26, v26, v2
    buffer_store_dword v24, v26, s[20:23], s26 offen
    v_add_u32 v12, 2, v11
    v_mul_lo_u32 v13, v12, s34
    v_lshrrev_b32 v13, 16, v13
    v_mul_u32_u24 v2, 18, v13
    v_sub_u32 v12, v12, v2
    v_lshrrev_b32 v2, 3, v12
    v_lshl_add_u32 v2, v13, 1, v2
    v_lshlrev_b32 v2, 15, v2
    v_and_b32 v3, 7, v12
    v_lshl_add_u32 v2, v3, 1, v2
    v_lshlrev_b32 v3, 13, v13
    v_add_u32 v3, 2097152, v3
    v_cmp_lt_u32 vcc, 15, v12
    v_mov_b32 v4, 4
    v_mov_b32 v5, 2
    v_cndmask_b32 v2, v2, v3, vcc
    v_cndmask_b32 v4, v4, v5, vcc
    v_mul_f32 v28, s33, v56
    v_mul_f32 v29, s33, v57
    v_cvt_pk_bf16_f32 v28, v28, v29
    v_add_u32 v30, 0, v10
    v_lshlrev_b32 v30, v4, v30
    v_add_u32 v30, v30, v2
    buffer_store_dword v28, v30, s[20:23], s26 offen
    v_mul_f32 v32, s33, v60
    v_mul_f32 v33, s33, v61
    v_cvt_pk_bf16_f32 v32, v32, v33
    v_add_u32 v34, 16, v10
    v_lshlrev_b32 v34, v4, v34
    v_add_u32 v34, v34, v2
    buffer_store_dword v32, v34, s[20:23], s26 offen
    v_add_u32 v12, 16, v11
    v_mul_lo_u32 v13, v12, s34
    v_lshrrev_b32 v13, 16, v13
    v_mul_u32_u24 v2, 18, v13
    v_sub_u32 v12, v12, v2
    v_lshrrev_b32 v2, 3, v12
    v_lshl_add_u32 v2, v13, 1, v2
    v_lshlrev_b32 v2, 15, v2
    v_and_b32 v3, 7, v12
    v_lshl_add_u32 v2, v3, 1, v2
    v_lshlrev_b32 v3, 13, v13
    v_add_u32 v3, 2097152, v3
    v_cmp_lt_u32 vcc, 15, v12
    v_mov_b32 v4, 4
    v_mov_b32 v5, 2
    v_cndmask_b32 v2, v2, v3, vcc
    v_cndmask_b32 v4, v4, v5, vcc
    v_mul_f32 v36, s33, v62
    v_mul_f32 v37, s33, v63
    v_cvt_pk_bf16_f32 v36, v36, v37
    v_add_u32 v38, 0, v10
    v_lshlrev_b32 v38, v4, v38
    v_add_u32 v38, v38, v2
    buffer_store_dword v36, v38, s[20:23], s26 offen
    v_mul_f32 v40, s33, v66
    v_mul_f32 v41, s33, v67
    v_cvt_pk_bf16_f32 v40, v40, v41
    v_add_u32 v42, 16, v10
    v_lshlrev_b32 v42, v4, v42
    v_add_u32 v42, v42, v2
    buffer_store_dword v40, v42, s[20:23], s26 offen
    v_add_u32 v12, 18, v11
    v_mul_lo_u32 v13, v12, s34
    v_lshrrev_b32 v13, 16, v13
    v_mul_u32_u24 v2, 18, v13
    v_sub_u32 v12, v12, v2
    v_lshrrev_b32 v2, 3, v12
    v_lshl_add_u32 v2, v13, 1, v2
    v_lshlrev_b32 v2, 15, v2
    v_and_b32 v3, 7, v12
    v_lshl_add_u32 v2, v3, 1, v2
    v_lshlrev_b32 v3, 13, v13
    v_add_u32 v3, 2097152, v3
    v_cmp_lt_u32 vcc, 15, v12
    v_mov_b32 v4, 4
    v_mov_b32 v5, 2
    v_cndmask_b32 v2, v2, v3, vcc
    v_cndmask_b32 v4, v4, v5, vcc
    v_mul_f32 v20, s33, v64
    v_mul_f32 v21, s33, v65
    v_cvt_pk_bf16_f32 v20, v20, v21
    v_add_u32 v22, 0, v10
    v_lshlrev_b32 v22, v4, v22
    v_add_u32 v22, v22, v2
    buffer_store_dword v20, v22, s[20:23], s26 offen
    v_mul_f32 v24, s33, v68
    v_mul_f32 v25, s33, v69
    v_cvt_pk_bf16_f32 v24, v24, v25
    v_add_u32 v26, 16, v10
    v_lshlrev_b32 v26, v4, v26
    v_add_u32 v26, v26, v2
    buffer_store_dword v24, v26, s[20:23], s26 offen
    v_add_u32 v12, 32, v11
    v_mul_lo_u32 v13, v12, s34
    v_lshrrev_b32 v13, 16, v13
    v_mul_u32_u24 v2, 18, v13
    v_sub_u32 v12, v12, v2
    v_lshrrev_b32 v2, 3, v12
    v_lshl_add_u32 v2, v13, 1, v2
    v_lshlrev_b32 v2, 15, v2
    v_and_b32 v3, 7, v12
    v_lshl_add_u32 v2, v3, 1, v2
    v_lshlrev_b32 v3, 13, v13
    v_add_u32 v3, 2097152, v3
    v_cmp_lt_u32 vcc, 15, v12
    v_mov_b32 v4, 4
    v_mov_b32 v5, 2
    v_cndmask_b32 v2, v2, v3, vcc
    v_cndmask_b32 v4, v4, v5, vcc
    v_mul_f32 v28, s33, v70
    v_mul_f32 v29, s33, v71
    v_cvt_pk_bf16_f32 v28, v28, v29
    v_add_u32 v30, 0, v10
    v_lshlrev_b32 v30, v4, v30
    v_add_u32 v30, v30, v2
    buffer_store_dword v28, v30, s[20:23], s26 offen
    v_mul_f32 v32, s33, v74
    v_mul_f32 v33, s33, v75
    v_cvt_pk_bf16_f32 v32, v32, v33
    v_add_u32 v34, 16, v10
    v_lshlrev_b32 v34, v4, v34
    v_add_u32 v34, v34, v2
    buffer_store_dword v32, v34, s[20:23], s26 offen
    v_add_u32 v12, 34, v11
    v_mul_lo_u32 v13, v12, s34
    v_lshrrev_b32 v13, 16, v13
    v_mul_u32_u24 v2, 18, v13
    v_sub_u32 v12, v12, v2
    v_lshrrev_b32 v2, 3, v12
    v_lshl_add_u32 v2, v13, 1, v2
    v_lshlrev_b32 v2, 15, v2
    v_and_b32 v3, 7, v12
    v_lshl_add_u32 v2, v3, 1, v2
    v_lshlrev_b32 v3, 13, v13
    v_add_u32 v3, 2097152, v3
    v_cmp_lt_u32 vcc, 15, v12
    v_mov_b32 v4, 4
    v_mov_b32 v5, 2
    v_cndmask_b32 v2, v2, v3, vcc
    v_cndmask_b32 v4, v4, v5, vcc
    v_mul_f32 v36, s33, v72
    v_mul_f32 v37, s33, v73
    v_cvt_pk_bf16_f32 v36, v36, v37
    v_add_u32 v38, 0, v10
    v_lshlrev_b32 v38, v4, v38
    v_add_u32 v38, v38, v2
    buffer_store_dword v36, v38, s[20:23], s26 offen
    v_mul_f32 v40, s33, v76
    v_mul_f32 v41, s33, v77
    v_cvt_pk_bf16_f32 v40, v40, v41
    v_add_u32 v42, 16, v10
    v_lshlrev_b32 v42, v4, v42
    v_add_u32 v42, v42, v2
    buffer_store_dword v40, v42, s[20:23], s26 offen
    v_add_u32 v12, 48, v11
    v_mul_lo_u32 v13, v12, s34
    v_lshrrev_b32 v13, 16, v13
    v_mul_u32_u24 v2, 18, v13
    v_sub_u32 v12, v12, v2
    v_lshrrev_b32 v2, 3, v12
    v_lshl_add_u32 v2, v13, 1, v2
    v_lshlrev_b32 v2, 15, v2
    v_and_b32 v3, 7, v12
    v_lshl_add_u32 v2, v3, 1, v2
    v_lshlrev_b32 v3, 13, v13
    v_add_u32 v3, 2097152, v3
    v_cmp_lt_u32 vcc, 15, v12
    v_mov_b32 v4, 4
    v_mov_b32 v5, 2
    v_cndmask_b32 v2, v2, v3, vcc
    v_cndmask_b32 v4, v4, v5, vcc
    v_mul_f32 v20, s33, v78
    v_mul_f32 v21, s33, v79
    v_cvt_pk_bf16_f32 v20, v20, v21
    v_add_u32 v22, 0, v10
    v_lshlrev_b32 v22, v4, v22
    v_add_u32 v22, v22, v2
    buffer_store_dword v20, v22, s[20:23], s26 offen
    v_mul_f32 v24, s33, v82
    v_mul_f32 v25, s33, v83
    v_cvt_pk_bf16_f32 v24, v24, v25
    v_add_u32 v26, 16, v10
    v_lshlrev_b32 v26, v4, v26
    v_add_u32 v26, v26, v2
    buffer_store_dword v24, v26, s[20:23], s26 offen
    v_add_u32 v12, 50, v11
    v_mul_lo_u32 v13, v12, s34
    v_lshrrev_b32 v13, 16, v13
    v_mul_u32_u24 v2, 18, v13
    v_sub_u32 v12, v12, v2
    v_lshrrev_b32 v2, 3, v12
    v_lshl_add_u32 v2, v13, 1, v2
    v_lshlrev_b32 v2, 15, v2
    v_and_b32 v3, 7, v12
    v_lshl_add_u32 v2, v3, 1, v2
    v_lshlrev_b32 v3, 13, v13
    v_add_u32 v3, 2097152, v3
    v_cmp_lt_u32 vcc, 15, v12
    v_mov_b32 v4, 4
    v_mov_b32 v5, 2
    v_cndmask_b32 v2, v2, v3, vcc
    v_cndmask_b32 v4, v4, v5, vcc
    v_mul_f32 v28, s33, v80
    v_mul_f32 v29, s33, v81
    v_cvt_pk_bf16_f32 v28, v28, v29
    v_add_u32 v30, 0, v10
    v_lshlrev_b32 v30, v4, v30
    v_add_u32 v30, v30, v2
    buffer_store_dword v28, v30, s[20:23], s26 offen
    v_mul_f32 v32, s33, v84
    v_mul_f32 v33, s33, v85
    v_cvt_pk_bf16_f32 v32, v32, v33
    v_add_u32 v34, 16, v10
    v_lshlrev_b32 v34, v4, v34
    v_add_u32 v34, v34, v2
    buffer_store_dword v32, v34, s[20:23], s26 offen
    v_add_u32 v12, 64, v11
    v_mul_lo_u32 v13, v12, s34
    v_lshrrev_b32 v13, 16, v13
    v_mul_u32_u24 v2, 18, v13
    v_sub_u32 v12, v12, v2
    v_lshrrev_b32 v2, 3, v12
    v_lshl_add_u32 v2, v13, 1, v2
    v_lshlrev_b32 v2, 15, v2
    v_and_b32 v3, 7, v12
    v_lshl_add_u32 v2, v3, 1, v2
    v_lshlrev_b32 v3, 13, v13
    v_add_u32 v3, 2097152, v3
    v_cmp_lt_u32 vcc, 15, v12
    v_mov_b32 v4, 4
    v_mov_b32 v5, 2
    v_cndmask_b32 v2, v2, v3, vcc
    v_cndmask_b32 v4, v4, v5, vcc
    v_mul_f32 v36, s33, v86
    v_mul_f32 v37, s33, v87
    v_cvt_pk_bf16_f32 v36, v36, v37
    v_add_u32 v38, 0, v10
    v_lshlrev_b32 v38, v4, v38
    v_add_u32 v38, v38, v2
    buffer_store_dword v36, v38, s[20:23], s26 offen
    v_mul_f32 v40, s33, v90
    v_mul_f32 v41, s33, v91
    v_cvt_pk_bf16_f32 v40, v40, v41
    v_add_u32 v42, 16, v10
    v_lshlrev_b32 v42, v4, v42
    v_add_u32 v42, v42, v2
    buffer_store_dword v40, v42, s[20:23], s26 offen
    v_add_u32 v12, 66, v11
    v_mul_lo_u32 v13, v12, s34
    v_lshrrev_b32 v13, 16, v13
    v_mul_u32_u24 v2, 18, v13
    v_sub_u32 v12, v12, v2
    v_lshrrev_b32 v2, 3, v12
    v_lshl_add_u32 v2, v13, 1, v2
    v_lshlrev_b32 v2, 15, v2
    v_and_b32 v3, 7, v12
    v_lshl_add_u32 v2, v3, 1, v2
    v_lshlrev_b32 v3, 13, v13
    v_add_u32 v3, 2097152, v3
    v_cmp_lt_u32 vcc, 15, v12
    v_mov_b32 v4, 4
    v_mov_b32 v5, 2
    v_cndmask_b32 v2, v2, v3, vcc
    v_cndmask_b32 v4, v4, v5, vcc
    v_mul_f32 v20, s33, v88
    v_mul_f32 v21, s33, v89
    v_cvt_pk_bf16_f32 v20, v20, v21
    v_add_u32 v22, 0, v10
    v_lshlrev_b32 v22, v4, v22
    v_add_u32 v22, v22, v2
    buffer_store_dword v20, v22, s[20:23], s26 offen
    v_mul_f32 v24, s33, v92
    v_mul_f32 v25, s33, v93
    v_cvt_pk_bf16_f32 v24, v24, v25
    v_add_u32 v26, 16, v10
    v_lshlrev_b32 v26, v4, v26
    v_add_u32 v26, v26, v2
    buffer_store_dword v24, v26, s[20:23], s26 offen
    v_add_u32 v12, 80, v11
    v_mul_lo_u32 v13, v12, s34
    v_lshrrev_b32 v13, 16, v13
    v_mul_u32_u24 v2, 18, v13
    v_sub_u32 v12, v12, v2
    v_lshrrev_b32 v2, 3, v12
    v_lshl_add_u32 v2, v13, 1, v2
    v_lshlrev_b32 v2, 15, v2
    v_and_b32 v3, 7, v12
    v_lshl_add_u32 v2, v3, 1, v2
    v_lshlrev_b32 v3, 13, v13
    v_add_u32 v3, 2097152, v3
    v_cmp_lt_u32 vcc, 15, v12
    v_mov_b32 v4, 4
    v_mov_b32 v5, 2
    v_cndmask_b32 v2, v2, v3, vcc
    v_cndmask_b32 v4, v4, v5, vcc
    v_mul_f32 v28, s33, v94
    v_mul_f32 v29, s33, v95
    v_cvt_pk_bf16_f32 v28, v28, v29
    v_add_u32 v30, 0, v10
    v_lshlrev_b32 v30, v4, v30
    v_add_u32 v30, v30, v2
    buffer_store_dword v28, v30, s[20:23], s26 offen
    v_mul_f32 v32, s33, v98
    v_mul_f32 v33, s33, v99
    v_cvt_pk_bf16_f32 v32, v32, v33
    v_add_u32 v34, 16, v10
    v_lshlrev_b32 v34, v4, v34
    v_add_u32 v34, v34, v2
    buffer_store_dword v32, v34, s[20:23], s26 offen
    v_add_u32 v12, 82, v11
    v_mul_lo_u32 v13, v12, s34
    v_lshrrev_b32 v13, 16, v13
    v_mul_u32_u24 v2, 18, v13
    v_sub_u32 v12, v12, v2
    v_lshrrev_b32 v2, 3, v12
    v_lshl_add_u32 v2, v13, 1, v2
    v_lshlrev_b32 v2, 15, v2
    v_and_b32 v3, 7, v12
    v_lshl_add_u32 v2, v3, 1, v2
    v_lshlrev_b32 v3, 13, v13
    v_add_u32 v3, 2097152, v3
    v_cmp_lt_u32 vcc, 15, v12
    v_mov_b32 v4, 4
    v_mov_b32 v5, 2
    v_cndmask_b32 v2, v2, v3, vcc
    v_cndmask_b32 v4, v4, v5, vcc
    v_mul_f32 v36, s33, v96
    v_mul_f32 v37, s33, v97
    v_cvt_pk_bf16_f32 v36, v36, v37
    v_add_u32 v38, 0, v10
    v_lshlrev_b32 v38, v4, v38
    v_add_u32 v38, v38, v2
    buffer_store_dword v36, v38, s[20:23], s26 offen
    v_mul_f32 v40, s33, v100
    v_mul_f32 v41, s33, v101
    v_cvt_pk_bf16_f32 v40, v40, v41
    v_add_u32 v42, 16, v10
    v_lshlrev_b32 v42, v4, v42
    v_add_u32 v42, v42, v2
    buffer_store_dword v40, v42, s[20:23], s26 offen
    v_add_u32 v12, 96, v11
    v_mul_lo_u32 v13, v12, s34
    v_lshrrev_b32 v13, 16, v13
    v_mul_u32_u24 v2, 18, v13
    v_sub_u32 v12, v12, v2
    v_lshrrev_b32 v2, 3, v12
    v_lshl_add_u32 v2, v13, 1, v2
    v_lshlrev_b32 v2, 15, v2
    v_and_b32 v3, 7, v12
    v_lshl_add_u32 v2, v3, 1, v2
    v_lshlrev_b32 v3, 13, v13
    v_add_u32 v3, 2097152, v3
    v_cmp_lt_u32 vcc, 15, v12
    v_mov_b32 v4, 4
    v_mov_b32 v5, 2
    v_cndmask_b32 v2, v2, v3, vcc
    v_cndmask_b32 v4, v4, v5, vcc
    v_mul_f32 v20, s33, v102
    v_mul_f32 v21, s33, v103
    v_cvt_pk_bf16_f32 v20, v20, v21
    v_add_u32 v22, 0, v10
    v_lshlrev_b32 v22, v4, v22
    v_add_u32 v22, v22, v2
    buffer_store_dword v20, v22, s[20:23], s26 offen
    v_mul_f32 v24, s33, v106
    v_mul_f32 v25, s33, v107
    v_cvt_pk_bf16_f32 v24, v24, v25
    v_add_u32 v26, 16, v10
    v_lshlrev_b32 v26, v4, v26
    v_add_u32 v26, v26, v2
    buffer_store_dword v24, v26, s[20:23], s26 offen
    v_add_u32 v12, 98, v11
    v_mul_lo_u32 v13, v12, s34
    v_lshrrev_b32 v13, 16, v13
    v_mul_u32_u24 v2, 18, v13
    v_sub_u32 v12, v12, v2
    v_lshrrev_b32 v2, 3, v12
    v_lshl_add_u32 v2, v13, 1, v2
    v_lshlrev_b32 v2, 15, v2
    v_and_b32 v3, 7, v12
    v_lshl_add_u32 v2, v3, 1, v2
    v_lshlrev_b32 v3, 13, v13
    v_add_u32 v3, 2097152, v3
    v_cmp_lt_u32 vcc, 15, v12
    v_mov_b32 v4, 4
    v_mov_b32 v5, 2
    v_cndmask_b32 v2, v2, v3, vcc
    v_cndmask_b32 v4, v4, v5, vcc
    v_mul_f32 v28, s33, v104
    v_mul_f32 v29, s33, v105
    v_cvt_pk_bf16_f32 v28, v28, v29
    v_add_u32 v30, 0, v10
    v_lshlrev_b32 v30, v4, v30
    v_add_u32 v30, v30, v2
    buffer_store_dword v28, v30, s[20:23], s26 offen
    v_mul_f32 v32, s33, v108
    v_mul_f32 v33, s33, v109
    v_cvt_pk_bf16_f32 v32, v32, v33
    v_add_u32 v34, 16, v10
    v_lshlrev_b32 v34, v4, v34
    v_add_u32 v34, v34, v2
    buffer_store_dword v32, v34, s[20:23], s26 offen
    v_add_u32 v12, 112, v11
    v_mul_lo_u32 v13, v12, s34
    v_lshrrev_b32 v13, 16, v13
    v_mul_u32_u24 v2, 18, v13
    v_sub_u32 v12, v12, v2
    v_lshrrev_b32 v2, 3, v12
    v_lshl_add_u32 v2, v13, 1, v2
    v_lshlrev_b32 v2, 15, v2
    v_and_b32 v3, 7, v12
    v_lshl_add_u32 v2, v3, 1, v2
    v_lshlrev_b32 v3, 13, v13
    v_add_u32 v3, 2097152, v3
    v_cmp_lt_u32 vcc, 15, v12
    v_mov_b32 v4, 4
    v_mov_b32 v5, 2
    v_cndmask_b32 v2, v2, v3, vcc
    v_cndmask_b32 v4, v4, v5, vcc
    v_mul_f32 v36, s33, v110
    v_mul_f32 v37, s33, v111
    v_cvt_pk_bf16_f32 v36, v36, v37
    v_add_u32 v38, 0, v10
    v_lshlrev_b32 v38, v4, v38
    v_add_u32 v38, v38, v2
    buffer_store_dword v36, v38, s[20:23], s26 offen
    v_mul_f32 v40, s33, v114
    v_mul_f32 v41, s33, v115
    v_cvt_pk_bf16_f32 v40, v40, v41
    v_add_u32 v42, 16, v10
    v_lshlrev_b32 v42, v4, v42
    v_add_u32 v42, v42, v2
    buffer_store_dword v40, v42, s[20:23], s26 offen
    v_add_u32 v12, 114, v11
    v_mul_lo_u32 v13, v12, s34
    v_lshrrev_b32 v13, 16, v13
    v_mul_u32_u24 v2, 18, v13
    v_sub_u32 v12, v12, v2
    v_lshrrev_b32 v2, 3, v12
    v_lshl_add_u32 v2, v13, 1, v2
    v_lshlrev_b32 v2, 15, v2
    v_and_b32 v3, 7, v12
    v_lshl_add_u32 v2, v3, 1, v2
    v_lshlrev_b32 v3, 13, v13
    v_add_u32 v3, 2097152, v3
    v_cmp_lt_u32 vcc, 15, v12
    v_mov_b32 v4, 4
    v_mov_b32 v5, 2
    v_cndmask_b32 v2, v2, v3, vcc
    v_cndmask_b32 v4, v4, v5, vcc
    v_mul_f32 v20, s33, v112
    v_mul_f32 v21, s33, v113
    v_cvt_pk_bf16_f32 v20, v20, v21
    v_add_u32 v22, 0, v10
    v_lshlrev_b32 v22, v4, v22
    v_add_u32 v22, v22, v2
    buffer_store_dword v20, v22, s[20:23], s26 offen
    v_mul_f32 v24, s33, v116
    v_mul_f32 v25, s33, v117
    v_cvt_pk_bf16_f32 v24, v24, v25
    v_add_u32 v26, 16, v10
    v_lshlrev_b32 v26, v4, v26
    v_add_u32 v26, v26, v2
    buffer_store_dword v24, v26, s[20:23], s26 offen
    v_add_u32 v12, 128, v11
    v_mul_lo_u32 v13, v12, s34
    v_lshrrev_b32 v13, 16, v13
    v_mul_u32_u24 v2, 18, v13
    v_sub_u32 v12, v12, v2
    v_lshrrev_b32 v2, 3, v12
    v_lshl_add_u32 v2, v13, 1, v2
    v_lshlrev_b32 v2, 15, v2
    v_and_b32 v3, 7, v12
    v_lshl_add_u32 v2, v3, 1, v2
    v_lshlrev_b32 v3, 13, v13
    v_add_u32 v3, 2097152, v3
    v_cmp_lt_u32 vcc, 15, v12
    v_mov_b32 v4, 4
    v_mov_b32 v5, 2
    v_cndmask_b32 v2, v2, v3, vcc
    v_cndmask_b32 v4, v4, v5, vcc
    v_mul_f32 v28, s33, v118
    v_mul_f32 v29, s33, v119
    v_cvt_pk_bf16_f32 v28, v28, v29
    v_add_u32 v30, 0, v10
    v_lshlrev_b32 v30, v4, v30
    v_add_u32 v30, v30, v2
    buffer_store_dword v28, v30, s[20:23], s26 offen
    v_mul_f32 v32, s33, v122
    v_mul_f32 v33, s33, v123
    v_cvt_pk_bf16_f32 v32, v32, v33
    v_add_u32 v34, 16, v10
    v_lshlrev_b32 v34, v4, v34
    v_add_u32 v34, v34, v2
    buffer_store_dword v32, v34, s[20:23], s26 offen
    v_add_u32 v12, 130, v11
    v_mul_lo_u32 v13, v12, s34
    v_lshrrev_b32 v13, 16, v13
    v_mul_u32_u24 v2, 18, v13
    v_sub_u32 v12, v12, v2
    v_lshrrev_b32 v2, 3, v12
    v_lshl_add_u32 v2, v13, 1, v2
    v_lshlrev_b32 v2, 15, v2
    v_and_b32 v3, 7, v12
    v_lshl_add_u32 v2, v3, 1, v2
    v_lshlrev_b32 v3, 13, v13
    v_add_u32 v3, 2097152, v3
    v_cmp_lt_u32 vcc, 15, v12
    v_mov_b32 v4, 4
    v_mov_b32 v5, 2
    v_cndmask_b32 v2, v2, v3, vcc
    v_cndmask_b32 v4, v4, v5, vcc
    v_mul_f32 v36, s33, v120
    v_mul_f32 v37, s33, v121
    v_cvt_pk_bf16_f32 v36, v36, v37
    v_add_u32 v38, 0, v10
    v_lshlrev_b32 v38, v4, v38
    v_add_u32 v38, v38, v2
    buffer_store_dword v36, v38, s[20:23], s26 offen
    v_mul_f32 v40, s33, v124
    v_mul_f32 v41, s33, v125
    v_cvt_pk_bf16_f32 v40, v40, v41
    v_add_u32 v42, 16, v10
    v_lshlrev_b32 v42, v4, v42
    v_add_u32 v42, v42, v2
    buffer_store_dword v40, v42, s[20:23], s26 offen
    s_branch qkv_done
qkv_vpath:
    s_add_u32 m0, s25, 0
    s_nop 0
    buffer_load_dwordx4 v2, s[8:11], s26 offen lds
    s_add_u32 m0, s25, 4096
    s_nop 0
    buffer_load_dwordx4 v3, s[8:11], s26 offen lds
    s_add_u32 m0, s38, 0
    s_add_u32 s28, s27, 128
    buffer_load_dwordx4 v4, s[12:15], s27 offen lds
    s_add_u32 m0, s38, 4096
    s_nop 0
    buffer_load_dwordx4 v4, s[12:15], s28 offen lds
    s_add_u32 m0, s39, 0
    s_mov_b64 exec, 0xffff
    buffer_load_dwordx4 v5, s[12:15], s27 offen lds
    s_mov_b64 exec, -1
    s_add_u32 s26, s26, 64
    s_add_u32 s27, s27, 110592
    s_add_u32 m0, s25, 17408
    s_nop 0
    buffer_load_dwordx4 v2, s[8:11], s26 offen lds
    s_add_u32 m0, s25, 21504
    s_nop 0
    buffer_load_dwordx4 v3, s[8:11], s26 offen lds
    s_add_u32 m0, s38, 17408
    s_add_u32 s28, s27, 128
    buffer_load_dwordx4 v4, s[12:15], s27 offen lds
    s_add_u32 m0, s38, 21504
    s_nop 0
    buffer_load_dwordx4 v4, s[12:15], s28 offen lds
    s_add_u32 m0, s39, 17408
    s_mov_b64 exec, 0xffff
    buffer_load_dwordx4 v5, s[12:15], s27 offen lds
    s_mov_b64 exec, -1
    s_add_u32 s26, s26, 64
    s_add_u32 s27, s27, 110592
    s_add_u32 m0, s25, 34816
    s_nop 0
    buffer_load_dwordx4 v2, s[8:11], s26 offen lds
    s_add_u32 m0, s25, 38912
    s_nop 0
    buffer_load_dwordx4 v3, s[8:11], s26 offen lds
    s_add_u32 m0, s38, 34816
    s_add_u32 s28, s27, 128
    buffer_load_dwordx4 v4, s[12:15], s27 offen lds
    s_add_u32 m0, s38, 38912
    s_nop 0
    buffer_load_dwordx4 v4, s[12:15], s28 offen lds
    s_add_u32 m0, s39, 34816
    s_mov_b64 exec, 0xffff
    buffer_load_dwordx4 v5, s[12:15], s27 offen lds
    s_mov_b64 exec, -1
    s_add_u32 s26, s26, 64
    s_add_u32 s27, s27, 110592
    s_add_u32 m0, s25, 52224
    s_nop 0
    buffer_load_dwordx4 v2, s[8:11], s26 offen lds
    s_add_u32 m0, s25, 56320
    s_nop 0
    buffer_load_dwordx4 v3, s[8:11], s26 offen lds
    s_add_u32 m0, s38, 52224
    s_add_u32 s28, s27, 128
    buffer_load_dwordx4 v4, s[12:15], s27 offen lds
    s_add_u32 m0, s38, 56320
    s_nop 0
    buffer_load_dwordx4 v4, s[12:15], s28 offen lds
    s_add_u32 m0, s39, 52224
    s_mov_b64 exec, 0xffff
    buffer_load_dwordx4 v5, s[12:15], s27 offen lds
    s_mov_b64 exec, -1
    s_add_u32 s26, s26, 64
    s_add_u32 s27, s27, 110592
    s_add_u32 m0, s25, 69632
    s_nop 0
    buffer_load_dwordx4 v2, s[8:11], s26 offen lds
    s_add_u32 m0, s25, 73728
    s_nop 0
    buffer_load_dwordx4 v3, s[8:11], s26 offen lds
    s_add_u32 m0, s38, 69632
    s_add_u32 s28, s27, 128
    buffer_load_dwordx4 v4, s[12:15], s27 offen lds
    s_add_u32 m0, s38, 73728
    s_nop 0
    buffer_load_dwordx4 v4, s[12:15], s28 offen lds
    s_add_u32 m0, s39, 69632
    s_mov_b64 exec, 0xffff
    buffer_load_dwordx4 v5, s[12:15], s27 offen lds
    s_mov_b64 exec, -1
    s_add_u32 s26, s26, 64
    s_add_u32 s27, s27, 110592
    s_waitcnt vmcnt(20)
    s_barrier
    ds_read_b128 v[6:9], v14 offset:0
    ds_read_b128 v[10:13], v14 offset:1024
    ds_read_b64_tr_b16 v[30:31], v16 offset:0
    ds_read_b64_tr_b16 v[32:33], v16 offset:512
    ds_read_b64_tr_b16 v[34:35], v17 offset:0
    ds_read_b64_tr_b16 v[36:37], v17 offset:512
    ds_read_b64_tr_b16 v[38:39], v18 offset:0
    ds_read_b64_tr_b16 v[40:41], v18 offset:512
    s_waitcnt lgkmcnt(0)
    ds_read_b64_tr_b16 v[42:43], v19 offset:0
    ds_read_b64_tr_b16 v[44:45], v19 offset:512
    ds_read_b64_tr_b16 v[46:47], v16 offset:4096
    ds_read_b64_tr_b16 v[48:49], v16 offset:4608
    ds_read_b64_tr_b16 v[50:51], v17 offset:4096
    ds_read_b64_tr_b16 v[52:53], v17 offset:4608
    s_add_u32 m0, s25, 87040
    s_nop 0
    buffer_load_dwordx4 v2, s[8:11], s26 offen lds
    s_add_u32 m0, s25, 91136
    s_nop 0
    buffer_load_dwordx4 v3, s[8:11], s26 offen lds
    s_add_u32 m0, s38, 87040
    s_add_u32 s28, s27, 128
    buffer_load_dwordx4 v4, s[12:15], s27 offen lds
    s_add_u32 m0, s38, 91136
    s_nop 0
    buffer_load_dwordx4 v4, s[12:15], s28 offen lds
    s_add_u32 m0, s39, 87040
    s_mov_b64 exec, 0xffff
    buffer_load_dwordx4 v5, s[12:15], s27 offen lds
    s_mov_b64 exec, -1
    s_add_u32 s26, s26, 64
    s_add_u32 s27, s27, 110592
    v_mfma_f32_16x16x32_bf16 v[54:57], v[6:9], v[30:33], v[54:57]
    v_mfma_f32_16x16x32_bf16 v[58:61], v[10:13], v[30:33], v[58:61]
    v_mfma_f32_16x16x32_bf16 v[62:65], v[6:9], v[34:37], v[62:65]
    v_mfma_f32_16x16x32_bf16 v[66:69], v[10:13], v[34:37], v[66:69]
    v_mfma_f32_16x16x32_bf16 v[70:73], v[6:9], v[38:41], v[70:73]
    v_mfma_f32_16x16x32_bf16 v[74:77], v[10:13], v[38:41], v[74:77]
    s_waitcnt lgkmcnt(0)
    ds_read_b64_tr_b16 v[30:31], v18 offset:4096
    ds_read_b64_tr_b16 v[32:33], v18 offset:4608
    ds_read_b64_tr_b16 v[34:35], v19 offset:4096
    ds_read_b64_tr_b16 v[36:37], v19 offset:4608
    ds_read_b64_tr_b16 v[38:39], v20
    ds_read_b64_tr_b16 v[40:41], v21
    v_mfma_f32_16x16x32_bf16 v[78:81], v[6:9], v[42:45], v[78:81]
    v_mfma_f32_16x16x32_bf16 v[82:85], v[10:13], v[42:45], v[82:85]
    v_mfma_f32_16x16x32_bf16 v[86:89], v[6:9], v[46:49], v[86:89]
    v_mfma_f32_16x16x32_bf16 v[90:93], v[10:13], v[46:49], v[90:93]
    v_mfma_f32_16x16x32_bf16 v[94:97], v[6:9], v[50:53], v[94:97]
    v_mfma_f32_16x16x32_bf16 v[98:101], v[10:13], v[50:53], v[98:101]
    s_waitcnt lgkmcnt(0)
    s_waitcnt vmcnt(20)
    s_barrier
    v_add_u32 v14, 17408, v14
    v_add_u32 v16, 17408, v16
    v_add_u32 v17, 17408, v17
    v_add_u32 v18, 17408, v18
    v_add_u32 v19, 17408, v19
    v_add_u32 v20, 17408, v20
    v_add_u32 v21, 17408, v21
    ds_read_b128 v[22:25], v14 offset:0
    ds_read_b128 v[26:29], v14 offset:1024
    ds_read_b64_tr_b16 v[42:43], v16 offset:0
    ds_read_b64_tr_b16 v[44:45], v16 offset:512
    ds_read_b64_tr_b16 v[46:47], v17 offset:0
    ds_read_b64_tr_b16 v[48:49], v17 offset:512
    ds_read_b64_tr_b16 v[50:51], v18 offset:0
    ds_read_b64_tr_b16 v[52:53], v18 offset:512
    v_mfma_f32_16x16x32_bf16 v[102:105], v[6:9], v[30:33], v[102:105]
    v_mfma_f32_16x16x32_bf16 v[106:109], v[10:13], v[30:33], v[106:109]
    v_mfma_f32_16x16x32_bf16 v[110:113], v[6:9], v[34:37], v[110:113]
    v_mfma_f32_16x16x32_bf16 v[114:117], v[10:13], v[34:37], v[114:117]
    v_mfma_f32_16x16x32_bf16 v[118:121], v[6:9], v[38:41], v[118:121]
    v_mfma_f32_16x16x32_bf16 v[122:125], v[10:13], v[38:41], v[122:125]
    s_waitcnt lgkmcnt(0)
    ds_read_b64_tr_b16 v[30:31], v19 offset:0
    ds_read_b64_tr_b16 v[32:33], v19 offset:512
    ds_read_b64_tr_b16 v[34:35], v16 offset:4096
    ds_read_b64_tr_b16 v[36:37], v16 offset:4608
    ds_read_b64_tr_b16 v[38:39], v17 offset:4096
    ds_read_b64_tr_b16 v[40:41], v17 offset:4608
    s_add_u32 m0, s25, 0
    s_nop 0
    buffer_load_dwordx4 v2, s[8:11], s26 offen lds
    s_add_u32 m0, s25, 4096
    s_nop 0
    buffer_load_dwordx4 v3, s[8:11], s26 offen lds
    s_add_u32 m0, s38, 0
    s_add_u32 s28, s27, 128
    buffer_load_dwordx4 v4, s[12:15], s27 offen lds
    s_add_u32 m0, s38, 4096
    s_nop 0
    buffer_load_dwordx4 v4, s[12:15], s28 offen lds
    s_add_u32 m0, s39, 0
    s_mov_b64 exec, 0xffff
    buffer_load_dwordx4 v5, s[12:15], s27 offen lds
    s_mov_b64 exec, -1
    s_add_u32 s26, s26, 64
    s_add_u32 s27, s27, 110592
    v_mfma_f32_16x16x32_bf16 v[54:57], v[22:25], v[42:45], v[54:57]
    v_mfma_f32_16x16x32_bf16 v[58:61], v[26:29], v[42:45], v[58:61]
    v_mfma_f32_16x16x32_bf16 v[62:65], v[22:25], v[46:49], v[62:65]
    v_mfma_f32_16x16x32_bf16 v[66:69], v[26:29], v[46:49], v[66:69]
    v_mfma_f32_16x16x32_bf16 v[70:73], v[22:25], v[50:53], v[70:73]
    v_mfma_f32_16x16x32_bf16 v[74:77], v[26:29], v[50:53], v[74:77]
    s_waitcnt lgkmcnt(0)
    ds_read_b64_tr_b16 v[42:43], v18 offset:4096
    ds_read_b64_tr_b16 v[44:45], v18 offset:4608
    ds_read_b64_tr_b16 v[46:47], v19 offset:4096
    ds_read_b64_tr_b16 v[48:49], v19 offset:4608
    ds_read_b64_tr_b16 v[50:51], v20
    ds_read_b64_tr_b16 v[52:53], v21
    v_mfma_f32_16x16x32_bf16 v[78:81], v[22:25], v[30:33], v[78:81]
    v_mfma_f32_16x16x32_bf16 v[82:85], v[26:29], v[30:33], v[82:85]
    v_mfma_f32_16x16x32_bf16 v[86:89], v[22:25], v[34:37], v[86:89]
    v_mfma_f32_16x16x32_bf16 v[90:93], v[26:29], v[34:37], v[90:93]
    v_mfma_f32_16x16x32_bf16 v[94:97], v[22:25], v[38:41], v[94:97]
    v_mfma_f32_16x16x32_bf16 v[98:101], v[26:29], v[38:41], v[98:101]
    s_waitcnt lgkmcnt(0)
    s_waitcnt vmcnt(20)
    s_barrier
    v_add_u32 v14, 17408, v14
    v_add_u32 v16, 17408, v16
    v_add_u32 v17, 17408, v17
    v_add_u32 v18, 17408, v18
    v_add_u32 v19, 17408, v19
    v_add_u32 v20, 17408, v20
    v_add_u32 v21, 17408, v21
    ds_read_b128 v[6:9], v14 offset:0
    ds_read_b128 v[10:13], v14 offset:1024
    ds_read_b64_tr_b16 v[30:31], v16 offset:0
    ds_read_b64_tr_b16 v[32:33], v16 offset:512
    ds_read_b64_tr_b16 v[34:35], v17 offset:0
    ds_read_b64_tr_b16 v[36:37], v17 offset:512
    ds_read_b64_tr_b16 v[38:39], v18 offset:0
    ds_read_b64_tr_b16 v[40:41], v18 offset:512
    v_mfma_f32_16x16x32_bf16 v[102:105], v[22:25], v[42:45], v[102:105]
    v_mfma_f32_16x16x32_bf16 v[106:109], v[26:29], v[42:45], v[106:109]
    v_mfma_f32_16x16x32_bf16 v[110:113], v[22:25], v[46:49], v[110:113]
    v_mfma_f32_16x16x32_bf16 v[114:117], v[26:29], v[46:49], v[114:117]
    v_mfma_f32_16x16x32_bf16 v[118:121], v[22:25], v[50:53], v[118:121]
    v_mfma_f32_16x16x32_bf16 v[122:125], v[26:29], v[50:53], v[122:125]
    s_waitcnt lgkmcnt(0)
    ds_read_b64_tr_b16 v[42:43], v19 offset:0
    ds_read_b64_tr_b16 v[44:45], v19 offset:512
    ds_read_b64_tr_b16 v[46:47], v16 offset:4096
    ds_read_b64_tr_b16 v[48:49], v16 offset:4608
    ds_read_b64_tr_b16 v[50:51], v17 offset:4096
    ds_read_b64_tr_b16 v[52:53], v17 offset:4608
    s_add_u32 m0, s25, 17408
    s_nop 0
    buffer_load_dwordx4 v2, s[8:11], s26 offen lds
    s_add_u32 m0, s25, 21504
    s_nop 0
    buffer_load_dwordx4 v3, s[8:11], s26 offen lds
    s_add_u32 m0, s38, 17408
    s_add_u32 s28, s27, 128
    buffer_load_dwordx4 v4, s[12:15], s27 offen lds
    s_add_u32 m0, s38, 21504
    s_nop 0
    buffer_load_dwordx4 v4, s[12:15], s28 offen lds
    s_add_u32 m0, s39, 17408
    s_mov_b64 exec, 0xffff
    buffer_load_dwordx4 v5, s[12:15], s27 offen lds
    s_mov_b64 exec, -1
    s_add_u32 s26, s26, 64
    s_add_u32 s27, s27, 110592
    v_mfma_f32_16x16x32_bf16 v[54:57], v[6:9], v[30:33], v[54:57]
    v_mfma_f32_16x16x32_bf16 v[58:61], v[10:13], v[30:33], v[58:61]
    v_mfma_f32_16x16x32_bf16 v[62:65], v[6:9], v[34:37], v[62:65]
    v_mfma_f32_16x16x32_bf16 v[66:69], v[10:13], v[34:37], v[66:69]
    v_mfma_f32_16x16x32_bf16 v[70:73], v[6:9], v[38:41], v[70:73]
    v_mfma_f32_16x16x32_bf16 v[74:77], v[10:13], v[38:41], v[74:77]
    s_waitcnt lgkmcnt(0)
    ds_read_b64_tr_b16 v[30:31], v18 offset:4096
    ds_read_b64_tr_b16 v[32:33], v18 offset:4608
    ds_read_b64_tr_b16 v[34:35], v19 offset:4096
    ds_read_b64_tr_b16 v[36:37], v19 offset:4608
    ds_read_b64_tr_b16 v[38:39], v20
    ds_read_b64_tr_b16 v[40:41], v21
    v_mfma_f32_16x16x32_bf16 v[78:81], v[6:9], v[42:45], v[78:81]
    v_mfma_f32_16x16x32_bf16 v[82:85], v[10:13], v[42:45], v[82:85]
    v_mfma_f32_16x16x32_bf16 v[86:89], v[6:9], v[46:49], v[86:89]
    v_mfma_f32_16x16x32_bf16 v[90:93], v[10:13], v[46:49], v[90:93]
    v_mfma_f32_16x16x32_bf16 v[94:97], v[6:9], v[50:53], v[94:97]
    v_mfma_f32_16x16x32_bf16 v[98:101], v[10:13], v[50:53], v[98:101]
    s_waitcnt lgkmcnt(0)
    s_waitcnt vmcnt(20)
    s_barrier
    v_add_u32 v14, 17408, v14
    v_add_u32 v16, 17408, v16
    v_add_u32 v17, 17408, v17
    v_add_u32 v18, 17408, v18
    v_add_u32 v19, 17408, v19
    v_add_u32 v20, 17408, v20
    v_add_u32 v21, 17408, v21
    ds_read_b128 v[22:25], v14 offset:0
    ds_read_b128 v[26:29], v14 offset:1024
    ds_read_b64_tr_b16 v[42:43], v16 offset:0
    ds_read_b64_tr_b16 v[44:45], v16 offset:512
    ds_read_b64_tr_b16 v[46:47], v17 offset:0
    ds_read_b64_tr_b16 v[48:49], v17 offset:512
    ds_read_b64_tr_b16 v[50:51], v18 offset:0
    ds_read_b64_tr_b16 v[52:53], v18 offset:512
    v_mfma_f32_16x16x32_bf16 v[102:105], v[6:9], v[30:33], v[102:105]
    v_mfma_f32_16x16x32_bf16 v[106:109], v[10:13], v[30:33], v[106:109]
    v_mfma_f32_16x16x32_bf16 v[110:113], v[6:9], v[34:37], v[110:113]
    v_mfma_f32_16x16x32_bf16 v[114:117], v[10:13], v[34:37], v[114:117]
    v_mfma_f32_16x16x32_bf16 v[118:121], v[6:9], v[38:41], v[118:121]
    v_mfma_f32_16x16x32_bf16 v[122:125], v[10:13], v[38:41], v[122:125]
    s_waitcnt lgkmcnt(0)
    ds_read_b64_tr_b16 v[30:31], v19 offset:0
    ds_read_b64_tr_b16 v[32:33], v19 offset:512
    ds_read_b64_tr_b16 v[34:35], v16 offset:4096
    ds_read_b64_tr_b16 v[36:37], v16 offset:4608
    ds_read_b64_tr_b16 v[38:39], v17 offset:4096
    ds_read_b64_tr_b16 v[40:41], v17 offset:4608
    s_add_u32 m0, s25, 34816
    s_nop 0
    buffer_load_dwordx4 v2, s[8:11], s26 offen lds
    s_add_u32 m0, s25, 38912
    s_nop 0
    buffer_load_dwordx4 v3, s[8:11], s26 offen lds
    s_add_u32 m0, s38, 34816
    s_add_u32 s28, s27, 128
    buffer_load_dwordx4 v4, s[12:15], s27 offen lds
    s_add_u32 m0, s38, 38912
    s_nop 0
    buffer_load_dwordx4 v4, s[12:15], s28 offen lds
    s_add_u32 m0, s39, 34816
    s_mov_b64 exec, 0xffff
    buffer_load_dwordx4 v5, s[12:15], s27 offen lds
    s_mov_b64 exec, -1
    s_add_u32 s26, s26, 64
    s_add_u32 s27, s27, 110592
    v_mfma_f32_16x16x32_bf16 v[54:57], v[22:25], v[42:45], v[54:57]
    v_mfma_f32_16x16x32_bf16 v[58:61], v[26:29], v[42:45], v[58:61]
    v_mfma_f32_16x16x32_bf16 v[62:65], v[22:25], v[46:49], v[62:65]
    v_mfma_f32_16x16x32_bf16 v[66:69], v[26:29], v[46:49], v[66:69]
    v_mfma_f32_16x16x32_bf16 v[70:73], v[22:25], v[50:53], v[70:73]
    v_mfma_f32_16x16x32_bf16 v[74:77], v[26:29], v[50:53], v[74:77]
    s_waitcnt lgkmcnt(0)
    ds_read_b64_tr_b16 v[42:43], v18 offset:4096
    ds_read_b64_tr_b16 v[44:45], v18 offset:4608
    ds_read_b64_tr_b16 v[46:47], v19 offset:4096
    ds_read_b64_tr_b16 v[48:49], v19 offset:4608
    ds_read_b64_tr_b16 v[50:51], v20
    ds_read_b64_tr_b16 v[52:53], v21
    v_mfma_f32_16x16x32_bf16 v[78:81], v[22:25], v[30:33], v[78:81]
    v_mfma_f32_16x16x32_bf16 v[82:85], v[26:29], v[30:33], v[82:85]
    v_mfma_f32_16x16x32_bf16 v[86:89], v[22:25], v[34:37], v[86:89]
    v_mfma_f32_16x16x32_bf16 v[90:93], v[26:29], v[34:37], v[90:93]
    v_mfma_f32_16x16x32_bf16 v[94:97], v[22:25], v[38:41], v[94:97]
    v_mfma_f32_16x16x32_bf16 v[98:101], v[26:29], v[38:41], v[98:101]
    s_waitcnt lgkmcnt(0)
    s_waitcnt vmcnt(20)
    s_barrier
    v_add_u32 v14, 17408, v14
    v_add_u32 v16, 17408, v16
    v_add_u32 v17, 17408, v17
    v_add_u32 v18, 17408, v18
    v_add_u32 v19, 17408, v19
    v_add_u32 v20, 17408, v20
    v_add_u32 v21, 17408, v21
    ds_read_b128 v[6:9], v14 offset:0
    ds_read_b128 v[10:13], v14 offset:1024
    ds_read_b64_tr_b16 v[30:31], v16 offset:0
    ds_read_b64_tr_b16 v[32:33], v16 offset:512
    ds_read_b64_tr_b16 v[34:35], v17 offset:0
    ds_read_b64_tr_b16 v[36:37], v17 offset:512
    ds_read_b64_tr_b16 v[38:39], v18 offset:0
    ds_read_b64_tr_b16 v[40:41], v18 offset:512
    v_mfma_f32_16x16x32_bf16 v[102:105], v[22:25], v[42:45], v[102:105]
    v_mfma_f32_16x16x32_bf16 v[106:109], v[26:29], v[42:45], v[106:109]
    v_mfma_f32_16x16x32_bf16 v[110:113], v[22:25], v[46:49], v[110:113]
    v_mfma_f32_16x16x32_bf16 v[114:117], v[26:29], v[46:49], v[114:117]
    v_mfma_f32_16x16x32_bf16 v[118:121], v[22:25], v[50:53], v[118:121]
    v_mfma_f32_16x16x32_bf16 v[122:125], v[26:29], v[50:53], v[122:125]
    s_waitcnt lgkmcnt(0)
    ds_read_b64_tr_b16 v[42:43], v19 offset:0
    ds_read_b64_tr_b16 v[44:45], v19 offset:512
    ds_read_b64_tr_b16 v[46:47], v16 offset:4096
    ds_read_b64_tr_b16 v[48:49], v16 offset:4608
    ds_read_b64_tr_b16 v[50:51], v17 offset:4096
    ds_read_b64_tr_b16 v[52:53], v17 offset:4608
    s_add_u32 m0, s25, 52224
    s_nop 0
    buffer_load_dwordx4 v2, s[8:11], s26 offen lds
    s_add_u32 m0, s25, 56320
    s_nop 0
    buffer_load_dwordx4 v3, s[8:11], s26 offen lds
    s_add_u32 m0, s38, 52224
    s_add_u32 s28, s27, 128
    buffer_load_dwordx4 v4, s[12:15], s27 offen lds
    s_add_u32 m0, s38, 56320
    s_nop 0
    buffer_load_dwordx4 v4, s[12:15], s28 offen lds
    s_add_u32 m0, s39, 52224
    s_mov_b64 exec, 0xffff
    buffer_load_dwordx4 v5, s[12:15], s27 offen lds
    s_mov_b64 exec, -1
    s_add_u32 s26, s26, 64
    s_add_u32 s27, s27, 110592
    v_mfma_f32_16x16x32_bf16 v[54:57], v[6:9], v[30:33], v[54:57]
    v_mfma_f32_16x16x32_bf16 v[58:61], v[10:13], v[30:33], v[58:61]
    v_mfma_f32_16x16x32_bf16 v[62:65], v[6:9], v[34:37], v[62:65]
    v_mfma_f32_16x16x32_bf16 v[66:69], v[10:13], v[34:37], v[66:69]
    v_mfma_f32_16x16x32_bf16 v[70:73], v[6:9], v[38:41], v[70:73]
    v_mfma_f32_16x16x32_bf16 v[74:77], v[10:13], v[38:41], v[74:77]
    s_waitcnt lgkmcnt(0)
    ds_read_b64_tr_b16 v[30:31], v18 offset:4096
    ds_read_b64_tr_b16 v[32:33], v18 offset:4608
    ds_read_b64_tr_b16 v[34:35], v19 offset:4096
    ds_read_b64_tr_b16 v[36:37], v19 offset:4608
    ds_read_b64_tr_b16 v[38:39], v20
    ds_read_b64_tr_b16 v[40:41], v21
    v_mfma_f32_16x16x32_bf16 v[78:81], v[6:9], v[42:45], v[78:81]
    v_mfma_f32_16x16x32_bf16 v[82:85], v[10:13], v[42:45], v[82:85]
    v_mfma_f32_16x16x32_bf16 v[86:89], v[6:9], v[46:49], v[86:89]
    v_mfma_f32_16x16x32_bf16 v[90:93], v[10:13], v[46:49], v[90:93]
    v_mfma_f32_16x16x32_bf16 v[94:97], v[6:9], v[50:53], v[94:97]
    v_mfma_f32_16x16x32_bf16 v[98:101], v[10:13], v[50:53], v[98:101]
    s_waitcnt lgkmcnt(0)
    s_waitcnt vmcnt(20)
    s_barrier
    v_add_u32 v14, 17408, v14
    v_add_u32 v16, 17408, v16
    v_add_u32 v17, 17408, v17
    v_add_u32 v18, 17408, v18
    v_add_u32 v19, 17408, v19
    v_add_u32 v20, 17408, v20
    v_add_u32 v21, 17408, v21
    ds_read_b128 v[22:25], v14 offset:0
    ds_read_b128 v[26:29], v14 offset:1024
    ds_read_b64_tr_b16 v[42:43], v16 offset:0
    ds_read_b64_tr_b16 v[44:45], v16 offset:512
    ds_read_b64_tr_b16 v[46:47], v17 offset:0
    ds_read_b64_tr_b16 v[48:49], v17 offset:512
    ds_read_b64_tr_b16 v[50:51], v18 offset:0
    ds_read_b64_tr_b16 v[52:53], v18 offset:512
    v_mfma_f32_16x16x32_bf16 v[102:105], v[6:9], v[30:33], v[102:105]
    v_mfma_f32_16x16x32_bf16 v[106:109], v[10:13], v[30:33], v[106:109]
    v_mfma_f32_16x16x32_bf16 v[110:113], v[6:9], v[34:37], v[110:113]
    v_mfma_f32_16x16x32_bf16 v[114:117], v[10:13], v[34:37], v[114:117]
    v_mfma_f32_16x16x32_bf16 v[118:121], v[6:9], v[38:41], v[118:121]
    v_mfma_f32_16x16x32_bf16 v[122:125], v[10:13], v[38:41], v[122:125]
    s_waitcnt lgkmcnt(0)
    ds_read_b64_tr_b16 v[30:31], v19 offset:0
    ds_read_b64_tr_b16 v[32:33], v19 offset:512
    ds_read_b64_tr_b16 v[34:35], v16 offset:4096
    ds_read_b64_tr_b16 v[36:37], v16 offset:4608
    ds_read_b64_tr_b16 v[38:39], v17 offset:4096
    ds_read_b64_tr_b16 v[40:41], v17 offset:4608
    s_add_u32 m0, s25, 69632
    s_nop 0
    buffer_load_dwordx4 v2, s[8:11], s26 offen lds
    s_add_u32 m0, s25, 73728
    s_nop 0
    buffer_load_dwordx4 v3, s[8:11], s26 offen lds
    s_add_u32 m0, s38, 69632
    s_add_u32 s28, s27, 128
    buffer_load_dwordx4 v4, s[12:15], s27 offen lds
    s_add_u32 m0, s38, 73728
    s_nop 0
    buffer_load_dwordx4 v4, s[12:15], s28 offen lds
    s_add_u32 m0, s39, 69632
    s_mov_b64 exec, 0xffff
    buffer_load_dwordx4 v5, s[12:15], s27 offen lds
    s_mov_b64 exec, -1
    s_add_u32 s26, s26, 64
    s_add_u32 s27, s27, 110592
    v_mfma_f32_16x16x32_bf16 v[54:57], v[22:25], v[42:45], v[54:57]
    v_mfma_f32_16x16x32_bf16 v[58:61], v[26:29], v[42:45], v[58:61]
    v_mfma_f32_16x16x32_bf16 v[62:65], v[22:25], v[46:49], v[62:65]
    v_mfma_f32_16x16x32_bf16 v[66:69], v[26:29], v[46:49], v[66:69]
    v_mfma_f32_16x16x32_bf16 v[70:73], v[22:25], v[50:53], v[70:73]
    v_mfma_f32_16x16x32_bf16 v[74:77], v[26:29], v[50:53], v[74:77]
    s_waitcnt lgkmcnt(0)
    ds_read_b64_tr_b16 v[42:43], v18 offset:4096
    ds_read_b64_tr_b16 v[44:45], v18 offset:4608
    ds_read_b64_tr_b16 v[46:47], v19 offset:4096
    ds_read_b64_tr_b16 v[48:49], v19 offset:4608
    ds_read_b64_tr_b16 v[50:51], v20
    ds_read_b64_tr_b16 v[52:53], v21
    v_mfma_f32_16x16x32_bf16 v[78:81], v[22:25], v[30:33], v[78:81]
    v_mfma_f32_16x16x32_bf16 v[82:85], v[26:29], v[30:33], v[82:85]
    v_mfma_f32_16x16x32_bf16 v[86:89], v[22:25], v[34:37], v[86:89]
    v_mfma_f32_16x16x32_bf16 v[90:93], v[26:29], v[34:37], v[90:93]
    v_mfma_f32_16x16x32_bf16 v[94:97], v[22:25], v[38:41], v[94:97]
    v_mfma_f32_16x16x32_bf16 v[98:101], v[26:29], v[38:41], v[98:101]
    s_waitcnt lgkmcnt(0)
    s_waitcnt vmcnt(20)
    s_barrier
    v_subrev_u32 v14, 87040, v14
    v_subrev_u32 v16, 87040, v16
    v_subrev_u32 v17, 87040, v17
    v_subrev_u32 v18, 87040, v18
    v_subrev_u32 v19, 87040, v19
    v_subrev_u32 v20, 87040, v20
    v_subrev_u32 v21, 87040, v21
    ds_read_b128 v[6:9], v14 offset:0
    ds_read_b128 v[10:13], v14 offset:1024
    ds_read_b64_tr_b16 v[30:31], v16 offset:0
    ds_read_b64_tr_b16 v[32:33], v16 offset:512
    ds_read_b64_tr_b16 v[34:35], v17 offset:0
    ds_read_b64_tr_b16 v[36:37], v17 offset:512
    ds_read_b64_tr_b16 v[38:39], v18 offset:0
    ds_read_b64_tr_b16 v[40:41], v18 offset:512
    v_mfma_f32_16x16x32_bf16 v[102:105], v[22:25], v[42:45], v[102:105]
    v_mfma_f32_16x16x32_bf16 v[106:109], v[26:29], v[42:45], v[106:109]
    v_mfma_f32_16x16x32_bf16 v[110:113], v[22:25], v[46:49], v[110:113]
    v_mfma_f32_16x16x32_bf16 v[114:117], v[26:29], v[46:49], v[114:117]
    v_mfma_f32_16x16x32_bf16 v[118:121], v[22:25], v[50:53], v[118:121]
    v_mfma_f32_16x16x32_bf16 v[122:125], v[26:29], v[50:53], v[122:125]
    s_waitcnt lgkmcnt(0)
    ds_read_b64_tr_b16 v[42:43], v19 offset:0
    ds_read_b64_tr_b16 v[44:45], v19 offset:512
    ds_read_b64_tr_b16 v[46:47], v16 offset:4096
    ds_read_b64_tr_b16 v[48:49], v16 offset:4608
    ds_read_b64_tr_b16 v[50:51], v17 offset:4096
    ds_read_b64_tr_b16 v[52:53], v17 offset:4608
    s_add_u32 m0, s25, 87040
    s_nop 0
    buffer_load_dwordx4 v2, s[8:11], s26 offen lds
    s_add_u32 m0, s25, 91136
    s_nop 0
    buffer_load_dwordx4 v3, s[8:11], s26 offen lds
    s_add_u32 m0, s38, 87040
    s_add_u32 s28, s27, 128
    buffer_load_dwordx4 v4, s[12:15], s27 offen lds
    s_add_u32 m0, s38, 91136
    s_nop 0
    buffer_load_dwordx4 v4, s[12:15], s28 offen lds
    s_add_u32 m0, s39, 87040
    s_mov_b64 exec, 0xffff
    buffer_load_dwordx4 v5, s[12:15], s27 offen lds
    s_mov_b64 exec, -1
    s_add_u32 s26, s26, 64
    s_add_u32 s27, s27, 110592
    v_mfma_f32_16x16x32_bf16 v[54:57], v[6:9], v[30:33], v[54:57]
    v_mfma_f32_16x16x32_bf16 v[58:61], v[10:13], v[30:33], v[58:61]
    v_mfma_f32_16x16x32_bf16 v[62:65], v[6:9], v[34:37], v[62:65]
    v_mfma_f32_16x16x32_bf16 v[66:69], v[10:13], v[34:37], v[66:69]
    v_mfma_f32_16x16x32_bf16 v[70:73], v[6:9], v[38:41], v[70:73]
    v_mfma_f32_16x16x32_bf16 v[74:77], v[10:13], v[38:41], v[74:77]
    s_waitcnt lgkmcnt(0)
    ds_read_b64_tr_b16 v[30:31], v18 offset:4096
    ds_read_b64_tr_b16 v[32:33], v18 offset:4608
    ds_read_b64_tr_b16 v[34:35], v19 offset:4096
    ds_read_b64_tr_b16 v[36:37], v19 offset:4608
    ds_read_b64_tr_b16 v[38:39], v20
    ds_read_b64_tr_b16 v[40:41], v21
    v_mfma_f32_16x16x32_bf16 v[78:81], v[6:9], v[42:45], v[78:81]
    v_mfma_f32_16x16x32_bf16 v[82:85], v[10:13], v[42:45], v[82:85]
    v_mfma_f32_16x16x32_bf16 v[86:89], v[6:9], v[46:49], v[86:89]
    v_mfma_f32_16x16x32_bf16 v[90:93], v[10:13], v[46:49], v[90:93]
    v_mfma_f32_16x16x32_bf16 v[94:97], v[6:9], v[50:53], v[94:97]
    v_mfma_f32_16x16x32_bf16 v[98:101], v[10:13], v[50:53], v[98:101]
    s_waitcnt lgkmcnt(0)
    s_waitcnt vmcnt(20)
    s_barrier
    v_add_u32 v14, 17408, v14
    v_add_u32 v16, 17408, v16
    v_add_u32 v17, 17408, v17
    v_add_u32 v18, 17408, v18
    v_add_u32 v19, 17408, v19
    v_add_u32 v20, 17408, v20
    v_add_u32 v21, 17408, v21
    ds_read_b128 v[22:25], v14 offset:0
    ds_read_b128 v[26:29], v14 offset:1024
    ds_read_b64_tr_b16 v[42:43], v16 offset:0
    ds_read_b64_tr_b16 v[44:45], v16 offset:512
    ds_read_b64_tr_b16 v[46:47], v17 offset:0
    ds_read_b64_tr_b16 v[48:49], v17 offset:512
    ds_read_b64_tr_b16 v[50:51], v18 offset:0
    ds_read_b64_tr_b16 v[52:53], v18 offset:512
    v_mfma_f32_16x16x32_bf16 v[102:105], v[6:9], v[30:33], v[102:105]
    v_mfma_f32_16x16x32_bf16 v[106:109], v[10:13], v[30:33], v[106:109]
    v_mfma_f32_16x16x32_bf16 v[110:113], v[6:9], v[34:37], v[110:113]
    v_mfma_f32_16x16x32_bf16 v[114:117], v[10:13], v[34:37], v[114:117]
    v_mfma_f32_16x16x32_bf16 v[118:121], v[6:9], v[38:41], v[118:121]
    v_mfma_f32_16x16x32_bf16 v[122:125], v[10:13], v[38:41], v[122:125]
    s_mov_b32 s37, 0
qkvv_loop:
    s_waitcnt lgkmcnt(0)
    ds_read_b64_tr_b16 v[30:31], v19 offset:0
    ds_read_b64_tr_b16 v[32:33], v19 offset:512
    ds_read_b64_tr_b16 v[34:35], v16 offset:4096
    ds_read_b64_tr_b16 v[36:37], v16 offset:4608
    ds_read_b64_tr_b16 v[38:39], v17 offset:4096
    ds_read_b64_tr_b16 v[40:41], v17 offset:4608
    s_add_u32 m0, s25, 0
    s_nop 0
    buffer_load_dwordx4 v2, s[8:11], s26 offen lds
    s_add_u32 m0, s25, 4096
    s_nop 0
    buffer_load_dwordx4 v3, s[8:11], s26 offen lds
    s_add_u32 m0, s38, 0
    s_add_u32 s28, s27, 128
    buffer_load_dwordx4 v4, s[12:15], s27 offen lds
    s_add_u32 m0, s38, 4096
    s_nop 0
    buffer_load_dwordx4 v4, s[12:15], s28 offen lds
    s_add_u32 m0, s39, 0
    s_mov_b64 exec, 0xffff
    buffer_load_dwordx4 v5, s[12:15], s27 offen lds
    s_mov_b64 exec, -1
    s_add_u32 s26, s26, 64
    s_add_u32 s27, s27, 110592
    v_mfma_f32_16x16x32_bf16 v[54:57], v[22:25], v[42:45], v[54:57]
    v_mfma_f32_16x16x32_bf16 v[58:61], v[26:29], v[42:45], v[58:61]
    v_mfma_f32_16x16x32_bf16 v[62:65], v[22:25], v[46:49], v[62:65]
    v_mfma_f32_16x16x32_bf16 v[66:69], v[26:29], v[46:49], v[66:69]
    v_mfma_f32_16x16x32_bf16 v[70:73], v[22:25], v[50:53], v[70:73]
    v_mfma_f32_16x16x32_bf16 v[74:77], v[26:29], v[50:53], v[74:77]
    s_waitcnt lgkmcnt(0)
    ds_read_b64_tr_b16 v[42:43], v18 offset:4096
    ds_read_b64_tr_b16 v[44:45], v18 offset:4608
    ds_read_b64_tr_b16 v[46:47], v19 offset:4096
    ds_read_b64_tr_b16 v[48:49], v19 offset:4608
    ds_read_b64_tr_b16 v[50:51], v20
    ds_read_b64_tr_b16 v[52:53], v21
    v_mfma_f32_16x16x32_bf16 v[78:81], v[22:25], v[30:33], v[78:81]
    v_mfma_f32_16x16x32_bf16 v[82:85], v[26:29], v[30:33], v[82:85]
    v_mfma_f32_16x16x32_bf16 v[86:89], v[22:25], v[34:37], v[86:89]
    v_mfma_f32_16x16x32_bf16 v[90:93], v[26:29], v[34:37], v[90:93]
    v_mfma_f32_16x16x32_bf16 v[94:97], v[22:25], v[38:41], v[94:97]
    v_mfma_f32_16x16x32_bf16 v[98:101], v[26:29], v[38:41], v[98:101]
    s_waitcnt lgkmcnt(0)
    s_waitcnt vmcnt(20)
    s_barrier
    v_add_u32 v14, 17408, v14
    v_add_u32 v16, 17408, v16
    v_add_u32 v17, 17408, v17
    v_add_u32 v18, 17408, v18
    v_add_u32 v19, 17408, v19
    v_add_u32 v20, 17408, v20
    v_add_u32 v21, 17408, v21
    ds_read_b128 v[6:9], v14 offset:0
    ds_read_b128 v[10:13], v14 offset:1024
    ds_read_b64_tr_b16 v[30:31], v16 offset:0
    ds_read_b64_tr_b16 v[32:33], v16 offset:512
    ds_read_b64_tr_b16 v[34:35], v17 offset:0
    ds_read_b64_tr_b16 v[36:37], v17 offset:512
    ds_read_b64_tr_b16 v[38:39], v18 offset:0
    ds_read_b64_tr_b16 v[40:41], v18 offset:512
    v_mfma_f32_16x16x32_bf16 v[102:105], v[22:25], v[42:45], v[102:105]
    v_mfma_f32_16x16x32_bf16 v[106:109], v[26:29], v[42:45], v[106:109]
    v_mfma_f32_16x16x32_bf16 v[110:113], v[22:25], v[46:49], v[110:113]
    v_mfma_f32_16x16x32_bf16 v[114:117], v[26:29], v[46:49], v[114:117]
    v_mfma_f32_16x16x32_bf16 v[118:121], v[22:25], v[50:53], v[118:121]
    v_mfma_f32_16x16x32_bf16 v[122:125], v[26:29], v[50:53], v[122:125]
    s_waitcnt lgkmcnt(0)
    ds_read_b64_tr_b16 v[42:43], v19 offset:0
    ds_read_b64_tr_b16 v[44:45], v19 offset:512
    ds_read_b64_tr_b16 v[46:47], v16 offset:4096
    ds_read_b64_tr_b16 v[48:49], v16 offset:4608
    ds_read_b64_tr_b16 v[50:51], v17 offset:4096
    ds_read_b64_tr_b16 v[52:53], v17 offset:4608
    s_add_u32 m0, s25, 17408
    s_nop 0
    buffer_load_dwordx4 v2, s[8:11], s26 offen lds
    s_add_u32 m0, s25, 21504
    s_nop 0
    buffer_load_dwordx4 v3, s[8:11], s26 offen lds
    s_add_u32 m0, s38, 17408
    s_add_u32 s28, s27, 128
    buffer_load_dwordx4 v4, s[12:15], s27 offen lds
    s_add_u32 m0, s38, 21504
    s_nop 0
    buffer_load_dwordx4 v4, s[12:15], s28 offen lds
    s_add_u32 m0, s39, 17408
    s_mov_b64 exec, 0xffff
    buffer_load_dwordx4 v5, s[12:15], s27 offen lds
    s_mov_b64 exec, -1
    s_add_u32 s26, s26, 64
    s_add_u32 s27, s27, 110592
    v_mfma_f32_16x16x32_bf16 v[54:57], v[6:9], v[30:33], v[54:57]
    v_mfma_f32_16x16x32_bf16 v[58:61], v[10:13], v[30:33], v[58:61]
    v_mfma_f32_16x16x32_bf16 v[62:65], v[6:9], v[34:37], v[62:65]
    v_mfma_f32_16x16x32_bf16 v[66:69], v[10:13], v[34:37], v[66:69]
    v_mfma_f32_16x16x32_bf16 v[70:73], v[6:9], v[38:41], v[70:73]
    v_mfma_f32_16x16x32_bf16 v[74:77], v[10:13], v[38:41], v[74:77]
    s_waitcnt lgkmcnt(0)
    ds_read_b64_tr_b16 v[30:31], v18 offset:4096
    ds_read_b64_tr_b16 v[32:33], v18 offset:4608
    ds_read_b64_tr_b16 v[34:35], v19 offset:4096
    ds_read_b64_tr_b16 v[36:37], v19 offset:4608
    ds_read_b64_tr_b16 v[38:39], v20
    ds_read_b64_tr_b16 v[40:41], v21
    v_mfma_f32_16x16x32_bf16 v[78:81], v[6:9], v[42:45], v[78:81]
    v_mfma_f32_16x16x32_bf16 v[82:85], v[10:13], v[42:45], v[82:85]
    v_mfma_f32_16x16x32_bf16 v[86:89], v[6:9], v[46:49], v[86:89]
    v_mfma_f32_16x16x32_bf16 v[90:93], v[10:13], v[46:49], v[90:93]
    v_mfma_f32_16x16x32_bf16 v[94:97], v[6:9], v[50:53], v[94:97]
    v_mfma_f32_16x16x32_bf16 v[98:101], v[10:13], v[50:53], v[98:101]
    s_waitcnt lgkmcnt(0)
    s_waitcnt vmcnt(20)
    s_barrier
    v_add_u32 v14, 17408, v14
    v_add_u32 v16, 17408, v16
    v_add_u32 v17, 17408, v17
    v_add_u32 v18, 17408, v18
    v_add_u32 v19, 17408, v19
    v_add_u32 v20, 17408, v20
    v_add_u32 v21, 17408, v21
    ds_read_b128 v[22:25], v14 offset:0
    ds_read_b128 v[26:29], v14 offset:1024
    ds_read_b64_tr_b16 v[42:43], v16 offset:0
    ds_read_b64_tr_b16 v[44:45], v16 offset:512
    ds_read_b64_tr_b16 v[46:47], v17 offset:0
    ds_read_b64_tr_b16 v[48:49], v17 offset:512
    ds_read_b64_tr_b16 v[50:51], v18 offset:0
    ds_read_b64_tr_b16 v[52:53], v18 offset:512
    v_mfma_f32_16x16x32_bf16 v[102:105], v[6:9], v[30:33], v[102:105]
    v_mfma_f32_16x16x32_bf16 v[106:109], v[10:13], v[30:33], v[106:109]
    v_mfma_f32_16x16x32_bf16 v[110:113], v[6:9], v[34:37], v[110:113]
    v_mfma_f32_16x16x32_bf16 v[114:117], v[10:13], v[34:37], v[114:117]
    v_mfma_f32_16x16x32_bf16 v[118:121], v[6:9], v[38:41], v[118:121]
    v_mfma_f32_16x16x32_bf16 v[122:125], v[10:13], v[38:41], v[122:125]
    s_waitcnt lgkmcnt(0)
    ds_read_b64_tr_b16 v[30:31], v19 offset:0
    ds_read_b64_tr_b16 v[32:33], v19 offset:512
    ds_read_b64_tr_b16 v[34:35], v16 offset:4096
    ds_read_b64_tr_b16 v[36:37], v16 offset:4608
    ds_read_b64_tr_b16 v[38:39], v17 offset:4096
    ds_read_b64_tr_b16 v[40:41], v17 offset:4608
    s_add_u32 m0, s25, 34816
    s_nop 0
    buffer_load_dwordx4 v2, s[8:11], s26 offen lds
    s_add_u32 m0, s25, 38912
    s_nop 0
    buffer_load_dwordx4 v3, s[8:11], s26 offen lds
    s_add_u32 m0, s38, 34816
    s_add_u32 s28, s27, 128
    buffer_load_dwordx4 v4, s[12:15], s27 offen lds
    s_add_u32 m0, s38, 38912
    s_nop 0
    buffer_load_dwordx4 v4, s[12:15], s28 offen lds
    s_add_u32 m0, s39, 34816
    s_mov_b64 exec, 0xffff
    buffer_load_dwordx4 v5, s[12:15], s27 offen lds
    s_mov_b64 exec, -1
    s_add_u32 s26, s26, 64
    s_add_u32 s27, s27, 110592
    v_mfma_f32_16x16x32_bf16 v[54:57], v[22:25], v[42:45], v[54:57]
    v_mfma_f32_16x16x32_bf16 v[58:61], v[26:29], v[42:45], v[58:61]
    v_mfma_f32_16x16x32_bf16 v[62:65], v[22:25], v[46:49], v[62:65]
    v_mfma_f32_16x16x32_bf16 v[66:69], v[26:29], v[46:49], v[66:69]
    v_mfma_f32_16x16x32_bf16 v[70:73], v[22:25], v[50:53], v[70:73]
    v_mfma_f32_16x16x32_bf16 v[74:77], v[26:29], v[50:53], v[74:77]
    s_waitcnt lgkmcnt(0)
    ds_read_b64_tr_b16 v[42:43], v18 offset:4096
    ds_read_b64_tr_b16 v[44:45], v18 offset:4608
    ds_read_b64_tr_b16 v[46:47], v19 offset:4096
    ds_read_b64_tr_b16 v[48:49], v19 offset:4608
    ds_read_b64_tr_b16 v[50:51], v20
    ds_read_b64_tr_b16 v[52:53], v21
    v_mfma_f32_16x16x32_bf16 v[78:81], v[22:25], v[30:33], v[78:81]
    v_mfma_f32_16x16x32_bf16 v[82:85], v[26:29], v[30:33], v[82:85]
    v_mfma_f32_16x16x32_bf16 v[86:89], v[22:25], v[34:37], v[86:89]
    v_mfma_f32_16x16x32_bf16 v[90:93], v[26:29], v[34:37], v[90:93]
    v_mfma_f32_16x16x32_bf16 v[94:97], v[22:25], v[38:41], v[94:97]
    v_mfma_f32_16x16x32_bf16 v[98:101], v[26:29], v[38:41], v[98:101]
    s_waitcnt lgkmcnt(0)
    s_waitcnt vmcnt(20)
    s_barrier
    v_add_u32 v14, 17408, v14
    v_add_u32 v16, 17408, v16
    v_add_u32 v17, 17408, v17
    v_add_u32 v18, 17408, v18
    v_add_u32 v19, 17408, v19
    v_add_u32 v20, 17408, v20
    v_add_u32 v21, 17408, v21
    ds_read_b128 v[6:9], v14 offset:0
    ds_read_b128 v[10:13], v14 offset:1024
    ds_read_b64_tr_b16 v[30:31], v16 offset:0
    ds_read_b64_tr_b16 v[32:33], v16 offset:512
    ds_read_b64_tr_b16 v[34:35], v17 offset:0
    ds_read_b64_tr_b16 v[36:37], v17 offset:512
    ds_read_b64_tr_b16 v[38:39], v18 offset:0
    ds_read_b64_tr_b16 v[40:41], v18 offset:512
    v_mfma_f32_16x16x32_bf16 v[102:105], v[22:25], v[42:45], v[102:105]
    v_mfma_f32_16x16x32_bf16 v[106:109], v[26:29], v[42:45], v[106:109]
    v_mfma_f32_16x16x32_bf16 v[110:113], v[22:25], v[46:49], v[110:113]
    v_mfma_f32_16x16x32_bf16 v[114:117], v[26:29], v[46:49], v[114:117]
    v_mfma_f32_16x16x32_bf16 v[118:121], v[22:25], v[50:53], v[118:121]
    v_mfma_f32_16x16x32_bf16 v[122:125], v[26:29], v[50:53], v[122:125]
    s_waitcnt lgkmcnt(0)
    ds_read_b64_tr_b16 v[42:43], v19 offset:0
    ds_read_b64_tr_b16 v[44:45], v19 offset:512
    ds_read_b64_tr_b16 v[46:47], v16 offset:4096
    ds_read_b64_tr_b16 v[48:49], v16 offset:4608
    ds_read_b64_tr_b16 v[50:51], v17 offset:4096
    ds_read_b64_tr_b16 v[52:53], v17 offset:4608
    s_add_u32 m0, s25, 52224
    s_nop 0
    buffer_load_dwordx4 v2, s[8:11], s26 offen lds
    s_add_u32 m0, s25, 56320
    s_nop 0
    buffer_load_dwordx4 v3, s[8:11], s26 offen lds
    s_add_u32 m0, s38, 52224
    s_add_u32 s28, s27, 128
    buffer_load_dwordx4 v4, s[12:15], s27 offen lds
    s_add_u32 m0, s38, 56320
    s_nop 0
    buffer_load_dwordx4 v4, s[12:15], s28 offen lds
    s_add_u32 m0, s39, 52224
    s_mov_b64 exec, 0xffff
    buffer_load_dwordx4 v5, s[12:15], s27 offen lds
    s_mov_b64 exec, -1
    s_add_u32 s26, s26, 64
    s_add_u32 s27, s27, 110592
    v_mfma_f32_16x16x32_bf16 v[54:57], v[6:9], v[30:33], v[54:57]
    v_mfma_f32_16x16x32_bf16 v[58:61], v[10:13], v[30:33], v[58:61]
    v_mfma_f32_16x16x32_bf16 v[62:65], v[6:9], v[34:37], v[62:65]
    v_mfma_f32_16x16x32_bf16 v[66:69], v[10:13], v[34:37], v[66:69]
    v_mfma_f32_16x16x32_bf16 v[70:73], v[6:9], v[38:41], v[70:73]
    v_mfma_f32_16x16x32_bf16 v[74:77], v[10:13], v[38:41], v[74:77]
    s_waitcnt lgkmcnt(0)
    ds_read_b64_tr_b16 v[30:31], v18 offset:4096
    ds_read_b64_tr_b16 v[32:33], v18 offset:4608
    ds_read_b64_tr_b16 v[34:35], v19 offset:4096
    ds_read_b64_tr_b16 v[36:37], v19 offset:4608
    ds_read_b64_tr_b16 v[38:39], v20
    ds_read_b64_tr_b16 v[40:41], v21
    v_mfma_f32_16x16x32_bf16 v[78:81], v[6:9], v[42:45], v[78:81]
    v_mfma_f32_16x16x32_bf16 v[82:85], v[10:13], v[42:45], v[82:85]
    v_mfma_f32_16x16x32_bf16 v[86:89], v[6:9], v[46:49], v[86:89]
    v_mfma_f32_16x16x32_bf16 v[90:93], v[10:13], v[46:49], v[90:93]
    v_mfma_f32_16x16x32_bf16 v[94:97], v[6:9], v[50:53], v[94:97]
    v_mfma_f32_16x16x32_bf16 v[98:101], v[10:13], v[50:53], v[98:101]
    s_waitcnt lgkmcnt(0)
    s_waitcnt vmcnt(20)
    s_barrier
    v_add_u32 v14, 17408, v14
    v_add_u32 v16, 17408, v16
    v_add_u32 v17, 17408, v17
    v_add_u32 v18, 17408, v18
    v_add_u32 v19, 17408, v19
    v_add_u32 v20, 17408, v20
    v_add_u32 v21, 17408, v21
    ds_read_b128 v[22:25], v14 offset:0
    ds_read_b128 v[26:29], v14 offset:1024
    ds_read_b64_tr_b16 v[42:43], v16 offset:0
    ds_read_b64_tr_b16 v[44:45], v16 offset:512
    ds_read_b64_tr_b16 v[46:47], v17 offset:0
    ds_read_b64_tr_b16 v[48:49], v17 offset:512
    ds_read_b64_tr_b16 v[50:51], v18 offset:0
    ds_read_b64_tr_b16 v[52:53], v18 offset:512
    v_mfma_f32_16x16x32_bf16 v[102:105], v[6:9], v[30:33], v[102:105]
    v_mfma_f32_16x16x32_bf16 v[106:109], v[10:13], v[30:33], v[106:109]
    v_mfma_f32_16x16x32_bf16 v[110:113], v[6:9], v[34:37], v[110:113]
    v_mfma_f32_16x16x32_bf16 v[114:117], v[10:13], v[34:37], v[114:117]
    v_mfma_f32_16x16x32_bf16 v[118:121], v[6:9], v[38:41], v[118:121]
    v_mfma_f32_16x16x32_bf16 v[122:125], v[10:13], v[38:41], v[122:125]
    s_waitcnt lgkmcnt(0)
    ds_read_b64_tr_b16 v[30:31], v19 offset:0
    ds_read_b64_tr_b16 v[32:33], v19 offset:512
    ds_read_b64_tr_b16 v[34:35], v16 offset:4096
    ds_read_b64_tr_b16 v[36:37], v16 offset:4608
    ds_read_b64_tr_b16 v[38:39], v17 offset:4096
    ds_read_b64_tr_b16 v[40:41], v17 offset:4608
    s_add_u32 m0, s25, 69632
    s_nop 0
    buffer_load_dwordx4 v2, s[8:11], s26 offen lds
    s_add_u32 m0, s25, 73728
    s_nop 0
    buffer_load_dwordx4 v3, s[8:11], s26 offen lds
    s_add_u32 m0, s38, 69632
    s_add_u32 s28, s27, 128
    buffer_load_dwordx4 v4, s[12:15], s27 offen lds
    s_add_u32 m0, s38, 73728
    s_nop 0
    buffer_load_dwordx4 v4, s[12:15], s28 offen lds
    s_add_u32 m0, s39, 69632
    s_mov_b64 exec, 0xffff
    buffer_load_dwordx4 v5, s[12:15], s27 offen lds
    s_mov_b64 exec, -1
    s_add_u32 s26, s26, 64
    s_add_u32 s27, s27, 110592
    v_mfma_f32_16x16x32_bf16 v[54:57], v[22:25], v[42:45], v[54:57]
    v_mfma_f32_16x16x32_bf16 v[58:61], v[26:29], v[42:45], v[58:61]
    v_mfma_f32_16x16x32_bf16 v[62:65], v[22:25], v[46:49], v[62:65]
    v_mfma_f32_16x16x32_bf16 v[66:69], v[26:29], v[46:49], v[66:69]
    v_mfma_f32_16x16x32_bf16 v[70:73], v[22:25], v[50:53], v[70:73]
    v_mfma_f32_16x16x32_bf16 v[74:77], v[26:29], v[50:53], v[74:77]
    s_waitcnt lgkmcnt(0)
    ds_read_b64_tr_b16 v[42:43], v18 offset:4096
    ds_read_b64_tr_b16 v[44:45], v18 offset:4608
    ds_read_b64_tr_b16 v[46:47], v19 offset:4096
    ds_read_b64_tr_b16 v[48:49], v19 offset:4608
    ds_read_b64_tr_b16 v[50:51], v20
    ds_read_b64_tr_b16 v[52:53], v21
    v_mfma_f32_16x16x32_bf16 v[78:81], v[22:25], v[30:33], v[78:81]
    v_mfma_f32_16x16x32_bf16 v[82:85], v[26:29], v[30:33], v[82:85]
    v_mfma_f32_16x16x32_bf16 v[86:89], v[22:25], v[34:37], v[86:89]
    v_mfma_f32_16x16x32_bf16 v[90:93], v[26:29], v[34:37], v[90:93]
    v_mfma_f32_16x16x32_bf16 v[94:97], v[22:25], v[38:41], v[94:97]
    v_mfma_f32_16x16x32_bf16 v[98:101], v[26:29], v[38:41], v[98:101]
    s_waitcnt lgkmcnt(0)
    s_waitcnt vmcnt(20)
    s_barrier
    v_subrev_u32 v14, 87040, v14
    v_subrev_u32 v16, 87040, v16
    v_subrev_u32 v17, 87040, v17
    v_subrev_u32 v18, 87040, v18
    v_subrev_u32 v19, 87040, v19
    v_subrev_u32 v20, 87040, v20
    v_subrev_u32 v21, 87040, v21
    ds_read_b128 v[6:9], v14 offset:0
    ds_read_b128 v[10:13], v14 offset:1024
    ds_read_b64_tr_b16 v[30:31], v16 offset:0
    ds_read_b64_tr_b16 v[32:33], v16 offset:512
    ds_read_b64_tr_b16 v[34:35], v17 offset:0
    ds_read_b64_tr_b16 v[36:37], v17 offset:512
    ds_read_b64_tr_b16 v[38:39], v18 offset:0
    ds_read_b64_tr_b16 v[40:41], v18 offset:512
    v_mfma_f32_16x16x32_bf16 v[102:105], v[22:25], v[42:45], v[102:105]
    v_mfma_f32_16x16x32_bf16 v[106:109], v[26:29], v[42:45], v[106:109]
    v_mfma_f32_16x16x32_bf16 v[110:113], v[22:25], v[46:49], v[110:113]
    v_mfma_f32_16x16x32_bf16 v[114:117], v[26:29], v[46:49], v[114:117]
    v_mfma_f32_16x16x32_bf16 v[118:121], v[22:25], v[50:53], v[118:121]
    v_mfma_f32_16x16x32_bf16 v[122:125], v[26:29], v[50:53], v[122:125]
    s_waitcnt lgkmcnt(0)
    ds_read_b64_tr_b16 v[42:43], v19 offset:0
    ds_read_b64_tr_b16 v[44:45], v19 offset:512
    ds_read_b64_tr_b16 v[46:47], v16 offset:4096
    ds_read_b64_tr_b16 v[48:49], v16 offset:4608
    ds_read_b64_tr_b16 v[50:51], v17 offset:4096
    ds_read_b64_tr_b16 v[52:53], v17 offset:4608
    s_add_u32 m0, s25, 87040
    s_nop 0
    buffer_load_dwordx4 v2, s[8:11], s26 offen lds
    s_add_u32 m0, s25, 91136
    s_nop 0
    buffer_load_dwordx4 v3, s[8:11], s26 offen lds
    s_add_u32 m0, s38, 87040
    s_add_u32 s28, s27, 128
    buffer_load_dwordx4 v4, s[12:15], s27 offen lds
    s_add_u32 m0, s38, 91136
    s_nop 0
    buffer_load_dwordx4 v4, s[12:15], s28 offen lds
    s_add_u32 m0, s39, 87040
    s_mov_b64 exec, 0xffff
    buffer_load_dwordx4 v5, s[12:15], s27 offen lds
    s_mov_b64 exec, -1
    s_add_u32 s26, s26, 64
    s_add_u32 s27, s27, 110592
    v_mfma_f32_16x16x32_bf16 v[54:57], v[6:9], v[30:33], v[54:57]
    v_mfma_f32_16x16x32_bf16 v[58:61], v[10:13], v[30:33], v[58:61]
    v_mfma_f32_16x16x32_bf16 v[62:65], v[6:9], v[34:37], v[62:65]
    v_mfma_f32_16x16x32_bf16 v[66:69], v[10:13], v[34:37], v[66:69]
    v_mfma_f32_16x16x32_bf16 v[70:73], v[6:9], v[38:41], v[70:73]
    v_mfma_f32_16x16x32_bf16 v[74:77], v[10:13], v[38:41], v[74:77]
    s_waitcnt lgkmcnt(0)
    ds_read_b64_tr_b16 v[30:31], v18 offset:4096
    ds_read_b64_tr_b16 v[32:33], v18 offset:4608
    ds_read_b64_tr_b16 v[34:35], v19 offset:4096
    ds_read_b64_tr_b16 v[36:37], v19 offset:4608
    ds_read_b64_tr_b16 v[38:39], v20
    ds_read_b64_tr_b16 v[40:41], v21
    v_mfma_f32_16x16x32_bf16 v[78:81], v[6:9], v[42:45], v[78:81]
    v_mfma_f32_16x16x32_bf16 v[82:85], v[10:13], v[42:45], v[82:85]
    v_mfma_f32_16x16x32_bf16 v[86:89], v[6:9], v[46:49], v[86:89]
    v_mfma_f32_16x16x32_bf16 v[90:93], v[10:13], v[46:49], v[90:93]
    v_mfma_f32_16x16x32_bf16 v[94:97], v[6:9], v[50:53], v[94:97]
    v_mfma_f32_16x16x32_bf16 v[98:101], v[10:13], v[50:53], v[98:101]
    s_waitcnt lgkmcnt(0)
    s_waitcnt vmcnt(20)
    s_barrier
    v_add_u32 v14, 17408, v14
    v_add_u32 v16, 17408, v16
    v_add_u32 v17, 17408, v17
    v_add_u32 v18, 17408, v18
    v_add_u32 v19, 17408, v19
    v_add_u32 v20, 17408, v20
    v_add_u32 v21, 17408, v21
    ds_read_b128 v[22:25], v14 offset:0
    ds_read_b128 v[26:29], v14 offset:1024
    ds_read_b64_tr_b16 v[42:43], v16 offset:0
    ds_read_b64_tr_b16 v[44:45], v16 offset:512
    ds_read_b64_tr_b16 v[46:47], v17 offset:0
    ds_read_b64_tr_b16 v[48:49], v17 offset:512
    ds_read_b64_tr_b16 v[50:51], v18 offset:0
    ds_read_b64_tr_b16 v[52:53], v18 offset:512
    v_mfma_f32_16x16x32_bf16 v[102:105], v[6:9], v[30:33], v[102:105]
    v_mfma_f32_16x16x32_bf16 v[106:109], v[10:13], v[30:33], v[106:109]
    v_mfma_f32_16x16x32_bf16 v[110:113], v[6:9], v[34:37], v[110:113]
    v_mfma_f32_16x16x32_bf16 v[114:117], v[10:13], v[34:37], v[114:117]
    v_mfma_f32_16x16x32_bf16 v[118:121], v[6:9], v[38:41], v[118:121]
    v_mfma_f32_16x16x32_bf16 v[122:125], v[10:13], v[38:41], v[122:125]
    s_add_u32 s37, s37, 1
    s_cmp_lt_u32 s37, 1
    s_cbranch_scc1 qkvv_loop
    s_waitcnt lgkmcnt(0)
    ds_read_b64_tr_b16 v[30:31], v19 offset:0
    ds_read_b64_tr_b16 v[32:33], v19 offset:512
    ds_read_b64_tr_b16 v[34:35], v16 offset:4096
    ds_read_b64_tr_b16 v[36:37], v16 offset:4608
    ds_read_b64_tr_b16 v[38:39], v17 offset:4096
    ds_read_b64_tr_b16 v[40:41], v17 offset:4608
    v_mfma_f32_16x16x32_bf16 v[54:57], v[22:25], v[42:45], v[54:57]
    v_mfma_f32_16x16x32_bf16 v[58:61], v[26:29], v[42:45], v[58:61]
    v_mfma_f32_16x16x32_bf16 v[62:65], v[22:25], v[46:49], v[62:65]
    v_mfma_f32_16x16x32_bf16 v[66:69], v[26:29], v[46:49], v[66:69]
    v_mfma_f32_16x16x32_bf16 v[70:73], v[22:25], v[50:53], v[70:73]
    v_mfma_f32_16x16x32_bf16 v[74:77], v[26:29], v[50:53], v[74:77]
    s_waitcnt lgkmcnt(0)
    ds_read_b64_tr_b16 v[42:43], v18 offset:4096
    ds_read_b64_tr_b16 v[44:45], v18 offset:4608
    ds_read_b64_tr_b16 v[46:47], v19 offset:4096
    ds_read_b64_tr_b16 v[48:49], v19 offset:4608
    ds_read_b64_tr_b16 v[50:51], v20
    ds_read_b64_tr_b16 v[52:53], v21
    v_mfma_f32_16x16x32_bf16 v[78:81], v[22:25], v[30:33], v[78:81]
    v_mfma_f32_16x16x32_bf16 v[82:85], v[26:29], v[30:33], v[82:85]
    v_mfma_f32_16x16x32_bf16 v[86:89], v[22:25], v[34:37], v[86:89]
    v_mfma_f32_16x16x32_bf16 v[90:93], v[26:29], v[34:37], v[90:93]
    v_mfma_f32_16x16x32_bf16 v[94:97], v[22:25], v[38:41], v[94:97]
    v_mfma_f32_16x16x32_bf16 v[98:101], v[26:29], v[38:41], v[98:101]
    s_waitcnt lgkmcnt(0)
    s_waitcnt vmcnt(15)
    s_barrier
    v_add_u32 v14, 17408, v14
    v_add_u32 v16, 17408, v16
    v_add_u32 v17, 17408, v17
    v_add_u32 v18, 17408, v18
    v_add_u32 v19, 17408, v19
    v_add_u32 v20, 17408, v20
    v_add_u32 v21, 17408, v21
    ds_read_b128 v[6:9], v14 offset:0
    ds_read_b128 v[10:13], v14 offset:1024
    ds_read_b64_tr_b16 v[30:31], v16 offset:0
    ds_read_b64_tr_b16 v[32:33], v16 offset:512
    ds_read_b64_tr_b16 v[34:35], v17 offset:0
    ds_read_b64_tr_b16 v[36:37], v17 offset:512
    ds_read_b64_tr_b16 v[38:39], v18 offset:0
    ds_read_b64_tr_b16 v[40:41], v18 offset:512
    v_mfma_f32_16x16x32_bf16 v[102:105], v[22:25], v[42:45], v[102:105]
    v_mfma_f32_16x16x32_bf16 v[106:109], v[26:29], v[42:45], v[106:109]
    v_mfma_f32_16x16x32_bf16 v[110:113], v[22:25], v[46:49], v[110:113]
    v_mfma_f32_16x16x32_bf16 v[114:117], v[26:29], v[46:49], v[114:117]
    v_mfma_f32_16x16x32_bf16 v[118:121], v[22:25], v[50:53], v[118:121]
    v_mfma_f32_16x16x32_bf16 v[122:125], v[26:29], v[50:53], v[122:125]
    s_waitcnt lgkmcnt(0)
    ds_read_b64_tr_b16 v[42:43], v19 offset:0
    ds_read_b64_tr_b16 v[44:45], v19 offset:512
    ds_read_b64_tr_b16 v[46:47], v16 offset:4096
    ds_read_b64_tr_b16 v[48:49], v16 offset:4608
    ds_read_b64_tr_b16 v[50:51], v17 offset:4096
    ds_read_b64_tr_b16 v[52:53], v17 offset:4608
    v_mfma_f32_16x16x32_bf16 v[54:57], v[6:9], v[30:33], v[54:57]
    v_mfma_f32_16x16x32_bf16 v[58:61], v[10:13], v[30:33], v[58:61]
    v_mfma_f32_16x16x32_bf16 v[62:65], v[6:9], v[34:37], v[62:65]
    v_mfma_f32_16x16x32_bf16 v[66:69], v[10:13], v[34:37], v[66:69]
    v_mfma_f32_16x16x32_bf16 v[70:73], v[6:9], v[38:41], v[70:73]
    v_mfma_f32_16x16x32_bf16 v[74:77], v[10:13], v[38:41], v[74:77]
    s_waitcnt lgkmcnt(0)
    ds_read_b64_tr_b16 v[30:31], v18 offset:4096
    ds_read_b64_tr_b16 v[32:33], v18 offset:4608
    ds_read_b64_tr_b16 v[34:35], v19 offset:4096
    ds_read_b64_tr_b16 v[36:37], v19 offset:4608
    ds_read_b64_tr_b16 v[38:39], v20
    ds_read_b64_tr_b16 v[40:41], v21
    v_mfma_f32_16x16x32_bf16 v[78:81], v[6:9], v[42:45], v[78:81]
    v_mfma_f32_16x16x32_bf16 v[82:85], v[10:13], v[42:45], v[82:85]
    v_mfma_f32_16x16x32_bf16 v[86:89], v[6:9], v[46:49], v[86:89]
    v_mfma_f32_16x16x32_bf16 v[90:93], v[10:13], v[46:49], v[90:93]
    v_mfma_f32_16x16x32_bf16 v[94:97], v[6:9], v[50:53], v[94:97]
    v_mfma_f32_16x16x32_bf16 v[98:101], v[10:13], v[50:53], v[98:101]
    s_waitcnt lgkmcnt(0)
    s_waitcnt vmcnt(10)
    s_barrier
    v_add_u32 v14, 17408, v14
    v_add_u32 v16, 17408, v16
    v_add_u32 v17, 17408, v17
    v_add_u32 v18, 17408, v18
    v_add_u32 v19, 17408, v19
    v_add_u32 v20, 17408, v20
    v_add_u32 v21, 17408, v21
    ds_read_b128 v[22:25], v14 offset:0
    ds_read_b128 v[26:29], v14 offset:1024
    ds_read_b64_tr_b16 v[42:43], v16 offset:0
    ds_read_b64_tr_b16 v[44:45], v16 offset:512
    ds_read_b64_tr_b16 v[46:47], v17 offset:0
    ds_read_b64_tr_b16 v[48:49], v17 offset:512
    ds_read_b64_tr_b16 v[50:51], v18 offset:0
    ds_read_b64_tr_b16 v[52:53], v18 offset:512
    v_mfma_f32_16x16x32_bf16 v[102:105], v[6:9], v[30:33], v[102:105]
    v_mfma_f32_16x16x32_bf16 v[106:109], v[10:13], v[30:33], v[106:109]
    v_mfma_f32_16x16x32_bf16 v[110:113], v[6:9], v[34:37], v[110:113]
    v_mfma_f32_16x16x32_bf16 v[114:117], v[10:13], v[34:37], v[114:117]
    v_mfma_f32_16x16x32_bf16 v[118:121], v[6:9], v[38:41], v[118:121]
    v_mfma_f32_16x16x32_bf16 v[122:125], v[10:13], v[38:41], v[122:125]
    s_waitcnt lgkmcnt(0)
    ds_read_b64_tr_b16 v[30:31], v19 offset:0
    ds_read_b64_tr_b16 v[32:33], v19 offset:512
    ds_read_b64_tr_b16 v[34:35], v16 offset:4096
    ds_read_b64_tr_b16 v[36:37], v16 offset:4608
    ds_read_b64_tr_b16 v[38:39], v17 offset:4096
    ds_read_b64_tr_b16 v[40:41], v17 offset:4608
    v_mfma_f32_16x16x32_bf16 v[54:57], v[22:25], v[42:45], v[54:57]
    v_mfma_f32_16x16x32_bf16 v[58:61], v[26:29], v[42:45], v[58:61]
    v_mfma_f32_16x16x32_bf16 v[62:65], v[22:25], v[46:49], v[62:65]
    v_mfma_f32_16x16x32_bf16 v[66:69], v[26:29], v[46:49], v[66:69]
    v_mfma_f32_16x16x32_bf16 v[70:73], v[22:25], v[50:53], v[70:73]
    v_mfma_f32_16x16x32_bf16 v[74:77], v[26:29], v[50:53], v[74:77]
    s_waitcnt lgkmcnt(0)
    ds_read_b64_tr_b16 v[42:43], v18 offset:4096
    ds_read_b64_tr_b16 v[44:45], v18 offset:4608
    ds_read_b64_tr_b16 v[46:47], v19 offset:4096
    ds_read_b64_tr_b16 v[48:49], v19 offset:4608
    ds_read_b64_tr_b16 v[50:51], v20
    ds_read_b64_tr_b16 v[52:53], v21
    v_mfma_f32_16x16x32_bf16 v[78:81], v[22:25], v[30:33], v[78:81]
    v_mfma_f32_16x16x32_bf16 v[82:85], v[26:29], v[30:33], v[82:85]
    v_mfma_f32_16x16x32_bf16 v[86:89], v[22:25], v[34:37], v[86:89]
    v_mfma_f32_16x16x32_bf16 v[90:93], v[26:29], v[34:37], v[90:93]
    v_mfma_f32_16x16x32_bf16 v[94:97], v[22:25], v[38:41], v[94:97]
    v_mfma_f32_16x16x32_bf16 v[98:101], v[26:29], v[38:41], v[98:101]
    s_waitcnt lgkmcnt(0)
    s_waitcnt vmcnt(5)
    s_barrier
    v_add_u32 v14, 17408, v14
    v_add_u32 v16, 17408, v16
    v_add_u32 v17, 17408, v17
    v_add_u32 v18, 17408, v18
    v_add_u32 v19, 17408, v19
    v_add_u32 v20, 17408, v20
    v_add_u32 v21, 17408, v21
    ds_read_b128 v[6:9], v14 offset:0
    ds_read_b128 v[10:13], v14 offset:1024
    ds_read_b64_tr_b16 v[30:31], v16 offset:0
    ds_read_b64_tr_b16 v[32:33], v16 offset:512
    ds_read_b64_tr_b16 v[34:35], v17 offset:0
    ds_read_b64_tr_b16 v[36:37], v17 offset:512
    ds_read_b64_tr_b16 v[38:39], v18 offset:0
    ds_read_b64_tr_b16 v[40:41], v18 offset:512
    v_mfma_f32_16x16x32_bf16 v[102:105], v[22:25], v[42:45], v[102:105]
    v_mfma_f32_16x16x32_bf16 v[106:109], v[26:29], v[42:45], v[106:109]
    v_mfma_f32_16x16x32_bf16 v[110:113], v[22:25], v[46:49], v[110:113]
    v_mfma_f32_16x16x32_bf16 v[114:117], v[26:29], v[46:49], v[114:117]
    v_mfma_f32_16x16x32_bf16 v[118:121], v[22:25], v[50:53], v[118:121]
    v_mfma_f32_16x16x32_bf16 v[122:125], v[26:29], v[50:53], v[122:125]
    s_waitcnt lgkmcnt(0)
    ds_read_b64_tr_b16 v[42:43], v19 offset:0
    ds_read_b64_tr_b16 v[44:45], v19 offset:512
    ds_read_b64_tr_b16 v[46:47], v16 offset:4096
    ds_read_b64_tr_b16 v[48:49], v16 offset:4608
    ds_read_b64_tr_b16 v[50:51], v17 offset:4096
    ds_read_b64_tr_b16 v[52:53], v17 offset:4608
    v_mfma_f32_16x16x32_bf16 v[54:57], v[6:9], v[30:33], v[54:57]
    v_mfma_f32_16x16x32_bf16 v[58:61], v[10:13], v[30:33], v[58:61]
    v_mfma_f32_16x16x32_bf16 v[62:65], v[6:9], v[34:37], v[62:65]
    v_mfma_f32_16x16x32_bf16 v[66:69], v[10:13], v[34:37], v[66:69]
    v_mfma_f32_16x16x32_bf16 v[70:73], v[6:9], v[38:41], v[70:73]
    v_mfma_f32_16x16x32_bf16 v[74:77], v[10:13], v[38:41], v[74:77]
    s_waitcnt lgkmcnt(0)
    ds_read_b64_tr_b16 v[30:31], v18 offset:4096
    ds_read_b64_tr_b16 v[32:33], v18 offset:4608
    ds_read_b64_tr_b16 v[34:35], v19 offset:4096
    ds_read_b64_tr_b16 v[36:37], v19 offset:4608
    ds_read_b64_tr_b16 v[38:39], v20
    ds_read_b64_tr_b16 v[40:41], v21
    v_mfma_f32_16x16x32_bf16 v[78:81], v[6:9], v[42:45], v[78:81]
    v_mfma_f32_16x16x32_bf16 v[82:85], v[10:13], v[42:45], v[82:85]
    v_mfma_f32_16x16x32_bf16 v[86:89], v[6:9], v[46:49], v[86:89]
    v_mfma_f32_16x16x32_bf16 v[90:93], v[10:13], v[46:49], v[90:93]
    v_mfma_f32_16x16x32_bf16 v[94:97], v[6:9], v[50:53], v[94:97]
    v_mfma_f32_16x16x32_bf16 v[98:101], v[10:13], v[50:53], v[98:101]
    s_waitcnt lgkmcnt(0)
    s_waitcnt vmcnt(0)
    s_barrier
    v_add_u32 v14, 17408, v14
    v_add_u32 v16, 17408, v16
    v_add_u32 v17, 17408, v17
    v_add_u32 v18, 17408, v18
    v_add_u32 v19, 17408, v19
    v_add_u32 v20, 17408, v20
    v_add_u32 v21, 17408, v21
    ds_read_b128 v[22:25], v14 offset:0
    ds_read_b128 v[26:29], v14 offset:1024
    ds_read_b64_tr_b16 v[42:43], v16 offset:0
    ds_read_b64_tr_b16 v[44:45], v16 offset:512
    ds_read_b64_tr_b16 v[46:47], v17 offset:0
    ds_read_b64_tr_b16 v[48:49], v17 offset:512
    ds_read_b64_tr_b16 v[50:51], v18 offset:0
    ds_read_b64_tr_b16 v[52:53], v18 offset:512
    v_mfma_f32_16x16x32_bf16 v[102:105], v[6:9], v[30:33], v[102:105]
    v_mfma_f32_16x16x32_bf16 v[106:109], v[10:13], v[30:33], v[106:109]
    v_mfma_f32_16x16x32_bf16 v[110:113], v[6:9], v[34:37], v[110:113]
    v_mfma_f32_16x16x32_bf16 v[114:117], v[10:13], v[34:37], v[114:117]
    v_mfma_f32_16x16x32_bf16 v[118:121], v[6:9], v[38:41], v[118:121]
    v_mfma_f32_16x16x32_bf16 v[122:125], v[10:13], v[38:41], v[122:125]
    s_waitcnt lgkmcnt(0)
    ds_read_b64_tr_b16 v[30:31], v19 offset:0
    ds_read_b64_tr_b16 v[32:33], v19 offset:512
    ds_read_b64_tr_b16 v[34:35], v16 offset:4096
    ds_read_b64_tr_b16 v[36:37], v16 offset:4608
    ds_read_b64_tr_b16 v[38:39], v17 offset:4096
    ds_read_b64_tr_b16 v[40:41], v17 offset:4608
    v_mfma_f32_16x16x32_bf16 v[54:57], v[22:25], v[42:45], v[54:57]
    v_mfma_f32_16x16x32_bf16 v[58:61], v[26:29], v[42:45], v[58:61]
    v_mfma_f32_16x16x32_bf16 v[62:65], v[22:25], v[46:49], v[62:65]
    v_mfma_f32_16x16x32_bf16 v[66:69], v[26:29], v[46:49], v[66:69]
    v_mfma_f32_16x16x32_bf16 v[70:73], v[22:25], v[50:53], v[70:73]
    v_mfma_f32_16x16x32_bf16 v[74:77], v[26:29], v[50:53], v[74:77]
    s_waitcnt lgkmcnt(0)
    ds_read_b64_tr_b16 v[42:43], v18 offset:4096
    ds_read_b64_tr_b16 v[44:45], v18 offset:4608
    ds_read_b64_tr_b16 v[46:47], v19 offset:4096
    ds_read_b64_tr_b16 v[48:49], v19 offset:4608
    ds_read_b64_tr_b16 v[50:51], v20
    ds_read_b64_tr_b16 v[52:53], v21
    v_mfma_f32_16x16x32_bf16 v[78:81], v[22:25], v[30:33], v[78:81]
    v_mfma_f32_16x16x32_bf16 v[82:85], v[26:29], v[30:33], v[82:85]
    v_mfma_f32_16x16x32_bf16 v[86:89], v[22:25], v[34:37], v[86:89]
    v_mfma_f32_16x16x32_bf16 v[90:93], v[26:29], v[34:37], v[90:93]
    v_mfma_f32_16x16x32_bf16 v[94:97], v[22:25], v[38:41], v[94:97]
    v_mfma_f32_16x16x32_bf16 v[98:101], v[26:29], v[38:41], v[98:101]
    s_waitcnt lgkmcnt(0)
    v_mfma_f32_16x16x32_bf16 v[102:105], v[22:25], v[42:45], v[102:105]
    v_mfma_f32_16x16x32_bf16 v[106:109], v[26:29], v[42:45], v[106:109]
    v_mfma_f32_16x16x32_bf16 v[110:113], v[22:25], v[46:49], v[110:113]
    v_mfma_f32_16x16x32_bf16 v[114:117], v[26:29], v[46:49], v[114:117]
    v_mfma_f32_16x16x32_bf16 v[118:121], v[22:25], v[50:53], v[118:121]
    v_mfma_f32_16x16x32_bf16 v[122:125], v[26:29], v[50:53], v[122:125]
    s_nop 15
    s_nop 7
    s_lshr_b32 s26, s31, 2
    s_and_b32 s27, s31, 3
    s_mul_i32 s27, s27, 144
    s_lshl_b32 s28, s29, 5
    s_lshl_b32 s33, s30, 7
    s_add_u32 s28, s28, s33
    v_and_b32 v10, 15, v0
    v_add_u32 v10, s27, v10
    v_lshlrev_b32 v10, 12, v10
    v_bfe_u32 v11, v0, 4, 1
    v_lshrrev_b32 v12, 5, v0
    v_lshlrev_b32 v11, 4, v11
    v_lshl_add_u32 v11, v12, 3, v11
    v_add_u32 v10, v10, v11
    s_lshl_b32 s26, s28, 1
    s_add_u32 s26, s26, 4718592
    v_cvt_pk_bf16_f32 v20, v54, v55
    v_cvt_pk_bf16_f32 v21, v56, v57
    buffer_store_dwordx2 v[20:21], v10, s[20:23], s26 offen offset:0
    v_cvt_pk_bf16_f32 v22, v58, v59
    v_cvt_pk_bf16_f32 v23, v60, v61
    buffer_store_dwordx2 v[22:23], v10, s[20:23], s26 offen offset:32
    v_add_u32 v10, 65536, v10
    v_cvt_pk_bf16_f32 v24, v62, v63
    v_cvt_pk_bf16_f32 v25, v64, v65
    buffer_store_dwordx2 v[24:25], v10, s[20:23], s26 offen offset:0
    v_cvt_pk_bf16_f32 v26, v66, v67
    v_cvt_pk_bf16_f32 v27, v68, v69
    buffer_store_dwordx2 v[26:27], v10, s[20:23], s26 offen offset:32
    v_add_u32 v10, 65536, v10
    v_cvt_pk_bf16_f32 v28, v70, v71
    v_cvt_pk_bf16_f32 v29, v72, v73
    buffer_store_dwordx2 v[28:29], v10, s[20:23], s26 offen offset:0
    v_cvt_pk_bf16_f32 v30, v74, v75
    v_cvt_pk_bf16_f32 v31, v76, v77
    buffer_store_dwordx2 v[30:31], v10, s[20:23], s26 offen offset:32
    v_add_u32 v10, 65536, v10
    v_cvt_pk_bf16_f32 v32, v78, v79
    v_cvt_pk_bf16_f32 v33, v80, v81
    buffer_store_dwordx2 v[32:33], v10, s[20:23], s26 offen offset:0
    v_cvt_pk_bf16_f32 v34, v82, v83
    v_cvt_pk_bf16_f32 v35, v84, v85
    buffer_store_dwordx2 v[34:35], v10, s[20:23], s26 offen offset:32
    v_add_u32 v10, 65536, v10
    v_cvt_pk_bf16_f32 v20, v86, v87
    v_cvt_pk_bf16_f32 v21, v88, v89
    buffer_store_dwordx2 v[20:21], v10, s[20:23], s26 offen offset:0
    v_cvt_pk_bf16_f32 v22, v90, v91
    v_cvt_pk_bf16_f32 v23, v92, v93
    buffer_store_dwordx2 v[22:23], v10, s[20:23], s26 offen offset:32
    v_add_u32 v10, 65536, v10
    v_cvt_pk_bf16_f32 v24, v94, v95
    v_cvt_pk_bf16_f32 v25, v96, v97
    buffer_store_dwordx2 v[24:25], v10, s[20:23], s26 offen offset:0
    v_cvt_pk_bf16_f32 v26, v98, v99
    v_cvt_pk_bf16_f32 v27, v100, v101
    buffer_store_dwordx2 v[26:27], v10, s[20:23], s26 offen offset:32
    v_add_u32 v10, 65536, v10
    v_cvt_pk_bf16_f32 v28, v102, v103
    v_cvt_pk_bf16_f32 v29, v104, v105
    buffer_store_dwordx2 v[28:29], v10, s[20:23], s26 offen offset:0
    v_cvt_pk_bf16_f32 v30, v106, v107
    v_cvt_pk_bf16_f32 v31, v108, v109
    buffer_store_dwordx2 v[30:31], v10, s[20:23], s26 offen offset:32
    v_add_u32 v10, 65536, v10
    v_cvt_pk_bf16_f32 v32, v110, v111
    v_cvt_pk_bf16_f32 v33, v112, v113
    buffer_store_dwordx2 v[32:33], v10, s[20:23], s26 offen offset:0
    v_cvt_pk_bf16_f32 v34, v114, v115
    v_cvt_pk_bf16_f32 v35, v116, v117
    buffer_store_dwordx2 v[34:35], v10, s[20:23], s26 offen offset:32
    v_add_u32 v10, 65536, v10
    v_cvt_pk_bf16_f32 v20, v118, v119
    v_cvt_pk_bf16_f32 v21, v120, v121
    buffer_store_dwordx2 v[20:21], v10, s[20:23], s26 offen offset:0
    v_cvt_pk_bf16_f32 v22, v122, v123
    v_cvt_pk_bf16_f32 v23, v124, v125
    buffer_store_dwordx2 v[22:23], v10, s[20:23], s26 offen offset:32
qkv_done:
    s_endpgm
    .globl l2_kernel
    .p2align 8
    .type l2_kernel,@function
l2_kernel:
    s_cmp_lt_u32 s2, 256
    s_cbranch_scc1 l2_kernel_A
    s_sub_u32 s2, s2, 256
    v_cmp_lt_u32 vcc, 255, v0
    s_cbranch_vccnz l2_kernel_exit
    s_branch down_kernel_body
l2_kernel_A:
    s_branch attn_kernel_body
l2_kernel_exit:
    s_endpgm
attn_kernel_body:
    s_cmp_ge_u32 s2, 256
    s_cbranch_scc1 attn_done
    s_load_dwordx2 s[44:45], s[0:1], 80
    v_lshrrev_b32 v1, 6, v0
    s_nop 0
    v_readfirstlane_b32 s24, v1
    v_and_b32 v0, 63, v0
    s_and_b32 s30, s2, 7
    s_lshl_b32 s30, s30, 5
    s_lshr_b32 s31, s2, 3
    s_add_u32 s30, s30, s31
    s_and_b32 s31, s30, 7
    s_lshr_b32 s30, s30, 3
    s_waitcnt lgkmcnt(0)
    s_mov_b32 s8, s44
    s_mov_b32 s9, s45
    s_mov_b32 s10, 8388608
    s_mov_b32 s11, 0x00020000
    s_add_u32 s12, s44, 27262976
    s_addc_u32 s13, s45, 0
    s_mov_b32 s14, 2359296
    s_mov_b32 s15, 0x00020000
    s_mov_b32 s35, 8.0
    v_lshlrev_b32 v1, 4, v0
    s_lshl_b32 s25, s24, 10
    s_lshl_b32 s26, s30, 16
    s_add_u32 s26, s26, 2359296
    s_add_u32 s50, s26, s25
    s_add_u32 s51, s50, 32768
    s_mov_b32 s55, s25
    s_add_u32 s56, s25, 8192
    s_add_u32 s26, s24, 0
    s_mul_i32 s27, s30, 18
    s_add_u32 s27, s27, s26
    s_lshl_b32 s27, s27, 12
    s_add_u32 s27, s27, 4718592
    s_mul_i32 s28, s26, 1040
    s_add_u32 s28, s28, 18432
    s_sub_u32 s29, s26, 18
    s_lshl_b32 s29, s29, 10
    s_lshl_b32 s33, s30, 13
    s_add_u32 s33, s33, s29
    s_add_u32 s33, s33, 4456448
    s_add_u32 s29, s29, 16384
    s_cmp_lt_u32 s26, 18
    s_cselect_b32 s52, s27, s33
    s_cselect_b32 s57, s28, s29
    s_cselect_b32 s60, 1, 2
    s_lshl_b32 s60, s60, 10
    s_add_u32 s26, s24, 8
    s_mul_i32 s27, s30, 18
    s_add_u32 s27, s27, s26
    s_lshl_b32 s27, s27, 12
    s_add_u32 s27, s27, 4718592
    s_mul_i32 s28, s26, 1040
    s_add_u32 s28, s28, 18432
    s_sub_u32 s29, s26, 18
    s_lshl_b32 s29, s29, 10
    s_lshl_b32 s33, s30, 13
    s_add_u32 s33, s33, s29
    s_add_u32 s33, s33, 4456448
    s_add_u32 s29, s29, 16384
    s_cmp_lt_u32 s26, 18
    s_cselect_b32 s53, s27, s33
    s_cselect_b32 s58, s28, s29
    s_cselect_b32 s61, 1, 2
    s_lshl_b32 s61, s61, 10
    s_add_u32 s26, s24, 16
    s_cmp_ge_u32 s26, 20
    s_cselect_b32 s27, 8, 0
    s_sub_u32 s26, s26, s27
    s_mul_i32 s27, s30, 18
    s_add_u32 s27, s27, s26
    s_lshl_b32 s27, s27, 12
    s_add_u32 s27, s27, 4718592
    s_mul_i32 s28, s26, 1040
    s_add_u32 s28, s28, 18432
    s_sub_u32 s29, s26, 18
    s_lshl_b32 s29, s29, 10
    s_lshl_b32 s33, s30, 13
    s_add_u32 s33, s33, s29
    s_add_u32 s33, s33, 4456448
    s_add_u32 s29, s29, 16384
    s_cmp_lt_u32 s26, 18
    s_cselect_b32 s54, s27, s33
    s_cselect_b32 s59, s28, s29
    s_cselect_b32 s62, 1, 2
    s_lshl_b32 s62, s62, 10
    s_add_u32 m0, s55, 0
    s_nop 0
    buffer_load_dwordx4 v1, s[8:11], s50 offen lds
    s_add_u32 m0, s56, 0
    s_nop 0
    buffer_load_dwordx4 v1, s[8:11], s51 offen lds
    s_add_u32 m0, s57, 0
    s_nop 0
    buffer_load_dwordx4 v1, s[8:11], s52 offen lds
    s_add_u32 m0, s58, 0
    s_nop 0
    buffer_load_dwordx4 v1, s[8:11], s53 offen lds
    s_add_u32 m0, s59, 0
    s_nop 0
    buffer_load_dwordx4 v1, s[8:11], s54 offen lds
    s_add_u32 s50, s50, 8192
    s_add_u32 s51, s51, 8192
    s_add_u32 s52, s52, s60
    s_add_u32 s53, s53, s61
    s_add_u32 s54, s54, s62
    v_lshlrev_b32 v2, 2, v0
    v_add_u32 v2, 74752, v2
    v_mov_b32 v3, 0x3f803f80
    v_cmp_gt_u32 vcc, 16, v0
    s_nop 1
    v_cndmask_b32 v3, 0, v3, vcc
    v_cmp_gt_u32 vcc, 32, v0
    s_and_saveexec_b64 s[36:37], vcc
    ds_write_b32 v2, v3
    s_mov_b64 exec, s[36:37]
    v_and_b32 v2, 31, v0
    v_lshrrev_b32 v3, 5, v0
    s_lshl_b32 s26, s31, 8
    s_lshl_b32 s27, s24, 5
    s_add_u32 s26, s26, s27
    v_add_u32 v7, s26, v2
    s_lshl_b32 s27, s30, 1
    v_add_u32 v5, s27, v3
    v_lshlrev_b32 v5, 11, v5
    v_add_u32 v5, v5, v7
    v_lshlrev_b32 v5, 4, v5
    buffer_load_dwordx4 v[8:11], v5, s[8:11], 0 offen
    s_lshl_b32 s27, s30, 11
    v_add_u32 v5, s27, v7
    v_lshlrev_b32 v5, 2, v5
    v_add_u32 v5, 2097152, v5
    v_cmp_lt_u32 vcc, 31, v0
    v_mov_b32 v6, 0x7f000000
    s_nop 1
    v_cndmask_b32 v5, v5, v6, vcc
    buffer_load_dword v12, v5, s[8:11], 0 offen
    s_add_u32 m0, s55, 37376
    s_nop 0
    buffer_load_dwordx4 v1, s[8:11], s50 offen lds
    s_add_u32 m0, s56, 37376
    s_nop 0
    buffer_load_dwordx4 v1, s[8:11], s51 offen lds
    s_add_u32 m0, s57, 37376
    s_nop 0
    buffer_load_dwordx4 v1, s[8:11], s52 offen lds
    s_add_u32 m0, s58, 37376
    s_nop 0
    buffer_load_dwordx4 v1, s[8:11], s53 offen lds
    s_add_u32 m0, s59, 37376
    s_nop 0
    buffer_load_dwordx4 v1, s[8:11], s54 offen lds
    s_add_u32 s50, s50, 8192
    s_add_u32 s51, s51, 8192
    s_add_u32 s52, s52, s60
    s_add_u32 s53, s53, s61
    s_add_u32 s54, s54, s62
    v_mov_b32 v13, 0
    v_mov_b32 v14, 0
    v_mov_b32 v15, 0
    v_mov_b32 v21, 0
    v_mov_b32 v22, 0
    v_mov_b32 v23, 0
    v_mov_b32 v29, 0
    v_mov_b32 v30, 0
    v_mov_b32 v31, 0
    v_mov_b32 v80, 0
    v_mov_b32 v81, 0
    v_mov_b32 v82, 0
    v_mov_b32 v83, 0
    v_mov_b32 v84, 0
    v_mov_b32 v85, 0
    v_mov_b32 v86, 0
    v_mov_b32 v87, 0
    v_mov_b32 v88, 0
    v_mov_b32 v89, 0
    v_mov_b32 v90, 0
    v_mov_b32 v91, 0
    v_mov_b32 v92, 0
    v_mov_b32 v93, 0
    v_mov_b32 v94, 0
    v_mov_b32 v95, 0
    v_mov_b32 v96, 0
    v_mov_b32 v97, 0
    v_mov_b32 v98, 0
    v_mov_b32 v99, 0
    v_mov_b32 v100, 0
    v_mov_b32 v101, 0
    v_mov_b32 v102, 0
    v_mov_b32 v103, 0
    v_mov_b32 v104, 0
    v_mov_b32 v105, 0
    v_mov_b32 v106, 0
    v_mov_b32 v107, 0
    v_mov_b32 v108, 0
    v_mov_b32 v109, 0
    v_mov_b32 v110, 0
    v_mov_b32 v111, 0
    v_lshlrev_b32 v4, 13, v3
    v_lshl_add_u32 v2, v2, 4, v4
    v_and_b32 v4, 31, v0
    v_lshlrev_b32 v4, 2, v4
    v_add_u32 v4, 16384, v4
    v_mov_b32 v5, 74816
    v_mov_b32 v6, 128
    v_cndmask_b32 v3, v4, v5, vcc
    v_cndmask_b32 v4, v6, 0, vcc
    v_and_b32 v5, 31, v0
    s_mov_b32 s27, 1040
    v_mul_lo_u32 v6, v5, s27
    v_lshrrev_b32 v1, 5, v0
    v_lshl_add_u32 v6, v1, 4, v6
    v_add_u32 v6, 18432, v6
    v_mov_b32 v1, 74816
    v_mov_b32 v120, 74752
    v_cmp_eq_u32 vcc, 18, v5
    s_nop 1
    v_cndmask_b32 v1, v1, v120, vcc
    v_cmp_gt_u32 vcc, 18, v5
    v_mov_b32 v120, 64
    s_nop 1
    v_cndmask_b32 v5, v1, v6, vcc
    v_cndmask_b32 v6, 0, v120, vcc
    v_mov_b32 v123, v2
    v_mov_b32 v124, v3
    v_mov_b32 v125, v5
    v_mov_b32 v120, 37376
    v_cmp_ne_u32 vcc, 0, v4
    s_nop 1
    v_cndmask_b32 v126, 0, v120, vcc
    v_cmp_ne_u32 vcc, 0, v6
    s_nop 1
    v_cndmask_b32 v127, 0, v120, vcc
    v_lshlrev_b32 v1, 4, v0
    s_waitcnt vmcnt(5) lgkmcnt(0)
    s_barrier
    ds_read_b128 v[16:19], v2
    ds_read_b32 v20, v3
    v_add_u32 v2, 512, v2
    v_add_u32 v3, v4, v3
    ds_read_b128 v[32:35], v5
    ds_read_b128 v[36:39], v5 offset:32
    v_add_u32 v5, v6, v5
    s_waitcnt lgkmcnt(2)
    v_mfma_f32_32x32x16_bf16 v[48:63], v[16:19], v[8:11], v[80:95]
    v_mfma_f32_32x32x16_bf16 v[48:63], v[20:23], v[12:15], v[48:63]
    ds_read_b128 v[24:27], v2
    ds_read_b32 v28, v3
    v_add_u32 v2, 512, v2
    v_add_u32 v3, v4, v3
    ds_read_b128 v[40:43], v5
    ds_read_b128 v[44:47], v5 offset:32
    v_add_u32 v5, v6, v5
    s_nop 15
    s_nop 7
    s_waitcnt lgkmcnt(2)
    v_mfma_f32_32x32x16_bf16 v[64:79], v[24:27], v[8:11], v[80:95]
    v_mfma_f32_32x32x16_bf16 v[64:79], v[28:31], v[12:15], v[64:79]
    v_max3_f32 v120, v48, v49, v50
    v_max3_f32 v121, v51, v52, v53
    v_max3_f32 v120, v120, v54, v55
    v_max3_f32 v121, v121, v56, v57
    v_max3_f32 v120, v120, v58, v59
    v_max3_f32 v121, v121, v60, v61
    v_max3_f32 v120, v120, v62, v63
    v_max_f32 v120, v120, v121
    ds_read_b128 v[16:19], v2
    ds_read_b32 v20, v3
    v_add_u32 v2, 512, v2
    v_add_u32 v3, v4, v3
    v_mov_b32 v121, v120
    v_mov_b32 v122, v120
    s_nop 1
    v_permlane32_swap_b32 v121, v122
    s_nop 1
    v_max_f32 v120, v121, v122
    v_sub_f32 v48, v48, v120
    v_sub_f32 v49, v49, v120
    v_sub_f32 v50, v50, v120
    v_sub_f32 v51, v51, v120
    v_sub_f32 v52, v52, v120
    v_sub_f32 v53, v53, v120
    v_sub_f32 v54, v54, v120
    v_sub_f32 v55, v55, v120
    v_sub_f32 v56, v56, v120
    v_sub_f32 v57, v57, v120
    v_sub_f32 v58, v58, v120
    v_sub_f32 v59, v59, v120
    v_sub_f32 v60, v60, v120
    v_sub_f32 v61, v61, v120
    v_sub_f32 v62, v62, v120
    v_sub_f32 v63, v63, v120
    s_nop 15
    s_nop 7
    v_sub_f32 v80, v80, v120
    v_sub_f32 v81, v81, v120
    v_sub_f32 v82, v82, v120
    v_sub_f32 v83, v83, v120
    v_sub_f32 v84, v84, v120
    v_sub_f32 v85, v85, v120
    v_sub_f32 v86, v86, v120
    v_sub_f32 v87, v87, v120
    v_sub_f32 v88, v88, v120
    v_sub_f32 v89, v89, v120
    v_sub_f32 v90, v90, v120
    v_sub_f32 v91, v91, v120
    v_sub_f32 v92, v92, v120
    v_sub_f32 v93, v93, v120
    v_sub_f32 v94, v94, v120
    v_sub_f32 v95, v95, v120
    v_sub_f32 v64, v64, v120
    v_sub_f32 v65, v65, v120
    v_sub_f32 v66, v66, v120
    v_sub_f32 v67, v67, v120
    v_sub_f32 v68, v68, v120
    v_sub_f32 v69, v69, v120
    v_sub_f32 v70, v70, v120
    v_sub_f32 v71, v71, v120
    v_sub_f32 v72, v72, v120
    v_sub_f32 v73, v73, v120
    v_sub_f32 v74, v74, v120
    v_sub_f32 v75, v75, v120
    v_sub_f32 v76, v76, v120
    v_sub_f32 v77, v77, v120
    v_sub_f32 v78, v78, v120
    v_sub_f32 v79, v79, v120
    v_exp_f32 v48, v48
    v_exp_f32 v49, v49
    v_exp_f32 v50, v50
    v_exp_f32 v51, v51
    v_exp_f32 v52, v52
    v_exp_f32 v53, v53
    v_exp_f32 v54, v54
    v_exp_f32 v55, v55
    v_cvt_pk_bf16_f32 v112, v48, v49
    v_cvt_pk_bf16_f32 v113, v50, v51
    v_cvt_pk_bf16_f32 v114, v52, v53
    v_cvt_pk_bf16_f32 v115, v54, v55
    v_exp_f32 v56, v56
    v_exp_f32 v57, v57
    v_mfma_f32_32x32x16_bf16 v[96:111], v[32:35], v[112:115], v[96:111]
    v_exp_f32 v58, v58
    v_exp_f32 v59, v59
    v_exp_f32 v60, v60
    v_exp_f32 v61, v61
    v_exp_f32 v62, v62
    v_exp_f32 v63, v63
    v_cvt_pk_bf16_f32 v116, v56, v57
    v_cvt_pk_bf16_f32 v117, v58, v59
    v_cvt_pk_bf16_f32 v118, v60, v61
    v_cvt_pk_bf16_f32 v119, v62, v63
    s_nop 1
    v_mfma_f32_32x32x16_bf16 v[96:111], v[36:39], v[116:119], v[96:111]
    ds_read_b128 v[32:35], v5
    ds_read_b128 v[36:39], v5 offset:32
    v_add_u32 v5, v6, v5
    s_mov_b32 s28, 0
c0loop:
    s_waitcnt lgkmcnt(2)
    v_mfma_f32_32x32x16_bf16 v[48:63], v[16:19], v[8:11], v[80:95]
    v_mfma_f32_32x32x16_bf16 v[48:63], v[20:23], v[12:15], v[48:63]
    v_max3_f32 v120, v64, v65, v66
    v_max3_f32 v121, v67, v68, v69
    v_max3_f32 v120, v120, v70, v71
    v_max3_f32 v121, v121, v72, v73
    v_max3_f32 v120, v120, v74, v75
    v_max3_f32 v121, v121, v76, v77
    v_max3_f32 v120, v120, v78, v79
    v_max_f32 v120, v120, v121
    ds_read_b128 v[24:27], v2
    ds_read_b32 v28, v3
    v_add_u32 v2, 512, v2
    v_add_u32 v3, v4, v3
    v_cmp_lt_f32 vcc, s35, v120
    s_nop 1
    s_cbranch_vccnz resc_c0l1
back_c0l1:
    v_exp_f32 v64, v64
    v_exp_f32 v65, v65
    v_exp_f32 v66, v66
    v_exp_f32 v67, v67
    v_exp_f32 v68, v68
    v_exp_f32 v69, v69
    v_exp_f32 v70, v70
    v_exp_f32 v71, v71
    v_cvt_pk_bf16_f32 v112, v64, v65
    v_cvt_pk_bf16_f32 v113, v66, v67
    v_cvt_pk_bf16_f32 v114, v68, v69
    v_cvt_pk_bf16_f32 v115, v70, v71
    v_exp_f32 v72, v72
    v_exp_f32 v73, v73
    v_mfma_f32_32x32x16_bf16 v[96:111], v[40:43], v[112:115], v[96:111]
    v_exp_f32 v74, v74
    v_exp_f32 v75, v75
    v_exp_f32 v76, v76
    v_exp_f32 v77, v77
    v_exp_f32 v78, v78
    v_exp_f32 v79, v79
    v_cvt_pk_bf16_f32 v116, v72, v73
    v_cvt_pk_bf16_f32 v117, v74, v75
    v_cvt_pk_bf16_f32 v118, v76, v77
    v_cvt_pk_bf16_f32 v119, v78, v79
    s_nop 1
    v_mfma_f32_32x32x16_bf16 v[96:111], v[44:47], v[116:119], v[96:111]
    ds_read_b128 v[40:43], v5
    ds_read_b128 v[44:47], v5 offset:32
    v_add_u32 v5, v6, v5
    s_waitcnt lgkmcnt(2)
    v_mfma_f32_32x32x16_bf16 v[64:79], v[24:27], v[8:11], v[80:95]
    v_mfma_f32_32x32x16_bf16 v[64:79], v[28:31], v[12:15], v[64:79]
    v_max3_f32 v120, v48, v49, v50
    v_max3_f32 v121, v51, v52, v53
    v_max3_f32 v120, v120, v54, v55
    v_max3_f32 v121, v121, v56, v57
    v_max3_f32 v120, v120, v58, v59
    v_max3_f32 v121, v121, v60, v61
    v_max3_f32 v120, v120, v62, v63
    v_max_f32 v120, v120, v121
    ds_read_b128 v[16:19], v2
    ds_read_b32 v20, v3
    v_add_u32 v2, 512, v2
    v_add_u32 v3, v4, v3
    v_cmp_lt_f32 vcc, s35, v120
    s_nop 1
    s_cbranch_vccnz resc_c0l0
back_c0l0:
    v_exp_f32 v48, v48
    v_exp_f32 v49, v49
    v_exp_f32 v50, v50
    v_exp_f32 v51, v51
    v_exp_f32 v52, v52
    v_exp_f32 v53, v53
    v_exp_f32 v54, v54
    v_exp_f32 v55, v55
    v_cvt_pk_bf16_f32 v112, v48, v49
    v_cvt_pk_bf16_f32 v113, v50, v51
    v_cvt_pk_bf16_f32 v114, v52, v53
    v_cvt_pk_bf16_f32 v115, v54, v55
    v_exp_f32 v56, v56
    v_exp_f32 v57, v57
    v_mfma_f32_32x32x16_bf16 v[96:111], v[32:35], v[112:115], v[96:111]
    v_exp_f32 v58, v58
    v_exp_f32 v59, v59
    v_exp_f32 v60, v60
    v_exp_f32 v61, v61
    v_exp_f32 v62, v62
    v_exp_f32 v63, v63
    v_cvt_pk_bf16_f32 v116, v56, v57
    v_cvt_pk_bf16_f32 v117, v58, v59
    v_cvt_pk_bf16_f32 v118, v60, v61
    v_cvt_pk_bf16_f32 v119, v62, v63
    s_nop 1
    v_mfma_f32_32x32x16_bf16 v[96:111], v[36:39], v[116:119], v[96:111]
    ds_read_b128 v[32:35], v5
    ds_read_b128 v[36:39], v5 offset:32
    v_add_u32 v5, v6, v5
    s_add_u32 s28, s28, 1
    s_cmp_lt_u32 s28, 7
    s_cbranch_scc1 c0loop
    s_waitcnt lgkmcnt(2)
    v_mfma_f32_32x32x16_bf16 v[48:63], v[16:19], v[8:11], v[80:95]
    v_mfma_f32_32x32x16_bf16 v[48:63], v[20:23], v[12:15], v[48:63]
    v_max3_f32 v120, v64, v65, v66
    v_max3_f32 v121, v67, v68, v69
    v_max3_f32 v120, v120, v70, v71
    v_max3_f32 v121, v121, v72, v73
    v_max3_f32 v120, v120, v74, v75
    v_max3_f32 v121, v121, v76, v77
    v_max3_f32 v120, v120, v78, v79
    v_max_f32 v120, v120, v121
    ds_read_b128 v[24:27], v2
    ds_read_b32 v28, v3
    v_add_u32 v2, 512, v2
    v_add_u32 v3, v4, v3
    v_cmp_lt_f32 vcc, s35, v120
    s_nop 1
    s_cbranch_vccnz resc_c0tl
back_c0tl:
    v_exp_f32 v64, v64
    v_exp_f32 v65, v65
    v_exp_f32 v66, v66
    v_exp_f32 v67, v67
    v_exp_f32 v68, v68
    v_exp_f32 v69, v69
    v_exp_f32 v70, v70
    v_exp_f32 v71, v71
    v_cvt_pk_bf16_f32 v112, v64, v65
    v_cvt_pk_bf16_f32 v113, v66, v67
    v_cvt_pk_bf16_f32 v114, v68, v69
    v_cvt_pk_bf16_f32 v115, v70, v71
    v_exp_f32 v72, v72
    v_exp_f32 v73, v73
    v_mfma_f32_32x32x16_bf16 v[96:111], v[40:43], v[112:115], v[96:111]
    v_exp_f32 v74, v74
    v_exp_f32 v75, v75
    v_exp_f32 v76, v76
    v_exp_f32 v77, v77
    v_exp_f32 v78, v78
    v_exp_f32 v79, v79
    v_cvt_pk_bf16_f32 v116, v72, v73
    v_cvt_pk_bf16_f32 v117, v74, v75
    v_cvt_pk_bf16_f32 v118, v76, v77
    v_cvt_pk_bf16_f32 v119, v78, v79
    s_nop 1
    v_mfma_f32_32x32x16_bf16 v[96:111], v[44:47], v[116:119], v[96:111]
    ds_read_b128 v[40:43], v5
    ds_read_b128 v[44:47], v5 offset:32
    v_add_u32 v5, v6, v5
    s_mov_b32 s63, 1
attn_chunks:
    s_waitcnt vmcnt(0) lgkmcnt(0)
    s_barrier
    s_cmp_ge_u32 s63, 3
    s_cbranch_scc1 attn_nodma
    s_and_b32 s64, s63, 1
    s_cmp_eq_u32 s64, 1
    s_cbranch_scc1 attn_dma0
    s_add_u32 m0, s55, 37376
    s_nop 0
    buffer_load_dwordx4 v1, s[8:11], s50 offen lds
    s_add_u32 m0, s56, 37376
    s_nop 0
    buffer_load_dwordx4 v1, s[8:11], s51 offen lds
    s_add_u32 m0, s57, 37376
    s_nop 0
    buffer_load_dwordx4 v1, s[8:11], s52 offen lds
    s_add_u32 m0, s58, 37376
    s_nop 0
    buffer_load_dwordx4 v1, s[8:11], s53 offen lds
    s_add_u32 m0, s59, 37376
    s_nop 0
    buffer_load_dwordx4 v1, s[8:11], s54 offen lds
    s_add_u32 s50, s50, 8192
    s_add_u32 s51, s51, 8192
    s_add_u32 s52, s52, s60
    s_add_u32 s53, s53, s61
    s_add_u32 s54, s54, s62
    s_branch attn_nodma
attn_dma0:
    s_add_u32 m0, s55, 0
    s_nop 0
    buffer_load_dwordx4 v1, s[8:11], s50 offen lds
    s_add_u32 m0, s56, 0
    s_nop 0
    buffer_load_dwordx4 v1, s[8:11], s51 offen lds
    s_add_u32 m0, s57, 0
    s_nop 0
    buffer_load_dwordx4 v1, s[8:11], s52 offen lds
    s_add_u32 m0, s58, 0
    s_nop 0
    buffer_load_dwordx4 v1, s[8:11], s53 offen lds
    s_add_u32 m0, s59, 0
    s_nop 0
    buffer_load_dwordx4 v1, s[8:11], s54 offen lds
    s_add_u32 s50, s50, 8192
    s_add_u32 s51, s51, 8192
    s_add_u32 s52, s52, s60
    s_add_u32 s53, s53, s61
    s_add_u32 s54, s54, s62
attn_nodma:
    s_and_b32 s64, s63, 1
    s_mul_i32 s64, s64, 37376
    v_add_u32 v2, s64, v123
    s_cmp_eq_u32 s64, 0
    s_cbranch_scc1 attn_b0
    v_add_u32 v3, v126, v124
    v_add_u32 v5, v127, v125
    s_branch attn_b1
attn_b0:
    v_mov_b32 v3, v124
    v_mov_b32 v5, v125
attn_b1:
    ds_read_b128 v[16:19], v2
    ds_read_b32 v20, v3
    v_add_u32 v2, 512, v2
    v_add_u32 v3, v4, v3
    ds_read_b128 v[32:35], v5
    ds_read_b128 v[36:39], v5 offset:32
    v_add_u32 v5, v6, v5
    s_waitcnt lgkmcnt(2)
    v_mfma_f32_32x32x16_bf16 v[48:63], v[16:19], v[8:11], v[80:95]
    v_mfma_f32_32x32x16_bf16 v[48:63], v[20:23], v[12:15], v[48:63]
    ds_read_b128 v[24:27], v2
    ds_read_b32 v28, v3
    v_add_u32 v2, 512, v2
    v_add_u32 v3, v4, v3
    ds_read_b128 v[40:43], v5
    ds_read_b128 v[44:47], v5 offset:32
    v_add_u32 v5, v6, v5
    s_nop 15
    s_nop 7
    s_waitcnt lgkmcnt(2)
    v_mfma_f32_32x32x16_bf16 v[64:79], v[24:27], v[8:11], v[80:95]
    v_mfma_f32_32x32x16_bf16 v[64:79], v[28:31], v[12:15], v[64:79]
    v_max3_f32 v120, v48, v49, v50
    v_max3_f32 v121, v51, v52, v53
    v_max3_f32 v120, v120, v54, v55
    v_max3_f32 v121, v121, v56, v57
    v_max3_f32 v120, v120, v58, v59
    v_max3_f32 v121, v121, v60, v61
    v_max3_f32 v120, v120, v62, v63
    v_max_f32 v120, v120, v121
    ds_read_b128 v[16:19], v2
    ds_read_b32 v20, v3
    v_add_u32 v2, 512, v2
    v_add_u32 v3, v4, v3
    v_cmp_lt_f32 vcc, s35, v120
    s_nop 1
    s_cbranch_vccnz resc_cnt0
back_cnt0:
    v_exp_f32 v48, v48
    v_exp_f32 v49, v49
    v_exp_f32 v50, v50
    v_exp_f32 v51, v51
    v_exp_f32 v52, v52
    v_exp_f32 v53, v53
    v_exp_f32 v54, v54
    v_exp_f32 v55, v55
    v_cvt_pk_bf16_f32 v112, v48, v49
    v_cvt_pk_bf16_f32 v113, v50, v51
    v_cvt_pk_bf16_f32 v114, v52, v53
    v_cvt_pk_bf16_f32 v115, v54, v55
    v_exp_f32 v56, v56
    v_exp_f32 v57, v57
    v_mfma_f32_32x32x16_bf16 v[96:111], v[32:35], v[112:115], v[96:111]
    v_exp_f32 v58, v58
    v_exp_f32 v59, v59
    v_exp_f32 v60, v60
    v_exp_f32 v61, v61
    v_exp_f32 v62, v62
    v_exp_f32 v63, v63
    v_cvt_pk_bf16_f32 v116, v56, v57
    v_cvt_pk_bf16_f32 v117, v58, v59
    v_cvt_pk_bf16_f32 v118, v60, v61
    v_cvt_pk_bf16_f32 v119, v62, v63
    s_nop 1
    v_mfma_f32_32x32x16_bf16 v[96:111], v[36:39], v[116:119], v[96:111]
    ds_read_b128 v[32:35], v5
    ds_read_b128 v[36:39], v5 offset:32
    v_add_u32 v5, v6, v5
    s_mov_b32 s28, 0
cnloop:
    s_waitcnt lgkmcnt(2)
    v_mfma_f32_32x32x16_bf16 v[48:63], v[16:19], v[8:11], v[80:95]
    v_mfma_f32_32x32x16_bf16 v[48:63], v[20:23], v[12:15], v[48:63]
    v_max3_f32 v120, v64, v65, v66
    v_max3_f32 v121, v67, v68, v69
    v_max3_f32 v120, v120, v70, v71
    v_max3_f32 v121, v121, v72, v73
    v_max3_f32 v120, v120, v74, v75
    v_max3_f32 v121, v121, v76, v77
    v_max3_f32 v120, v120, v78, v79
    v_max_f32 v120, v120, v121
    ds_read_b128 v[24:27], v2
    ds_read_b32 v28, v3
    v_add_u32 v2, 512, v2
    v_add_u32 v3, v4, v3
    v_cmp_lt_f32 vcc, s35, v120
    s_nop 1
    s_cbranch_vccnz resc_cnl1
back_cnl1:
    v_exp_f32 v64, v64
    v_exp_f32 v65, v65
    v_exp_f32 v66, v66
    v_exp_f32 v67, v67
    v_exp_f32 v68, v68
    v_exp_f32 v69, v69
    v_exp_f32 v70, v70
    v_exp_f32 v71, v71
    v_cvt_pk_bf16_f32 v112, v64, v65
    v_cvt_pk_bf16_f32 v113, v66, v67
    v_cvt_pk_bf16_f32 v114, v68, v69
    v_cvt_pk_bf16_f32 v115, v70, v71
    v_exp_f32 v72, v72
    v_exp_f32 v73, v73
    v_mfma_f32_32x32x16_bf16 v[96:111], v[40:43], v[112:115], v[96:111]
    v_exp_f32 v74, v74
    v_exp_f32 v75, v75
    v_exp_f32 v76, v76
    v_exp_f32 v77, v77
    v_exp_f32 v78, v78
    v_exp_f32 v79, v79
    v_cvt_pk_bf16_f32 v116, v72, v73
    v_cvt_pk_bf16_f32 v117, v74, v75
    v_cvt_pk_bf16_f32 v118, v76, v77
    v_cvt_pk_bf16_f32 v119, v78, v79
    s_nop 1
    v_mfma_f32_32x32x16_bf16 v[96:111], v[44:47], v[116:119], v[96:111]
    ds_read_b128 v[40:43], v5
    ds_read_b128 v[44:47], v5 offset:32
    v_add_u32 v5, v6, v5
    s_waitcnt lgkmcnt(2)
    v_mfma_f32_32x32x16_bf16 v[64:79], v[24:27], v[8:11], v[80:95]
    v_mfma_f32_32x32x16_bf16 v[64:79], v[28:31], v[12:15], v[64:79]
    v_max3_f32 v120, v48, v49, v50
    v_max3_f32 v121, v51, v52, v53
    v_max3_f32 v120, v120, v54, v55
    v_max3_f32 v121, v121, v56, v57
    v_max3_f32 v120, v120, v58, v59
    v_max3_f32 v121, v121, v60, v61
    v_max3_f32 v120, v120, v62, v63
    v_max_f32 v120, v120, v121
    ds_read_b128 v[16:19], v2
    ds_read_b32 v20, v3
    v_add_u32 v2, 512, v2
    v_add_u32 v3, v4, v3
    v_cmp_lt_f32 vcc, s35, v120
    s_nop 1
    s_cbranch_vccnz resc_cnl0
back_cnl0:
    v_exp_f32 v48, v48
    v_exp_f32 v49, v49
    v_exp_f32 v50, v50
    v_exp_f32 v51, v51
    v_exp_f32 v52, v52
    v_exp_f32 v53, v53
    v_exp_f32 v54, v54
    v_exp_f32 v55, v55
    v_cvt_pk_bf16_f32 v112, v48, v49
    v_cvt_pk_bf16_f32 v113, v50, v51
    v_cvt_pk_bf16_f32 v114, v52, v53
    v_cvt_pk_bf16_f32 v115, v54, v55
    v_exp_f32 v56, v56
    v_exp_f32 v57, v57
    v_mfma_f32_32x32x16_bf16 v[96:111], v[32:35], v[112:115], v[96:111]
    v_exp_f32 v58, v58
    v_exp_f32 v59, v59
    v_exp_f32 v60, v60
    v_exp_f32 v61, v61
    v_exp_f32 v62, v62
    v_exp_f32 v63, v63
    v_cvt_pk_bf16_f32 v116, v56, v57
    v_cvt_pk_bf16_f32 v117, v58, v59
    v_cvt_pk_bf16_f32 v118, v60, v61
    v_cvt_pk_bf16_f32 v119, v62, v63
    s_nop 1
    v_mfma_f32_32x32x16_bf16 v[96:111], v[36:39], v[116:119], v[96:111]
    ds_read_b128 v[32:35], v5
    ds_read_b128 v[36:39], v5 offset:32
    v_add_u32 v5, v6, v5
    s_add_u32 s28, s28, 1
    s_cmp_lt_u32 s28, 7
    s_cbranch_scc1 cnloop
    s_waitcnt lgkmcnt(2)
    v_mfma_f32_32x32x16_bf16 v[48:63], v[16:19], v[8:11], v[80:95]
    v_mfma_f32_32x32x16_bf16 v[48:63], v[20:23], v[12:15], v[48:63]
    v_max3_f32 v120, v64, v65, v66
    v_max3_f32 v121, v67, v68, v69
    v_max3_f32 v120, v120, v70, v71
    v_max3_f32 v121, v121, v72, v73
    v_max3_f32 v120, v120, v74, v75
    v_max3_f32 v121, v121, v76, v77
    v_max3_f32 v120, v120, v78, v79
    v_max_f32 v120, v120, v121
    ds_read_b128 v[24:27], v2
    ds_read_b32 v28, v3
    v_add_u32 v2, 512, v2
    v_add_u32 v3, v4, v3
    v_cmp_lt_f32 vcc, s35, v120
    s_nop 1
    s_cbranch_vccnz resc_cntl
back_cntl:
    v_exp_f32 v64, v64
    v_exp_f32 v65, v65
    v_exp_f32 v66, v66
    v_exp_f32 v67, v67
    v_exp_f32 v68, v68
    v_exp_f32 v69, v69
    v_exp_f32 v70, v70
    v_exp_f32 v71, v71
    v_cvt_pk_bf16_f32 v112, v64, v65
    v_cvt_pk_bf16_f32 v113, v66, v67
    v_cvt_pk_bf16_f32 v114, v68, v69
    v_cvt_pk_bf16_f32 v115, v70, v71
    v_exp_f32 v72, v72
    v_exp_f32 v73, v73
    v_mfma_f32_32x32x16_bf16 v[96:111], v[40:43], v[112:115], v[96:111]
    v_exp_f32 v74, v74
    v_exp_f32 v75, v75
    v_exp_f32 v76, v76
    v_exp_f32 v77, v77
    v_exp_f32 v78, v78
    v_exp_f32 v79, v79
    v_cvt_pk_bf16_f32 v116, v72, v73
    v_cvt_pk_bf16_f32 v117, v74, v75
    v_cvt_pk_bf16_f32 v118, v76, v77
    v_cvt_pk_bf16_f32 v119, v78, v79
    s_nop 1
    v_mfma_f32_32x32x16_bf16 v[96:111], v[44:47], v[116:119], v[96:111]
    ds_read_b128 v[40:43], v5
    ds_read_b128 v[44:47], v5 offset:32
    v_add_u32 v5, v6, v5
    s_add_u32 s63, s63, 1
    s_cmp_lt_u32 s63, 4
    s_cbranch_scc1 attn_chunks
    s_nop 15
    s_nop 7
    v_lshrrev_b32 v1, 5, v0
    s_mov_b32 s27, 1152
    v_mul_lo_u32 v2, v7, s27
    v_lshl_add_u32 v2, v1, 3, v2
    s_mul_i32 s27, s30, 36
    v_cmp_lt_u32 vcc, 31, v0
    v_mov_b32 v4, 0x7f000000
    s_nop 1
    v_cndmask_b32 v3, v2, v4, vcc
    v_mov_b32 v120, v106
    v_mov_b32 v121, v106
    s_nop 1
    v_permlane32_swap_b32 v120, v121
    s_nop 1
    v_rcp_f32 v120, v120
    s_nop 0
    v_mul_f32 v96, v96, v120
    v_mul_f32 v97, v97, v120
    v_mul_f32 v98, v98, v120
    v_mul_f32 v99, v99, v120
    v_mul_f32 v100, v100, v120
    v_mul_f32 v101, v101, v120
    v_mul_f32 v102, v102, v120
    v_mul_f32 v103, v103, v120
    v_mul_f32 v104, v104, v120
    v_mul_f32 v105, v105, v120
    v_cvt_pk_bf16_f32 v122, v96, v97
    v_cvt_pk_bf16_f32 v123, v98, v99
    v_cvt_pk_bf16_f32 v124, v100, v101
    v_cvt_pk_bf16_f32 v125, v102, v103
    v_cvt_pk_bf16_f32 v126, v104, v105
    buffer_store_dwordx2 v[122:123], v2, s[12:15], s27 offen
    buffer_store_dwordx2 v[124:125], v2, s[12:15], s27 offen offset:16
    buffer_store_dword v126, v3, s[12:15], s27 offen offset:32
    s_endpgm
resc_c0l1:
    v_mov_b32 v121, v120
    v_mov_b32 v122, v120
    s_nop 1
    v_permlane32_swap_b32 v121, v122
    s_nop 1
    v_max_f32 v120, v121, v122
    v_max_f32 v120, 0, v120
    v_sub_f32 v121, 0, v120
    v_exp_f32 v121, v121
    s_nop 0
    v_mul_f32 v96, v96, v121
    v_mul_f32 v97, v97, v121
    v_mul_f32 v98, v98, v121
    v_mul_f32 v99, v99, v121
    v_mul_f32 v100, v100, v121
    v_mul_f32 v101, v101, v121
    v_mul_f32 v102, v102, v121
    v_mul_f32 v103, v103, v121
    v_mul_f32 v104, v104, v121
    v_mul_f32 v105, v105, v121
    v_mul_f32 v106, v106, v121
    v_mul_f32 v107, v107, v121
    v_sub_f32 v64, v64, v120
    v_sub_f32 v65, v65, v120
    v_sub_f32 v66, v66, v120
    v_sub_f32 v67, v67, v120
    v_sub_f32 v68, v68, v120
    v_sub_f32 v69, v69, v120
    v_sub_f32 v70, v70, v120
    v_sub_f32 v71, v71, v120
    v_sub_f32 v72, v72, v120
    v_sub_f32 v73, v73, v120
    v_sub_f32 v74, v74, v120
    v_sub_f32 v75, v75, v120
    v_sub_f32 v76, v76, v120
    v_sub_f32 v77, v77, v120
    v_sub_f32 v78, v78, v120
    v_sub_f32 v79, v79, v120
    s_nop 15
    s_nop 7
    v_sub_f32 v80, v80, v120
    v_sub_f32 v81, v81, v120
    v_sub_f32 v82, v82, v120
    v_sub_f32 v83, v83, v120
    v_sub_f32 v84, v84, v120
    v_sub_f32 v85, v85, v120
    v_sub_f32 v86, v86, v120
    v_sub_f32 v87, v87, v120
    v_sub_f32 v88, v88, v120
    v_sub_f32 v89, v89, v120
    v_sub_f32 v90, v90, v120
    v_sub_f32 v91, v91, v120
    v_sub_f32 v92, v92, v120
    v_sub_f32 v93, v93, v120
    v_sub_f32 v94, v94, v120
    v_sub_f32 v95, v95, v120
    v_sub_f32 v48, v48, v120
    v_sub_f32 v49, v49, v120
    v_sub_f32 v50, v50, v120
    v_sub_f32 v51, v51, v120
    v_sub_f32 v52, v52, v120
    v_sub_f32 v53, v53, v120
    v_sub_f32 v54, v54, v120
    v_sub_f32 v55, v55, v120
    v_sub_f32 v56, v56, v120
    v_sub_f32 v57, v57, v120
    v_sub_f32 v58, v58, v120
    v_sub_f32 v59, v59, v120
    v_sub_f32 v60, v60, v120
    v_sub_f32 v61, v61, v120
    v_sub_f32 v62, v62, v120
    v_sub_f32 v63, v63, v120
    s_branch back_c0l1
resc_c0l0:
    v_mov_b32 v121, v120
    v_mov_b32 v122, v120
    s_nop 1
    v_permlane32_swap_b32 v121, v122
    s_nop 1
    v_max_f32 v120, v121, v122
    v_max_f32 v120, 0, v120
    v_sub_f32 v121, 0, v120
    v_exp_f32 v121, v121
    s_nop 0
    v_mul_f32 v96, v96, v121
    v_mul_f32 v97, v97, v121
    v_mul_f32 v98, v98, v121
    v_mul_f32 v99, v99, v121
    v_mul_f32 v100, v100, v121
    v_mul_f32 v101, v101, v121
    v_mul_f32 v102, v102, v121
    v_mul_f32 v103, v103, v121
    v_mul_f32 v104, v104, v121
    v_mul_f32 v105, v105, v121
    v_mul_f32 v106, v106, v121
    v_mul_f32 v107, v107, v121
    v_sub_f32 v48, v48, v120
    v_sub_f32 v49, v49, v120
    v_sub_f32 v50, v50, v120
    v_sub_f32 v51, v51, v120
    v_sub_f32 v52, v52, v120
    v_sub_f32 v53, v53, v120
    v_sub_f32 v54, v54, v120
    v_sub_f32 v55, v55, v120
    v_sub_f32 v56, v56, v120
    v_sub_f32 v57, v57, v120
    v_sub_f32 v58, v58, v120
    v_sub_f32 v59, v59, v120
    v_sub_f32 v60, v60, v120
    v_sub_f32 v61, v61, v120
    v_sub_f32 v62, v62, v120
    v_sub_f32 v63, v63, v120
    s_nop 15
    s_nop 7
    v_sub_f32 v80, v80, v120
    v_sub_f32 v81, v81, v120
    v_sub_f32 v82, v82, v120
    v_sub_f32 v83, v83, v120
    v_sub_f32 v84, v84, v120
    v_sub_f32 v85, v85, v120
    v_sub_f32 v86, v86, v120
    v_sub_f32 v87, v87, v120
    v_sub_f32 v88, v88, v120
    v_sub_f32 v89, v89, v120
    v_sub_f32 v90, v90, v120
    v_sub_f32 v91, v91, v120
    v_sub_f32 v92, v92, v120
    v_sub_f32 v93, v93, v120
    v_sub_f32 v94, v94, v120
    v_sub_f32 v95, v95, v120
    v_sub_f32 v64, v64, v120
    v_sub_f32 v65, v65, v120
    v_sub_f32 v66, v66, v120
    v_sub_f32 v67, v67, v120
    v_sub_f32 v68, v68, v120
    v_sub_f32 v69, v69, v120
    v_sub_f32 v70, v70, v120
    v_sub_f32 v71, v71, v120
    v_sub_f32 v72, v72, v120
    v_sub_f32 v73, v73, v120
    v_sub_f32 v74, v74, v120
    v_sub_f32 v75, v75, v120
    v_sub_f32 v76, v76, v120
    v_sub_f32 v77, v77, v120
    v_sub_f32 v78, v78, v120
    v_sub_f32 v79, v79, v120
    s_branch back_c0l0
resc_c0tl:
    v_mov_b32 v121, v120
    v_mov_b32 v122, v120
    s_nop 1
    v_permlane32_swap_b32 v121, v122
    s_nop 1
    v_max_f32 v120, v121, v122
    v_max_f32 v120, 0, v120
    v_sub_f32 v121, 0, v120
    v_exp_f32 v121, v121
    s_nop 0
    v_mul_f32 v96, v96, v121
    v_mul_f32 v97, v97, v121
    v_mul_f32 v98, v98, v121
    v_mul_f32 v99, v99, v121
    v_mul_f32 v100, v100, v121
    v_mul_f32 v101, v101, v121
    v_mul_f32 v102, v102, v121
    v_mul_f32 v103, v103, v121
    v_mul_f32 v104, v104, v121
    v_mul_f32 v105, v105, v121
    v_mul_f32 v106, v106, v121
    v_mul_f32 v107, v107, v121
    v_sub_f32 v64, v64, v120
    v_sub_f32 v65, v65, v120
    v_sub_f32 v66, v66, v120
    v_sub_f32 v67, v67, v120
    v_sub_f32 v68, v68, v120
    v_sub_f32 v69, v69, v120
    v_sub_f32 v70, v70, v120
    v_sub_f32 v71, v71, v120
    v_sub_f32 v72, v72, v120
    v_sub_f32 v73, v73, v120
    v_sub_f32 v74, v74, v120
    v_sub_f32 v75, v75, v120
    v_sub_f32 v76, v76, v120
    v_sub_f32 v77, v77, v120
    v_sub_f32 v78, v78, v120
    v_sub_f32 v79, v79, v120
    s_nop 15
    s_nop 7
    v_sub_f32 v80, v80, v120
    v_sub_f32 v81, v81, v120
    v_sub_f32 v82, v82, v120
    v_sub_f32 v83, v83, v120
    v_sub_f32 v84, v84, v120
    v_sub_f32 v85, v85, v120
    v_sub_f32 v86, v86, v120
    v_sub_f32 v87, v87, v120
    v_sub_f32 v88, v88, v120
    v_sub_f32 v89, v89, v120
    v_sub_f32 v90, v90, v120
    v_sub_f32 v91, v91, v120
    v_sub_f32 v92, v92, v120
    v_sub_f32 v93, v93, v120
    v_sub_f32 v94, v94, v120
    v_sub_f32 v95, v95, v120
    v_sub_f32 v48, v48, v120
    v_sub_f32 v49, v49, v120
    v_sub_f32 v50, v50, v120
    v_sub_f32 v51, v51, v120
    v_sub_f32 v52, v52, v120
    v_sub_f32 v53, v53, v120
    v_sub_f32 v54, v54, v120
    v_sub_f32 v55, v55, v120
    v_sub_f32 v56, v56, v120
    v_sub_f32 v57, v57, v120
    v_sub_f32 v58, v58, v120
    v_sub_f32 v59, v59, v120
    v_sub_f32 v60, v60, v120
    v_sub_f32 v61, v61, v120
    v_sub_f32 v62, v62, v120
    v_sub_f32 v63, v63, v120
    s_branch back_c0tl
resc_cnt0:
    v_mov_b32 v121, v120
    v_mov_b32 v122, v120
    s_nop 1
    v_permlane32_swap_b32 v121, v122
    s_nop 1
    v_max_f32 v120, v121, v122
    v_max_f32 v120, 0, v120
    v_sub_f32 v121, 0, v120
    v_exp_f32 v121, v121
    s_nop 0
    v_mul_f32 v96, v96, v121
    v_mul_f32 v97, v97, v121
    v_mul_f32 v98, v98, v121
    v_mul_f32 v99, v99, v121
    v_mul_f32 v100, v100, v121
    v_mul_f32 v101, v101, v121
    v_mul_f32 v102, v102, v121
    v_mul_f32 v103, v103, v121
    v_mul_f32 v104, v104, v121
    v_mul_f32 v105, v105, v121
    v_mul_f32 v106, v106, v121
    v_mul_f32 v107, v107, v121
    v_sub_f32 v48, v48, v120
    v_sub_f32 v49, v49, v120
    v_sub_f32 v50, v50, v120
    v_sub_f32 v51, v51, v120
    v_sub_f32 v52, v52, v120
    v_sub_f32 v53, v53, v120
    v_sub_f32 v54, v54, v120
    v_sub_f32 v55, v55, v120
    v_sub_f32 v56, v56, v120
    v_sub_f32 v57, v57, v120
    v_sub_f32 v58, v58, v120
    v_sub_f32 v59, v59, v120
    v_sub_f32 v60, v60, v120
    v_sub_f32 v61, v61, v120
    v_sub_f32 v62, v62, v120
    v_sub_f32 v63, v63, v120
    s_nop 15
    s_nop 7
    v_sub_f32 v80, v80, v120
    v_sub_f32 v81, v81, v120
    v_sub_f32 v82, v82, v120
    v_sub_f32 v83, v83, v120
    v_sub_f32 v84, v84, v120
    v_sub_f32 v85, v85, v120
    v_sub_f32 v86, v86, v120
    v_sub_f32 v87, v87, v120
    v_sub_f32 v88, v88, v120
    v_sub_f32 v89, v89, v120
    v_sub_f32 v90, v90, v120
    v_sub_f32 v91, v91, v120
    v_sub_f32 v92, v92, v120
    v_sub_f32 v93, v93, v120
    v_sub_f32 v94, v94, v120
    v_sub_f32 v95, v95, v120
    v_sub_f32 v64, v64, v120
    v_sub_f32 v65, v65, v120
    v_sub_f32 v66, v66, v120
    v_sub_f32 v67, v67, v120
    v_sub_f32 v68, v68, v120
    v_sub_f32 v69, v69, v120
    v_sub_f32 v70, v70, v120
    v_sub_f32 v71, v71, v120
    v_sub_f32 v72, v72, v120
    v_sub_f32 v73, v73, v120
    v_sub_f32 v74, v74, v120
    v_sub_f32 v75, v75, v120
    v_sub_f32 v76, v76, v120
    v_sub_f32 v77, v77, v120
    v_sub_f32 v78, v78, v120
    v_sub_f32 v79, v79, v120
    s_branch back_cnt0
resc_cnl1:
    v_mov_b32 v121, v120
    v_mov_b32 v122, v120
    s_nop 1
    v_permlane32_swap_b32 v121, v122
    s_nop 1
    v_max_f32 v120, v121, v122
    v_max_f32 v120, 0, v120
    v_sub_f32 v121, 0, v120
    v_exp_f32 v121, v121
    s_nop 0
    v_mul_f32 v96, v96, v121
    v_mul_f32 v97, v97, v121
    v_mul_f32 v98, v98, v121
    v_mul_f32 v99, v99, v121
    v_mul_f32 v100, v100, v121
    v_mul_f32 v101, v101, v121
    v_mul_f32 v102, v102, v121
    v_mul_f32 v103, v103, v121
    v_mul_f32 v104, v104, v121
    v_mul_f32 v105, v105, v121
    v_mul_f32 v106, v106, v121
    v_mul_f32 v107, v107, v121
    v_sub_f32 v64, v64, v120
    v_sub_f32 v65, v65, v120
    v_sub_f32 v66, v66, v120
    v_sub_f32 v67, v67, v120
    v_sub_f32 v68, v68, v120
    v_sub_f32 v69, v69, v120
    v_sub_f32 v70, v70, v120
    v_sub_f32 v71, v71, v120
    v_sub_f32 v72, v72, v120
    v_sub_f32 v73, v73, v120
    v_sub_f32 v74, v74, v120
    v_sub_f32 v75, v75, v120
    v_sub_f32 v76, v76, v120
    v_sub_f32 v77, v77, v120
    v_sub_f32 v78, v78, v120
    v_sub_f32 v79, v79, v120
    s_nop 15
    s_nop 7
    v_sub_f32 v80, v80, v120
    v_sub_f32 v81, v81, v120
    v_sub_f32 v82, v82, v120
    v_sub_f32 v83, v83, v120
    v_sub_f32 v84, v84, v120
    v_sub_f32 v85, v85, v120
    v_sub_f32 v86, v86, v120
    v_sub_f32 v87, v87, v120
    v_sub_f32 v88, v88, v120
    v_sub_f32 v89, v89, v120
    v_sub_f32 v90, v90, v120
    v_sub_f32 v91, v91, v120
    v_sub_f32 v92, v92, v120
    v_sub_f32 v93, v93, v120
    v_sub_f32 v94, v94, v120
    v_sub_f32 v95, v95, v120
    v_sub_f32 v48, v48, v120
    v_sub_f32 v49, v49, v120
    v_sub_f32 v50, v50, v120
    v_sub_f32 v51, v51, v120
    v_sub_f32 v52, v52, v120
    v_sub_f32 v53, v53, v120
    v_sub_f32 v54, v54, v120
    v_sub_f32 v55, v55, v120
    v_sub_f32 v56, v56, v120
    v_sub_f32 v57, v57, v120
    v_sub_f32 v58, v58, v120
    v_sub_f32 v59, v59, v120
    v_sub_f32 v60, v60, v120
    v_sub_f32 v61, v61, v120
    v_sub_f32 v62, v62, v120
    v_sub_f32 v63, v63, v120
    s_branch back_cnl1
resc_cnl0:
    v_mov_b32 v121, v120
    v_mov_b32 v122, v120
    s_nop 1
    v_permlane32_swap_b32 v121, v122
    s_nop 1
    v_max_f32 v120, v121, v122
    v_max_f32 v120, 0, v120
    v_sub_f32 v121, 0, v120
    v_exp_f32 v121, v121
    s_nop 0
    v_mul_f32 v96, v96, v121
    v_mul_f32 v97, v97, v121
    v_mul_f32 v98, v98, v121
    v_mul_f32 v99, v99, v121
    v_mul_f32 v100, v100, v121
    v_mul_f32 v101, v101, v121
    v_mul_f32 v102, v102, v121
    v_mul_f32 v103, v103, v121
    v_mul_f32 v104, v104, v121
    v_mul_f32 v105, v105, v121
    v_mul_f32 v106, v106, v121
    v_mul_f32 v107, v107, v121
    v_sub_f32 v48, v48, v120
    v_sub_f32 v49, v49, v120
    v_sub_f32 v50, v50, v120
    v_sub_f32 v51, v51, v120
    v_sub_f32 v52, v52, v120
    v_sub_f32 v53, v53, v120
    v_sub_f32 v54, v54, v120
    v_sub_f32 v55, v55, v120
    v_sub_f32 v56, v56, v120
    v_sub_f32 v57, v57, v120
    v_sub_f32 v58, v58, v120
    v_sub_f32 v59, v59, v120
    v_sub_f32 v60, v60, v120
    v_sub_f32 v61, v61, v120
    v_sub_f32 v62, v62, v120
    v_sub_f32 v63, v63, v120
    s_nop 15
    s_nop 7
    v_sub_f32 v80, v80, v120
    v_sub_f32 v81, v81, v120
    v_sub_f32 v82, v82, v120
    v_sub_f32 v83, v83, v120
    v_sub_f32 v84, v84, v120
    v_sub_f32 v85, v85, v120
    v_sub_f32 v86, v86, v120
    v_sub_f32 v87, v87, v120
    v_sub_f32 v88, v88, v120
    v_sub_f32 v89, v89, v120
    v_sub_f32 v90, v90, v120
    v_sub_f32 v91, v91, v120
    v_sub_f32 v92, v92, v120
    v_sub_f32 v93, v93, v120
    v_sub_f32 v94, v94, v120
    v_sub_f32 v95, v95, v120
    v_sub_f32 v64, v64, v120
    v_sub_f32 v65, v65, v120
    v_sub_f32 v66, v66, v120
    v_sub_f32 v67, v67, v120
    v_sub_f32 v68, v68, v120
    v_sub_f32 v69, v69, v120
    v_sub_f32 v70, v70, v120
    v_sub_f32 v71, v71, v120
    v_sub_f32 v72, v72, v120
    v_sub_f32 v73, v73, v120
    v_sub_f32 v74, v74, v120
    v_sub_f32 v75, v75, v120
    v_sub_f32 v76, v76, v120
    v_sub_f32 v77, v77, v120
    v_sub_f32 v78, v78, v120
    v_sub_f32 v79, v79, v120
    s_branch back_cnl0
resc_cntl:
    v_mov_b32 v121, v120
    v_mov_b32 v122, v120
    s_nop 1
    v_permlane32_swap_b32 v121, v122
    s_nop 1
    v_max_f32 v120, v121, v122
    v_max_f32 v120, 0, v120
    v_sub_f32 v121, 0, v120
    v_exp_f32 v121, v121
    s_nop 0
    v_mul_f32 v96, v96, v121
    v_mul_f32 v97, v97, v121
    v_mul_f32 v98, v98, v121
    v_mul_f32 v99, v99, v121
    v_mul_f32 v100, v100, v121
    v_mul_f32 v101, v101, v121
    v_mul_f32 v102, v102, v121
    v_mul_f32 v103, v103, v121
    v_mul_f32 v104, v104, v121
    v_mul_f32 v105, v105, v121
    v_mul_f32 v106, v106, v121
    v_mul_f32 v107, v107, v121
    v_sub_f32 v64, v64, v120
    v_sub_f32 v65, v65, v120
    v_sub_f32 v66, v66, v120
    v_sub_f32 v67, v67, v120
    v_sub_f32 v68, v68, v120
    v_sub_f32 v69, v69, v120
    v_sub_f32 v70, v70, v120
    v_sub_f32 v71, v71, v120
    v_sub_f32 v72, v72, v120
    v_sub_f32 v73, v73, v120
    v_sub_f32 v74, v74, v120
    v_sub_f32 v75, v75, v120
    v_sub_f32 v76, v76, v120
    v_sub_f32 v77, v77, v120
    v_sub_f32 v78, v78, v120
    v_sub_f32 v79, v79, v120
    s_nop 15
    s_nop 7
    v_sub_f32 v80, v80, v120
    v_sub_f32 v81, v81, v120
    v_sub_f32 v82, v82, v120
    v_sub_f32 v83, v83, v120
    v_sub_f32 v84, v84, v120
    v_sub_f32 v85, v85, v120
    v_sub_f32 v86, v86, v120
    v_sub_f32 v87, v87, v120
    v_sub_f32 v88, v88, v120
    v_sub_f32 v89, v89, v120
    v_sub_f32 v90, v90, v120
    v_sub_f32 v91, v91, v120
    v_sub_f32 v92, v92, v120
    v_sub_f32 v93, v93, v120
    v_sub_f32 v94, v94, v120
    v_sub_f32 v95, v95, v120
    v_sub_f32 v48, v48, v120
    v_sub_f32 v49, v49, v120
    v_sub_f32 v50, v50, v120
    v_sub_f32 v51, v51, v120
    v_sub_f32 v52, v52, v120
    v_sub_f32 v53, v53, v120
    v_sub_f32 v54, v54, v120
    v_sub_f32 v55, v55, v120
    v_sub_f32 v56, v56, v120
    v_sub_f32 v57, v57, v120
    v_sub_f32 v58, v58, v120
    v_sub_f32 v59, v59, v120
    v_sub_f32 v60, v60, v120
    v_sub_f32 v61, v61, v120
    v_sub_f32 v62, v62, v120
    v_sub_f32 v63, v63, v120
    s_branch back_cntl
attn_done:
    s_endpgm
down_kernel_body:
    s_cmp_ge_u32 s2, 256
    s_cbranch_scc1 down_done
    s_load_dwordx2 s[40:41], s[0:1], 48
    s_load_dwordx2 s[44:45], s[0:1], 80
    v_lshrrev_b32 v1, 6, v0
    s_nop 0
    v_readfirstlane_b32 s24, v1
    v_and_b32 v0, 63, v0
    s_and_b32 s30, s2, 7
    s_lshl_b32 s30, s30, 5
    s_lshr_b32 s31, s2, 3
    s_add_u32 s30, s30, s31
    s_and_b32 s31, s30, 3
    s_lshr_b32 s32, s30, 6
    s_bfe_u32 s30, s30, 0x40002
    s_waitcnt lgkmcnt(0)
    s_add_u32 s8, s44, 8388608
    s_addc_u32 s9, s45, 0
    s_mov_b32 s10, 18874368
    s_mov_b32 s11, 0x00020000
    s_mov_b32 s12, s40
    s_mov_b32 s13, s41
    s_mov_b32 s14, 5308416
    s_mov_b32 s15, 0x00020000
    s_add_u32 s20, s44, 33554432
    s_addc_u32 s21, s45, 0
    s_mov_b32 s22, 18874368
    s_mov_b32 s23, 0x00020000
    s_and_b32 s29, s24, 3
    s_lshr_b32 s33, s24, 2
    s_and_b32 s34, s24, 3
    v_lshrrev_b32 v10, 2, v0
    v_lshrrev_b32 v11, 4, v0
    v_sub_u32 v11, 4, v11
    v_and_b32 v11, 3, v11
    v_and_b32 v12, 3, v0
    v_xor_b32 v12, v12, v11
    s_lshl_b32 s26, s24, 4
    v_add_u32 v10, s26, v10
    s_mov_b32 s26, 9216
    v_mul_lo_u32 v10, v10, s26
    v_lshl_add_u32 v2, v12, 4, v10
    v_add_u32 v3, 589824, v2
    v_lshrrev_b32 v10, 3, v0
    v_bfe_u32 v11, v0, 4, 1
    s_and_b32 s26, s34, 1
    s_lshl_b32 s26, s26, 1
    v_or_b32 v11, s26, v11
    v_bfe_u32 v12, v0, 1, 2
    v_xor_b32 v12, v12, v11
    v_and_b32 v13, 1, v0
    v_lshlrev_b32 v13, 4, v13
    v_lshl_add_u32 v13, v12, 5, v13
    s_lshl_b32 s26, s34, 3
    v_add_u32 v10, s26, v10
    s_mov_b32 s26, 1152
    v_mul_lo_u32 v10, v10, s26
    v_add_u32 v4, v10, v13
    v_lshrrev_b32 v10, 1, v0
    s_lshl_b32 s26, s34, 3
    v_add_u32 v10, s26, v10
    s_and_b32 s26, s34, 1
    s_lshl_b32 s26, s26, 2
    v_xor_b32 v10, s26, v10
    s_mov_b32 s26, 1152
    v_mul_lo_u32 v10, v10, s26
    v_and_b32 v11, 1, v0
    v_lshl_add_u32 v10, v11, 4, v10
    v_add_u32 v5, 256, v10
    v_bfe_u32 v10, v0, 2, 2
    v_sub_u32 v10, 4, v10
    v_and_b32 v10, 3, v10
    v_lshrrev_b32 v11, 4, v0
    v_xor_b32 v10, v10, v11
    v_and_b32 v11, 15, v0
    s_mul_i32 s26, s29, 32
    v_add_u32 v11, s26, v11
    v_lshlrev_b32 v11, 6, v11
    v_lshl_add_u32 v14, v10, 4, v11
    s_mul_i32 s26, s33, 9216
    s_add_u32 s26, s26, 8192
    v_lshrrev_b32 v10, 4, v0
    v_bfe_u32 v11, v0, 2, 2
    v_lshl_add_u32 v11, v10, 3, v11
    v_and_b32 v12, 3, v0
    v_lshlrev_b32 v13, 7, v11
    v_lshl_add_u32 v13, v12, 3, v13
    v_add_u32 v13, s26, v13
    v_bfe_u32 v6, v0, 3, 1
    v_and_b32 v7, 1, v10
    v_lshl_or_b32 v6, v7, 1, v6
    v_xor_b32 v8, 0, v6
    v_lshl_add_u32 v16, v8, 5, v13
    v_xor_b32 v8, 1, v6
    v_lshl_add_u32 v17, v8, 5, v13
    v_xor_b32 v8, 2, v6
    v_lshl_add_u32 v18, v8, 5, v13
    v_xor_b32 v8, 3, v6
    v_lshl_add_u32 v19, v8, 5, v13
    v_lshlrev_b32 v13, 5, v11
    v_lshl_add_u32 v13, v12, 3, v13
    v_add_u32 v13, s26, v13
    v_add_u32 v13, 8192, v13
    v_lshl_add_u32 v20, v7, 7, v13
    v_xor_b32 v7, 1, v7
    v_lshl_add_u32 v21, v7, 7, v13
    s_lshl_b32 s25, s24, 10
    s_mul_i32 s38, s33, 9216
    s_add_u32 s38, s38, 8192
    s_lshl_b32 s26, s34, 8
    s_add_u32 s39, s38, s26
    s_add_u32 s39, s39, 8192
    s_lshl_b32 s26, s34, 10
    s_add_u32 s38, s38, s26
    s_mul_i32 s26, s30, 1179648
    s_mul_i32 s27, s32, 2304
    s_add_u32 s26, s26, s27
    s_mul_i32 s27, s32, 1327104
    s_mul_i32 s28, s31, 288
    s_add_u32 s27, s27, s28
    v_mov_b32 v54, 0
    v_mov_b32 v55, 0
    v_mov_b32 v56, 0
    v_mov_b32 v57, 0
    v_mov_b32 v58, 0
    v_mov_b32 v59, 0
    v_mov_b32 v60, 0
    v_mov_b32 v61, 0
    v_mov_b32 v62, 0
    v_mov_b32 v63, 0
    v_mov_b32 v64, 0
    v_mov_b32 v65, 0
    v_mov_b32 v66, 0
    v_mov_b32 v67, 0
    v_mov_b32 v68, 0
    v_mov_b32 v69, 0
    v_mov_b32 v70, 0
    v_mov_b32 v71, 0
    v_mov_b32 v72, 0
    v_mov_b32 v73, 0
    v_mov_b32 v74, 0
    v_mov_b32 v75, 0
    v_mov_b32 v76, 0
    v_mov_b32 v77, 0
    v_mov_b32 v78, 0
    v_mov_b32 v79, 0
    v_mov_b32 v80, 0
    v_mov_b32 v81, 0
    v_mov_b32 v82, 0
    v_mov_b32 v83, 0
    v_mov_b32 v84, 0
    v_mov_b32 v85, 0
    v_mov_b32 v86, 0
    v_mov_b32 v87, 0
    v_mov_b32 v88, 0
    v_mov_b32 v89, 0
    v_mov_b32 v90, 0
    v_mov_b32 v91, 0
    v_mov_b32 v92, 0
    v_mov_b32 v93, 0
    v_mov_b32 v94, 0
    v_mov_b32 v95, 0
    v_mov_b32 v96, 0
    v_mov_b32 v97, 0
    v_mov_b32 v98, 0
    v_mov_b32 v99, 0
    v_mov_b32 v100, 0
    v_mov_b32 v101, 0
    v_mov_b32 v102, 0
    v_mov_b32 v103, 0
    v_mov_b32 v104, 0
    v_mov_b32 v105, 0
    v_mov_b32 v106, 0
    v_mov_b32 v107, 0
    v_mov_b32 v108, 0
    v_mov_b32 v109, 0
    v_mov_b32 v110, 0
    v_mov_b32 v111, 0
    v_mov_b32 v112, 0
    v_mov_b32 v113, 0
    v_mov_b32 v114, 0
    v_mov_b32 v115, 0
    v_mov_b32 v116, 0
    v_mov_b32 v117, 0
    v_mov_b32 v118, 0
    v_mov_b32 v119, 0
    v_mov_b32 v120, 0
    v_mov_b32 v121, 0
    v_mov_b32 v122, 0
    v_mov_b32 v123, 0
    v_mov_b32 v124, 0
    v_mov_b32 v125, 0
    s_add_u32 m0, s25, 0
    s_nop 0
    buffer_load_dwordx4 v2, s[8:11], s26 offen lds
    s_add_u32 m0, s25, 4096
    s_nop 0
    buffer_load_dwordx4 v3, s[8:11], s26 offen lds
    s_add_u32 m0, s38, 0
    s_add_u32 s28, s27, 128
    buffer_load_dwordx4 v4, s[12:15], s27 offen lds
    s_add_u32 m0, s38, 4096
    s_nop 0
    buffer_load_dwordx4 v4, s[12:15], s28 offen lds
    s_add_u32 m0, s39, 0
    s_mov_b64 exec, 0xffff
    buffer_load_dwordx4 v5, s[12:15], s27 offen lds
    s_mov_b64 exec, -1
    s_add_u32 s26, s26, 64
    s_add_u32 s27, s27, 36864
    s_add_u32 m0, s25, 17408
    s_nop 0
    buffer_load_dwordx4 v2, s[8:11], s26 offen lds
    s_add_u32 m0, s25, 21504
    s_nop 0
    buffer_load_dwordx4 v3, s[8:11], s26 offen lds
    s_add_u32 m0, s38, 17408
    s_add_u32 s28, s27, 128
    buffer_load_dwordx4 v4, s[12:15], s27 offen lds
    s_add_u32 m0, s38, 21504
    s_nop 0
    buffer_load_dwordx4 v4, s[12:15], s28 offen lds
    s_add_u32 m0, s39, 17408
    s_mov_b64 exec, 0xffff
    buffer_load_dwordx4 v5, s[12:15], s27 offen lds
    s_mov_b64 exec, -1
    s_add_u32 s26, s26, 64
    s_add_u32 s27, s27, 36864
    s_add_u32 m0, s25, 34816
    s_nop 0
    buffer_load_dwordx4 v2, s[8:11], s26 offen lds
    s_add_u32 m0, s25, 38912
    s_nop 0
    buffer_load_dwordx4 v3, s[8:11], s26 offen lds
    s_add_u32 m0, s38, 34816
    s_add_u32 s28, s27, 128
    buffer_load_dwordx4 v4, s[12:15], s27 offen lds
    s_add_u32 m0, s38, 38912
    s_nop 0
    buffer_load_dwordx4 v4, s[12:15], s28 offen lds
    s_add_u32 m0, s39, 34816
    s_mov_b64 exec, 0xffff
    buffer_load_dwordx4 v5, s[12:15], s27 offen lds
    s_mov_b64 exec, -1
    s_add_u32 s26, s26, 64
    s_add_u32 s27, s27, 36864
    s_waitcnt vmcnt(10)
    s_barrier
    ds_read_b128 v[6:9], v14 offset:0
    ds_read_b128 v[10:13], v14 offset:1024
    ds_read_b64_tr_b16 v[30:31], v16 offset:0
    ds_read_b64_tr_b16 v[32:33], v16 offset:512
    ds_read_b64_tr_b16 v[34:35], v17 offset:0
    ds_read_b64_tr_b16 v[36:37], v17 offset:512
    ds_read_b64_tr_b16 v[38:39], v18 offset:0
    ds_read_b64_tr_b16 v[40:41], v18 offset:512
    s_waitcnt lgkmcnt(0)
    ds_read_b64_tr_b16 v[42:43], v19 offset:0
    ds_read_b64_tr_b16 v[44:45], v19 offset:512
    ds_read_b64_tr_b16 v[46:47], v16 offset:4096
    ds_read_b64_tr_b16 v[48:49], v16 offset:4608
    ds_read_b64_tr_b16 v[50:51], v17 offset:4096
    ds_read_b64_tr_b16 v[52:53], v17 offset:4608
    s_add_u32 m0, s25, 52224
    s_nop 0
    buffer_load_dwordx4 v2, s[8:11], s26 offen lds
    s_add_u32 m0, s25, 56320
    s_nop 0
    buffer_load_dwordx4 v3, s[8:11], s26 offen lds
    s_add_u32 m0, s38, 52224
    s_add_u32 s28, s27, 128
    buffer_load_dwordx4 v4, s[12:15], s27 offen lds
    s_add_u32 m0, s38, 56320
    s_nop 0
    buffer_load_dwordx4 v4, s[12:15], s28 offen lds
    s_add_u32 m0, s39, 52224
    s_mov_b64 exec, 0xffff
    buffer_load_dwordx4 v5, s[12:15], s27 offen lds
    s_mov_b64 exec, -1
    s_add_u32 s26, s26, 64
    s_add_u32 s27, s27, 36864
    v_mfma_f32_16x16x32_bf16 v[54:57], v[30:33], v[6:9], v[54:57]
    v_mfma_f32_16x16x32_bf16 v[58:61], v[30:33], v[10:13], v[58:61]
    v_mfma_f32_16x16x32_bf16 v[62:65], v[34:37], v[6:9], v[62:65]
    v_mfma_f32_16x16x32_bf16 v[66:69], v[34:37], v[10:13], v[66:69]
    v_mfma_f32_16x16x32_bf16 v[70:73], v[38:41], v[6:9], v[70:73]
    v_mfma_f32_16x16x32_bf16 v[74:77], v[38:41], v[10:13], v[74:77]
    s_waitcnt lgkmcnt(0)
    ds_read_b64_tr_b16 v[30:31], v18 offset:4096
    ds_read_b64_tr_b16 v[32:33], v18 offset:4608
    ds_read_b64_tr_b16 v[34:35], v19 offset:4096
    ds_read_b64_tr_b16 v[36:37], v19 offset:4608
    ds_read_b64_tr_b16 v[38:39], v20
    ds_read_b64_tr_b16 v[40:41], v21
    v_mfma_f32_16x16x32_bf16 v[78:81], v[42:45], v[6:9], v[78:81]
    v_mfma_f32_16x16x32_bf16 v[82:85], v[42:45], v[10:13], v[82:85]
    v_mfma_f32_16x16x32_bf16 v[86:89], v[46:49], v[6:9], v[86:89]
    v_mfma_f32_16x16x32_bf16 v[90:93], v[46:49], v[10:13], v[90:93]
    v_mfma_f32_16x16x32_bf16 v[94:97], v[50:53], v[6:9], v[94:97]
    v_mfma_f32_16x16x32_bf16 v[98:101], v[50:53], v[10:13], v[98:101]
    s_waitcnt lgkmcnt(0)
    s_waitcnt vmcnt(10)
    s_barrier
    v_add_u32 v14, 17408, v14
    v_add_u32 v16, 17408, v16
    v_add_u32 v17, 17408, v17
    v_add_u32 v18, 17408, v18
    v_add_u32 v19, 17408, v19
    v_add_u32 v20, 17408, v20
    v_add_u32 v21, 17408, v21
    ds_read_b128 v[22:25], v14 offset:0
    ds_read_b128 v[26:29], v14 offset:1024
    ds_read_b64_tr_b16 v[42:43], v16 offset:0
    ds_read_b64_tr_b16 v[44:45], v16 offset:512
    ds_read_b64_tr_b16 v[46:47], v17 offset:0
    ds_read_b64_tr_b16 v[48:49], v17 offset:512
    ds_read_b64_tr_b16 v[50:51], v18 offset:0
    ds_read_b64_tr_b16 v[52:53], v18 offset:512
    v_mfma_f32_16x16x32_bf16 v[102:105], v[30:33], v[6:9], v[102:105]
    v_mfma_f32_16x16x32_bf16 v[106:109], v[30:33], v[10:13], v[106:109]
    v_mfma_f32_16x16x32_bf16 v[110:113], v[34:37], v[6:9], v[110:113]
    v_mfma_f32_16x16x32_bf16 v[114:117], v[34:37], v[10:13], v[114:117]
    v_mfma_f32_16x16x32_bf16 v[118:121], v[38:41], v[6:9], v[118:121]
    v_mfma_f32_16x16x32_bf16 v[122:125], v[38:41], v[10:13], v[122:125]
    s_waitcnt lgkmcnt(0)
    ds_read_b64_tr_b16 v[30:31], v19 offset:0
    ds_read_b64_tr_b16 v[32:33], v19 offset:512
    ds_read_b64_tr_b16 v[34:35], v16 offset:4096
    ds_read_b64_tr_b16 v[36:37], v16 offset:4608
    ds_read_b64_tr_b16 v[38:39], v17 offset:4096
    ds_read_b64_tr_b16 v[40:41], v17 offset:4608
    s_add_u32 m0, s25, 0
    s_nop 0
    buffer_load_dwordx4 v2, s[8:11], s26 offen lds
    s_add_u32 m0, s25, 4096
    s_nop 0
    buffer_load_dwordx4 v3, s[8:11], s26 offen lds
    s_add_u32 m0, s38, 0
    s_add_u32 s28, s27, 128
    buffer_load_dwordx4 v4, s[12:15], s27 offen lds
    s_add_u32 m0, s38, 4096
    s_nop 0
    buffer_load_dwordx4 v4, s[12:15], s28 offen lds
    s_add_u32 m0, s39, 0
    s_mov_b64 exec, 0xffff
    buffer_load_dwordx4 v5, s[12:15], s27 offen lds
    s_mov_b64 exec, -1
    s_add_u32 s26, s26, 64
    s_add_u32 s27, s27, 36864
    v_mfma_f32_16x16x32_bf16 v[54:57], v[42:45], v[22:25], v[54:57]
    v_mfma_f32_16x16x32_bf16 v[58:61], v[42:45], v[26:29], v[58:61]
    v_mfma_f32_16x16x32_bf16 v[62:65], v[46:49], v[22:25], v[62:65]
    v_mfma_f32_16x16x32_bf16 v[66:69], v[46:49], v[26:29], v[66:69]
    v_mfma_f32_16x16x32_bf16 v[70:73], v[50:53], v[22:25], v[70:73]
    v_mfma_f32_16x16x32_bf16 v[74:77], v[50:53], v[26:29], v[74:77]
    s_waitcnt lgkmcnt(0)
    ds_read_b64_tr_b16 v[42:43], v18 offset:4096
    ds_read_b64_tr_b16 v[44:45], v18 offset:4608
    ds_read_b64_tr_b16 v[46:47], v19 offset:4096
    ds_read_b64_tr_b16 v[48:49], v19 offset:4608
    ds_read_b64_tr_b16 v[50:51], v20
    ds_read_b64_tr_b16 v[52:53], v21
    v_mfma_f32_16x16x32_bf16 v[78:81], v[30:33], v[22:25], v[78:81]
    v_mfma_f32_16x16x32_bf16 v[82:85], v[30:33], v[26:29], v[82:85]
    v_mfma_f32_16x16x32_bf16 v[86:89], v[34:37], v[22:25], v[86:89]
    v_mfma_f32_16x16x32_bf16 v[90:93], v[34:37], v[26:29], v[90:93]
    v_mfma_f32_16x16x32_bf16 v[94:97], v[38:41], v[22:25], v[94:97]
    v_mfma_f32_16x16x32_bf16 v[98:101], v[38:41], v[26:29], v[98:101]
    s_waitcnt lgkmcnt(0)
    s_waitcnt vmcnt(10)
    s_barrier
    v_add_u32 v14, 17408, v14
    v_add_u32 v16, 17408, v16
    v_add_u32 v17, 17408, v17
    v_add_u32 v18, 17408, v18
    v_add_u32 v19, 17408, v19
    v_add_u32 v20, 17408, v20
    v_add_u32 v21, 17408, v21
    ds_read_b128 v[6:9], v14 offset:0
    ds_read_b128 v[10:13], v14 offset:1024
    ds_read_b64_tr_b16 v[30:31], v16 offset:0
    ds_read_b64_tr_b16 v[32:33], v16 offset:512
    ds_read_b64_tr_b16 v[34:35], v17 offset:0
    ds_read_b64_tr_b16 v[36:37], v17 offset:512
    ds_read_b64_tr_b16 v[38:39], v18 offset:0
    ds_read_b64_tr_b16 v[40:41], v18 offset:512
    v_mfma_f32_16x16x32_bf16 v[102:105], v[42:45], v[22:25], v[102:105]
    v_mfma_f32_16x16x32_bf16 v[106:109], v[42:45], v[26:29], v[106:109]
    v_mfma_f32_16x16x32_bf16 v[110:113], v[46:49], v[22:25], v[110:113]
    v_mfma_f32_16x16x32_bf16 v[114:117], v[46:49], v[26:29], v[114:117]
    v_mfma_f32_16x16x32_bf16 v[118:121], v[50:53], v[22:25], v[118:121]
    v_mfma_f32_16x16x32_bf16 v[122:125], v[50:53], v[26:29], v[122:125]
    s_waitcnt lgkmcnt(0)
    ds_read_b64_tr_b16 v[42:43], v19 offset:0
    ds_read_b64_tr_b16 v[44:45], v19 offset:512
    ds_read_b64_tr_b16 v[46:47], v16 offset:4096
    ds_read_b64_tr_b16 v[48:49], v16 offset:4608
    ds_read_b64_tr_b16 v[50:51], v17 offset:4096
    ds_read_b64_tr_b16 v[52:53], v17 offset:4608
    s_add_u32 m0, s25, 17408
    s_nop 0
    buffer_load_dwordx4 v2, s[8:11], s26 offen lds
    s_add_u32 m0, s25, 21504
    s_nop 0
    buffer_load_dwordx4 v3, s[8:11], s26 offen lds
    s_add_u32 m0, s38, 17408
    s_add_u32 s28, s27, 128
    buffer_load_dwordx4 v4, s[12:15], s27 offen lds
    s_add_u32 m0, s38, 21504
    s_nop 0
    buffer_load_dwordx4 v4, s[12:15], s28 offen lds
    s_add_u32 m0, s39, 17408
    s_mov_b64 exec, 0xffff
    buffer_load_dwordx4 v5, s[12:15], s27 offen lds
    s_mov_b64 exec, -1
    s_add_u32 s26, s26, 64
    s_add_u32 s27, s27, 36864
    v_mfma_f32_16x16x32_bf16 v[54:57], v[30:33], v[6:9], v[54:57]
    v_mfma_f32_16x16x32_bf16 v[58:61], v[30:33], v[10:13], v[58:61]
    v_mfma_f32_16x16x32_bf16 v[62:65], v[34:37], v[6:9], v[62:65]
    v_mfma_f32_16x16x32_bf16 v[66:69], v[34:37], v[10:13], v[66:69]
    v_mfma_f32_16x16x32_bf16 v[70:73], v[38:41], v[6:9], v[70:73]
    v_mfma_f32_16x16x32_bf16 v[74:77], v[38:41], v[10:13], v[74:77]
    s_waitcnt lgkmcnt(0)
    ds_read_b64_tr_b16 v[30:31], v18 offset:4096
    ds_read_b64_tr_b16 v[32:33], v18 offset:4608
    ds_read_b64_tr_b16 v[34:35], v19 offset:4096
    ds_read_b64_tr_b16 v[36:37], v19 offset:4608
    ds_read_b64_tr_b16 v[38:39], v20
    ds_read_b64_tr_b16 v[40:41], v21
    v_mfma_f32_16x16x32_bf16 v[78:81], v[42:45], v[6:9], v[78:81]
    v_mfma_f32_16x16x32_bf16 v[82:85], v[42:45], v[10:13], v[82:85]
    v_mfma_f32_16x16x32_bf16 v[86:89], v[46:49], v[6:9], v[86:89]
    v_mfma_f32_16x16x32_bf16 v[90:93], v[46:49], v[10:13], v[90:93]
    v_mfma_f32_16x16x32_bf16 v[94:97], v[50:53], v[6:9], v[94:97]
    v_mfma_f32_16x16x32_bf16 v[98:101], v[50:53], v[10:13], v[98:101]
    s_waitcnt lgkmcnt(0)
    s_waitcnt vmcnt(10)
    s_barrier
    v_add_u32 v14, 17408, v14
    v_add_u32 v16, 17408, v16
    v_add_u32 v17, 17408, v17
    v_add_u32 v18, 17408, v18
    v_add_u32 v19, 17408, v19
    v_add_u32 v20, 17408, v20
    v_add_u32 v21, 17408, v21
    ds_read_b128 v[22:25], v14 offset:0
    ds_read_b128 v[26:29], v14 offset:1024
    ds_read_b64_tr_b16 v[42:43], v16 offset:0
    ds_read_b64_tr_b16 v[44:45], v16 offset:512
    ds_read_b64_tr_b16 v[46:47], v17 offset:0
    ds_read_b64_tr_b16 v[48:49], v17 offset:512
    ds_read_b64_tr_b16 v[50:51], v18 offset:0
    ds_read_b64_tr_b16 v[52:53], v18 offset:512
    v_mfma_f32_16x16x32_bf16 v[102:105], v[30:33], v[6:9], v[102:105]
    v_mfma_f32_16x16x32_bf16 v[106:109], v[30:33], v[10:13], v[106:109]
    v_mfma_f32_16x16x32_bf16 v[110:113], v[34:37], v[6:9], v[110:113]
    v_mfma_f32_16x16x32_bf16 v[114:117], v[34:37], v[10:13], v[114:117]
    v_mfma_f32_16x16x32_bf16 v[118:121], v[38:41], v[6:9], v[118:121]
    v_mfma_f32_16x16x32_bf16 v[122:125], v[38:41], v[10:13], v[122:125]
    s_waitcnt lgkmcnt(0)
    ds_read_b64_tr_b16 v[30:31], v19 offset:0
    ds_read_b64_tr_b16 v[32:33], v19 offset:512
    ds_read_b64_tr_b16 v[34:35], v16 offset:4096
    ds_read_b64_tr_b16 v[36:37], v16 offset:4608
    ds_read_b64_tr_b16 v[38:39], v17 offset:4096
    ds_read_b64_tr_b16 v[40:41], v17 offset:4608
    s_add_u32 m0, s25, 34816
    s_nop 0
    buffer_load_dwordx4 v2, s[8:11], s26 offen lds
    s_add_u32 m0, s25, 38912
    s_nop 0
    buffer_load_dwordx4 v3, s[8:11], s26 offen lds
    s_add_u32 m0, s38, 34816
    s_add_u32 s28, s27, 128
    buffer_load_dwordx4 v4, s[12:15], s27 offen lds
    s_add_u32 m0, s38, 38912
    s_nop 0
    buffer_load_dwordx4 v4, s[12:15], s28 offen lds
    s_add_u32 m0, s39, 34816
    s_mov_b64 exec, 0xffff
    buffer_load_dwordx4 v5, s[12:15], s27 offen lds
    s_mov_b64 exec, -1
    s_add_u32 s26, s26, 64
    s_add_u32 s27, s27, 36864
    v_mfma_f32_16x16x32_bf16 v[54:57], v[42:45], v[22:25], v[54:57]
    v_mfma_f32_16x16x32_bf16 v[58:61], v[42:45], v[26:29], v[58:61]
    v_mfma_f32_16x16x32_bf16 v[62:65], v[46:49], v[22:25], v[62:65]
    v_mfma_f32_16x16x32_bf16 v[66:69], v[46:49], v[26:29], v[66:69]
    v_mfma_f32_16x16x32_bf16 v[70:73], v[50:53], v[22:25], v[70:73]
    v_mfma_f32_16x16x32_bf16 v[74:77], v[50:53], v[26:29], v[74:77]
    s_waitcnt lgkmcnt(0)
    ds_read_b64_tr_b16 v[42:43], v18 offset:4096
    ds_read_b64_tr_b16 v[44:45], v18 offset:4608
    ds_read_b64_tr_b16 v[46:47], v19 offset:4096
    ds_read_b64_tr_b16 v[48:49], v19 offset:4608
    ds_read_b64_tr_b16 v[50:51], v20
    ds_read_b64_tr_b16 v[52:53], v21
    v_mfma_f32_16x16x32_bf16 v[78:81], v[30:33], v[22:25], v[78:81]
    v_mfma_f32_16x16x32_bf16 v[82:85], v[30:33], v[26:29], v[82:85]
    v_mfma_f32_16x16x32_bf16 v[86:89], v[34:37], v[22:25], v[86:89]
    v_mfma_f32_16x16x32_bf16 v[90:93], v[34:37], v[26:29], v[90:93]
    v_mfma_f32_16x16x32_bf16 v[94:97], v[38:41], v[22:25], v[94:97]
    v_mfma_f32_16x16x32_bf16 v[98:101], v[38:41], v[26:29], v[98:101]
    s_waitcnt lgkmcnt(0)
    s_waitcnt vmcnt(10)
    s_barrier
    v_subrev_u32 v14, 52224, v14
    v_subrev_u32 v16, 52224, v16
    v_subrev_u32 v17, 52224, v17
    v_subrev_u32 v18, 52224, v18
    v_subrev_u32 v19, 52224, v19
    v_subrev_u32 v20, 52224, v20
    v_subrev_u32 v21, 52224, v21
    ds_read_b128 v[6:9], v14 offset:0
    ds_read_b128 v[10:13], v14 offset:1024
    ds_read_b64_tr_b16 v[30:31], v16 offset:0
    ds_read_b64_tr_b16 v[32:33], v16 offset:512
    ds_read_b64_tr_b16 v[34:35], v17 offset:0
    ds_read_b64_tr_b16 v[36:37], v17 offset:512
    ds_read_b64_tr_b16 v[38:39], v18 offset:0
    ds_read_b64_tr_b16 v[40:41], v18 offset:512
    v_mfma_f32_16x16x32_bf16 v[102:105], v[42:45], v[22:25], v[102:105]
    v_mfma_f32_16x16x32_bf16 v[106:109], v[42:45], v[26:29], v[106:109]
    v_mfma_f32_16x16x32_bf16 v[110:113], v[46:49], v[22:25], v[110:113]
    v_mfma_f32_16x16x32_bf16 v[114:117], v[46:49], v[26:29], v[114:117]
    v_mfma_f32_16x16x32_bf16 v[118:121], v[50:53], v[22:25], v[118:121]
    v_mfma_f32_16x16x32_bf16 v[122:125], v[50:53], v[26:29], v[122:125]
    s_waitcnt lgkmcnt(0)
    ds_read_b64_tr_b16 v[42:43], v19 offset:0
    ds_read_b64_tr_b16 v[44:45], v19 offset:512
    ds_read_b64_tr_b16 v[46:47], v16 offset:4096
    ds_read_b64_tr_b16 v[48:49], v16 offset:4608
    ds_read_b64_tr_b16 v[50:51], v17 offset:4096
    ds_read_b64_tr_b16 v[52:53], v17 offset:4608
    s_add_u32 m0, s25, 52224
    s_nop 0
    buffer_load_dwordx4 v2, s[8:11], s26 offen lds
    s_add_u32 m0, s25, 56320
    s_nop 0
    buffer_load_dwordx4 v3, s[8:11], s26 offen lds
    s_add_u32 m0, s38, 52224
    s_add_u32 s28, s27, 128
    buffer_load_dwordx4 v4, s[12:15], s27 offen lds
    s_add_u32 m0, s38, 56320
    s_nop 0
    buffer_load_dwordx4 v4, s[12:15], s28 offen lds
    s_add_u32 m0, s39, 52224
    s_mov_b64 exec, 0xffff
    buffer_load_dwordx4 v5, s[12:15], s27 offen lds
    s_mov_b64 exec, -1
    s_add_u32 s26, s26, 64
    s_add_u32 s27, s27, 36864
    v_mfma_f32_16x16x32_bf16 v[54:57], v[30:33], v[6:9], v[54:57]
    v_mfma_f32_16x16x32_bf16 v[58:61], v[30:33], v[10:13], v[58:61]
    v_mfma_f32_16x16x32_bf16 v[62:65], v[34:37], v[6:9], v[62:65]
    v_mfma_f32_16x16x32_bf16 v[66:69], v[34:37], v[10:13], v[66:69]
    v_mfma_f32_16x16x32_bf16 v[70:73], v[38:41], v[6:9], v[70:73]
    v_mfma_f32_16x16x32_bf16 v[74:77], v[38:41], v[10:13], v[74:77]
    s_waitcnt lgkmcnt(0)
    ds_read_b64_tr_b16 v[30:31], v18 offset:4096
    ds_read_b64_tr_b16 v[32:33], v18 offset:4608
    ds_read_b64_tr_b16 v[34:35], v19 offset:4096
    ds_read_b64_tr_b16 v[36:37], v19 offset:4608
    ds_read_b64_tr_b16 v[38:39], v20
    ds_read_b64_tr_b16 v[40:41], v21
    v_mfma_f32_16x16x32_bf16 v[78:81], v[42:45], v[6:9], v[78:81]
    v_mfma_f32_16x16x32_bf16 v[82:85], v[42:45], v[10:13], v[82:85]
    v_mfma_f32_16x16x32_bf16 v[86:89], v[46:49], v[6:9], v[86:89]
    v_mfma_f32_16x16x32_bf16 v[90:93], v[46:49], v[10:13], v[90:93]
    v_mfma_f32_16x16x32_bf16 v[94:97], v[50:53], v[6:9], v[94:97]
    v_mfma_f32_16x16x32_bf16 v[98:101], v[50:53], v[10:13], v[98:101]
    s_waitcnt lgkmcnt(0)
    s_waitcnt vmcnt(10)
    s_barrier
    v_add_u32 v14, 17408, v14
    v_add_u32 v16, 17408, v16
    v_add_u32 v17, 17408, v17
    v_add_u32 v18, 17408, v18
    v_add_u32 v19, 17408, v19
    v_add_u32 v20, 17408, v20
    v_add_u32 v21, 17408, v21
    ds_read_b128 v[22:25], v14 offset:0
    ds_read_b128 v[26:29], v14 offset:1024
    ds_read_b64_tr_b16 v[42:43], v16 offset:0
    ds_read_b64_tr_b16 v[44:45], v16 offset:512
    ds_read_b64_tr_b16 v[46:47], v17 offset:0
    ds_read_b64_tr_b16 v[48:49], v17 offset:512
    ds_read_b64_tr_b16 v[50:51], v18 offset:0
    ds_read_b64_tr_b16 v[52:53], v18 offset:512
    v_mfma_f32_16x16x32_bf16 v[102:105], v[30:33], v[6:9], v[102:105]
    v_mfma_f32_16x16x32_bf16 v[106:109], v[30:33], v[10:13], v[106:109]
    v_mfma_f32_16x16x32_bf16 v[110:113], v[34:37], v[6:9], v[110:113]
    v_mfma_f32_16x16x32_bf16 v[114:117], v[34:37], v[10:13], v[114:117]
    v_mfma_f32_16x16x32_bf16 v[118:121], v[38:41], v[6:9], v[118:121]
    v_mfma_f32_16x16x32_bf16 v[122:125], v[38:41], v[10:13], v[122:125]
    s_mov_b32 s37, 0
down_loop:
    s_waitcnt lgkmcnt(0)
    ds_read_b64_tr_b16 v[30:31], v19 offset:0
    ds_read_b64_tr_b16 v[32:33], v19 offset:512
    ds_read_b64_tr_b16 v[34:35], v16 offset:4096
    ds_read_b64_tr_b16 v[36:37], v16 offset:4608
    ds_read_b64_tr_b16 v[38:39], v17 offset:4096
    ds_read_b64_tr_b16 v[40:41], v17 offset:4608
    s_add_u32 m0, s25, 0
    s_nop 0
    buffer_load_dwordx4 v2, s[8:11], s26 offen lds
    s_add_u32 m0, s25, 4096
    s_nop 0
    buffer_load_dwordx4 v3, s[8:11], s26 offen lds
    s_add_u32 m0, s38, 0
    s_add_u32 s28, s27, 128
    buffer_load_dwordx4 v4, s[12:15], s27 offen lds
    s_add_u32 m0, s38, 4096
    s_nop 0
    buffer_load_dwordx4 v4, s[12:15], s28 offen lds
    s_add_u32 m0, s39, 0
    s_mov_b64 exec, 0xffff
    buffer_load_dwordx4 v5, s[12:15], s27 offen lds
    s_mov_b64 exec, -1
    s_add_u32 s26, s26, 64
    s_add_u32 s27, s27, 36864
    v_mfma_f32_16x16x32_bf16 v[54:57], v[42:45], v[22:25], v[54:57]
    v_mfma_f32_16x16x32_bf16 v[58:61], v[42:45], v[26:29], v[58:61]
    v_mfma_f32_16x16x32_bf16 v[62:65], v[46:49], v[22:25], v[62:65]
    v_mfma_f32_16x16x32_bf16 v[66:69], v[46:49], v[26:29], v[66:69]
    v_mfma_f32_16x16x32_bf16 v[70:73], v[50:53], v[22:25], v[70:73]
    v_mfma_f32_16x16x32_bf16 v[74:77], v[50:53], v[26:29], v[74:77]
    s_waitcnt lgkmcnt(0)
    ds_read_b64_tr_b16 v[42:43], v18 offset:4096
    ds_read_b64_tr_b16 v[44:45], v18 offset:4608
    ds_read_b64_tr_b16 v[46:47], v19 offset:4096
    ds_read_b64_tr_b16 v[48:49], v19 offset:4608
    ds_read_b64_tr_b16 v[50:51], v20
    ds_read_b64_tr_b16 v[52:53], v21
    v_mfma_f32_16x16x32_bf16 v[78:81], v[30:33], v[22:25], v[78:81]
    v_mfma_f32_16x16x32_bf16 v[82:85], v[30:33], v[26:29], v[82:85]
    v_mfma_f32_16x16x32_bf16 v[86:89], v[34:37], v[22:25], v[86:89]
    v_mfma_f32_16x16x32_bf16 v[90:93], v[34:37], v[26:29], v[90:93]
    v_mfma_f32_16x16x32_bf16 v[94:97], v[38:41], v[22:25], v[94:97]
    v_mfma_f32_16x16x32_bf16 v[98:101], v[38:41], v[26:29], v[98:101]
    s_waitcnt lgkmcnt(0)
    s_waitcnt vmcnt(10)
    s_barrier
    v_add_u32 v14, 17408, v14
    v_add_u32 v16, 17408, v16
    v_add_u32 v17, 17408, v17
    v_add_u32 v18, 17408, v18
    v_add_u32 v19, 17408, v19
    v_add_u32 v20, 17408, v20
    v_add_u32 v21, 17408, v21
    ds_read_b128 v[6:9], v14 offset:0
    ds_read_b128 v[10:13], v14 offset:1024
    ds_read_b64_tr_b16 v[30:31], v16 offset:0
    ds_read_b64_tr_b16 v[32:33], v16 offset:512
    ds_read_b64_tr_b16 v[34:35], v17 offset:0
    ds_read_b64_tr_b16 v[36:37], v17 offset:512
    ds_read_b64_tr_b16 v[38:39], v18 offset:0
    ds_read_b64_tr_b16 v[40:41], v18 offset:512
    v_mfma_f32_16x16x32_bf16 v[102:105], v[42:45], v[22:25], v[102:105]
    v_mfma_f32_16x16x32_bf16 v[106:109], v[42:45], v[26:29], v[106:109]
    v_mfma_f32_16x16x32_bf16 v[110:113], v[46:49], v[22:25], v[110:113]
    v_mfma_f32_16x16x32_bf16 v[114:117], v[46:49], v[26:29], v[114:117]
    v_mfma_f32_16x16x32_bf16 v[118:121], v[50:53], v[22:25], v[118:121]
    v_mfma_f32_16x16x32_bf16 v[122:125], v[50:53], v[26:29], v[122:125]
    s_waitcnt lgkmcnt(0)
    ds_read_b64_tr_b16 v[42:43], v19 offset:0
    ds_read_b64_tr_b16 v[44:45], v19 offset:512
    ds_read_b64_tr_b16 v[46:47], v16 offset:4096
    ds_read_b64_tr_b16 v[48:49], v16 offset:4608
    ds_read_b64_tr_b16 v[50:51], v17 offset:4096
    ds_read_b64_tr_b16 v[52:53], v17 offset:4608
    s_add_u32 m0, s25, 17408
    s_nop 0
    buffer_load_dwordx4 v2, s[8:11], s26 offen lds
    s_add_u32 m0, s25, 21504
    s_nop 0
    buffer_load_dwordx4 v3, s[8:11], s26 offen lds
    s_add_u32 m0, s38, 17408
    s_add_u32 s28, s27, 128
    buffer_load_dwordx4 v4, s[12:15], s27 offen lds
    s_add_u32 m0, s38, 21504
    s_nop 0
    buffer_load_dwordx4 v4, s[12:15], s28 offen lds
    s_add_u32 m0, s39, 17408
    s_mov_b64 exec, 0xffff
    buffer_load_dwordx4 v5, s[12:15], s27 offen lds
    s_mov_b64 exec, -1
    s_add_u32 s26, s26, 64
    s_add_u32 s27, s27, 36864
    v_mfma_f32_16x16x32_bf16 v[54:57], v[30:33], v[6:9], v[54:57]
    v_mfma_f32_16x16x32_bf16 v[58:61], v[30:33], v[10:13], v[58:61]
    v_mfma_f32_16x16x32_bf16 v[62:65], v[34:37], v[6:9], v[62:65]
    v_mfma_f32_16x16x32_bf16 v[66:69], v[34:37], v[10:13], v[66:69]
    v_mfma_f32_16x16x32_bf16 v[70:73], v[38:41], v[6:9], v[70:73]
    v_mfma_f32_16x16x32_bf16 v[74:77], v[38:41], v[10:13], v[74:77]
    s_waitcnt lgkmcnt(0)
    ds_read_b64_tr_b16 v[30:31], v18 offset:4096
    ds_read_b64_tr_b16 v[32:33], v18 offset:4608
    ds_read_b64_tr_b16 v[34:35], v19 offset:4096
    ds_read_b64_tr_b16 v[36:37], v19 offset:4608
    ds_read_b64_tr_b16 v[38:39], v20
    ds_read_b64_tr_b16 v[40:41], v21
    v_mfma_f32_16x16x32_bf16 v[78:81], v[42:45], v[6:9], v[78:81]
    v_mfma_f32_16x16x32_bf16 v[82:85], v[42:45], v[10:13], v[82:85]
    v_mfma_f32_16x16x32_bf16 v[86:89], v[46:49], v[6:9], v[86:89]
    v_mfma_f32_16x16x32_bf16 v[90:93], v[46:49], v[10:13], v[90:93]
    v_mfma_f32_16x16x32_bf16 v[94:97], v[50:53], v[6:9], v[94:97]
    v_mfma_f32_16x16x32_bf16 v[98:101], v[50:53], v[10:13], v[98:101]
    s_waitcnt lgkmcnt(0)
    s_waitcnt vmcnt(10)
    s_barrier
    v_add_u32 v14, 17408, v14
    v_add_u32 v16, 17408, v16
    v_add_u32 v17, 17408, v17
    v_add_u32 v18, 17408, v18
    v_add_u32 v19, 17408, v19
    v_add_u32 v20, 17408, v20
    v_add_u32 v21, 17408, v21
    ds_read_b128 v[22:25], v14 offset:0
    ds_read_b128 v[26:29], v14 offset:1024
    ds_read_b64_tr_b16 v[42:43], v16 offset:0
    ds_read_b64_tr_b16 v[44:45], v16 offset:512
    ds_read_b64_tr_b16 v[46:47], v17 offset:0
    ds_read_b64_tr_b16 v[48:49], v17 offset:512
    ds_read_b64_tr_b16 v[50:51], v18 offset:0
    ds_read_b64_tr_b16 v[52:53], v18 offset:512
    v_mfma_f32_16x16x32_bf16 v[102:105], v[30:33], v[6:9], v[102:105]
    v_mfma_f32_16x16x32_bf16 v[106:109], v[30:33], v[10:13], v[106:109]
    v_mfma_f32_16x16x32_bf16 v[110:113], v[34:37], v[6:9], v[110:113]
    v_mfma_f32_16x16x32_bf16 v[114:117], v[34:37], v[10:13], v[114:117]
    v_mfma_f32_16x16x32_bf16 v[118:121], v[38:41], v[6:9], v[118:121]
    v_mfma_f32_16x16x32_bf16 v[122:125], v[38:41], v[10:13], v[122:125]
    s_waitcnt lgkmcnt(0)
    ds_read_b64_tr_b16 v[30:31], v19 offset:0
    ds_read_b64_tr_b16 v[32:33], v19 offset:512
    ds_read_b64_tr_b16 v[34:35], v16 offset:4096
    ds_read_b64_tr_b16 v[36:37], v16 offset:4608
    ds_read_b64_tr_b16 v[38:39], v17 offset:4096
    ds_read_b64_tr_b16 v[40:41], v17 offset:4608
    s_add_u32 m0, s25, 34816
    s_nop 0
    buffer_load_dwordx4 v2, s[8:11], s26 offen lds
    s_add_u32 m0, s25, 38912
    s_nop 0
    buffer_load_dwordx4 v3, s[8:11], s26 offen lds
    s_add_u32 m0, s38, 34816
    s_add_u32 s28, s27, 128
    buffer_load_dwordx4 v4, s[12:15], s27 offen lds
    s_add_u32 m0, s38, 38912
    s_nop 0
    buffer_load_dwordx4 v4, s[12:15], s28 offen lds
    s_add_u32 m0, s39, 34816
    s_mov_b64 exec, 0xffff
    buffer_load_dwordx4 v5, s[12:15], s27 offen lds
    s_mov_b64 exec, -1
    s_add_u32 s26, s26, 64
    s_add_u32 s27, s27, 36864
    v_mfma_f32_16x16x32_bf16 v[54:57], v[42:45], v[22:25], v[54:57]
    v_mfma_f32_16x16x32_bf16 v[58:61], v[42:45], v[26:29], v[58:61]
    v_mfma_f32_16x16x32_bf16 v[62:65], v[46:49], v[22:25], v[62:65]
    v_mfma_f32_16x16x32_bf16 v[66:69], v[46:49], v[26:29], v[66:69]
    v_mfma_f32_16x16x32_bf16 v[70:73], v[50:53], v[22:25], v[70:73]
    v_mfma_f32_16x16x32_bf16 v[74:77], v[50:53], v[26:29], v[74:77]
    s_waitcnt lgkmcnt(0)
    ds_read_b64_tr_b16 v[42:43], v18 offset:4096
    ds_read_b64_tr_b16 v[44:45], v18 offset:4608
    ds_read_b64_tr_b16 v[46:47], v19 offset:4096
    ds_read_b64_tr_b16 v[48:49], v19 offset:4608
    ds_read_b64_tr_b16 v[50:51], v20
    ds_read_b64_tr_b16 v[52:53], v21
    v_mfma_f32_16x16x32_bf16 v[78:81], v[30:33], v[22:25], v[78:81]
    v_mfma_f32_16x16x32_bf16 v[82:85], v[30:33], v[26:29], v[82:85]
    v_mfma_f32_16x16x32_bf16 v[86:89], v[34:37], v[22:25], v[86:89]
    v_mfma_f32_16x16x32_bf16 v[90:93], v[34:37], v[26:29], v[90:93]
    v_mfma_f32_16x16x32_bf16 v[94:97], v[38:41], v[22:25], v[94:97]
    v_mfma_f32_16x16x32_bf16 v[98:101], v[38:41], v[26:29], v[98:101]
    s_waitcnt lgkmcnt(0)
    s_waitcnt vmcnt(10)
    s_barrier
    v_subrev_u32 v14, 52224, v14
    v_subrev_u32 v16, 52224, v16
    v_subrev_u32 v17, 52224, v17
    v_subrev_u32 v18, 52224, v18
    v_subrev_u32 v19, 52224, v19
    v_subrev_u32 v20, 52224, v20
    v_subrev_u32 v21, 52224, v21
    ds_read_b128 v[6:9], v14 offset:0
    ds_read_b128 v[10:13], v14 offset:1024
    ds_read_b64_tr_b16 v[30:31], v16 offset:0
    ds_read_b64_tr_b16 v[32:33], v16 offset:512
    ds_read_b64_tr_b16 v[34:35], v17 offset:0
    ds_read_b64_tr_b16 v[36:37], v17 offset:512
    ds_read_b64_tr_b16 v[38:39], v18 offset:0
    ds_read_b64_tr_b16 v[40:41], v18 offset:512
    v_mfma_f32_16x16x32_bf16 v[102:105], v[42:45], v[22:25], v[102:105]
    v_mfma_f32_16x16x32_bf16 v[106:109], v[42:45], v[26:29], v[106:109]
    v_mfma_f32_16x16x32_bf16 v[110:113], v[46:49], v[22:25], v[110:113]
    v_mfma_f32_16x16x32_bf16 v[114:117], v[46:49], v[26:29], v[114:117]
    v_mfma_f32_16x16x32_bf16 v[118:121], v[50:53], v[22:25], v[118:121]
    v_mfma_f32_16x16x32_bf16 v[122:125], v[50:53], v[26:29], v[122:125]
    s_waitcnt lgkmcnt(0)
    ds_read_b64_tr_b16 v[42:43], v19 offset:0
    ds_read_b64_tr_b16 v[44:45], v19 offset:512
    ds_read_b64_tr_b16 v[46:47], v16 offset:4096
    ds_read_b64_tr_b16 v[48:49], v16 offset:4608
    ds_read_b64_tr_b16 v[50:51], v17 offset:4096
    ds_read_b64_tr_b16 v[52:53], v17 offset:4608
    s_add_u32 m0, s25, 52224
    s_nop 0
    buffer_load_dwordx4 v2, s[8:11], s26 offen lds
    s_add_u32 m0, s25, 56320
    s_nop 0
    buffer_load_dwordx4 v3, s[8:11], s26 offen lds
    s_add_u32 m0, s38, 52224
    s_add_u32 s28, s27, 128
    buffer_load_dwordx4 v4, s[12:15], s27 offen lds
    s_add_u32 m0, s38, 56320
    s_nop 0
    buffer_load_dwordx4 v4, s[12:15], s28 offen lds
    s_add_u32 m0, s39, 52224
    s_mov_b64 exec, 0xffff
    buffer_load_dwordx4 v5, s[12:15], s27 offen lds
    s_mov_b64 exec, -1
    s_add_u32 s26, s26, 64
    s_add_u32 s27, s27, 36864
    v_mfma_f32_16x16x32_bf16 v[54:57], v[30:33], v[6:9], v[54:57]
    v_mfma_f32_16x16x32_bf16 v[58:61], v[30:33], v[10:13], v[58:61]
    v_mfma_f32_16x16x32_bf16 v[62:65], v[34:37], v[6:9], v[62:65]
    v_mfma_f32_16x16x32_bf16 v[66:69], v[34:37], v[10:13], v[66:69]
    v_mfma_f32_16x16x32_bf16 v[70:73], v[38:41], v[6:9], v[70:73]
    v_mfma_f32_16x16x32_bf16 v[74:77], v[38:41], v[10:13], v[74:77]
    s_waitcnt lgkmcnt(0)
    ds_read_b64_tr_b16 v[30:31], v18 offset:4096
    ds_read_b64_tr_b16 v[32:33], v18 offset:4608
    ds_read_b64_tr_b16 v[34:35], v19 offset:4096
    ds_read_b64_tr_b16 v[36:37], v19 offset:4608
    ds_read_b64_tr_b16 v[38:39], v20
    ds_read_b64_tr_b16 v[40:41], v21
    v_mfma_f32_16x16x32_bf16 v[78:81], v[42:45], v[6:9], v[78:81]
    v_mfma_f32_16x16x32_bf16 v[82:85], v[42:45], v[10:13], v[82:85]
    v_mfma_f32_16x16x32_bf16 v[86:89], v[46:49], v[6:9], v[86:89]
    v_mfma_f32_16x16x32_bf16 v[90:93], v[46:49], v[10:13], v[90:93]
    v_mfma_f32_16x16x32_bf16 v[94:97], v[50:53], v[6:9], v[94:97]
    v_mfma_f32_16x16x32_bf16 v[98:101], v[50:53], v[10:13], v[98:101]
    s_waitcnt lgkmcnt(0)
    s_waitcnt vmcnt(10)
    s_barrier
    v_add_u32 v14, 17408, v14
    v_add_u32 v16, 17408, v16
    v_add_u32 v17, 17408, v17
    v_add_u32 v18, 17408, v18
    v_add_u32 v19, 17408, v19
    v_add_u32 v20, 17408, v20
    v_add_u32 v21, 17408, v21
    ds_read_b128 v[22:25], v14 offset:0
    ds_read_b128 v[26:29], v14 offset:1024
    ds_read_b64_tr_b16 v[42:43], v16 offset:0
    ds_read_b64_tr_b16 v[44:45], v16 offset:512
    ds_read_b64_tr_b16 v[46:47], v17 offset:0
    ds_read_b64_tr_b16 v[48:49], v17 offset:512
    ds_read_b64_tr_b16 v[50:51], v18 offset:0
    ds_read_b64_tr_b16 v[52:53], v18 offset:512
    v_mfma_f32_16x16x32_bf16 v[102:105], v[30:33], v[6:9], v[102:105]
    v_mfma_f32_16x16x32_bf16 v[106:109], v[30:33], v[10:13], v[106:109]
    v_mfma_f32_16x16x32_bf16 v[110:113], v[34:37], v[6:9], v[110:113]
    v_mfma_f32_16x16x32_bf16 v[114:117], v[34:37], v[10:13], v[114:117]
    v_mfma_f32_16x16x32_bf16 v[118:121], v[38:41], v[6:9], v[118:121]
    v_mfma_f32_16x16x32_bf16 v[122:125], v[38:41], v[10:13], v[122:125]
    s_add_u32 s37, s37, 1
    s_cmp_lt_u32 s37, 7
    s_cbranch_scc1 down_loop
    s_waitcnt lgkmcnt(0)
    ds_read_b64_tr_b16 v[30:31], v19 offset:0
    ds_read_b64_tr_b16 v[32:33], v19 offset:512
    ds_read_b64_tr_b16 v[34:35], v16 offset:4096
    ds_read_b64_tr_b16 v[36:37], v16 offset:4608
    ds_read_b64_tr_b16 v[38:39], v17 offset:4096
    ds_read_b64_tr_b16 v[40:41], v17 offset:4608
    v_mfma_f32_16x16x32_bf16 v[54:57], v[42:45], v[22:25], v[54:57]
    v_mfma_f32_16x16x32_bf16 v[58:61], v[42:45], v[26:29], v[58:61]
    v_mfma_f32_16x16x32_bf16 v[62:65], v[46:49], v[22:25], v[62:65]
    v_mfma_f32_16x16x32_bf16 v[66:69], v[46:49], v[26:29], v[66:69]
    v_mfma_f32_16x16x32_bf16 v[70:73], v[50:53], v[22:25], v[70:73]
    v_mfma_f32_16x16x32_bf16 v[74:77], v[50:53], v[26:29], v[74:77]
    s_waitcnt lgkmcnt(0)
    ds_read_b64_tr_b16 v[42:43], v18 offset:4096
    ds_read_b64_tr_b16 v[44:45], v18 offset:4608
    ds_read_b64_tr_b16 v[46:47], v19 offset:4096
    ds_read_b64_tr_b16 v[48:49], v19 offset:4608
    ds_read_b64_tr_b16 v[50:51], v20
    ds_read_b64_tr_b16 v[52:53], v21
    v_mfma_f32_16x16x32_bf16 v[78:81], v[30:33], v[22:25], v[78:81]
    v_mfma_f32_16x16x32_bf16 v[82:85], v[30:33], v[26:29], v[82:85]
    v_mfma_f32_16x16x32_bf16 v[86:89], v[34:37], v[22:25], v[86:89]
    v_mfma_f32_16x16x32_bf16 v[90:93], v[34:37], v[26:29], v[90:93]
    v_mfma_f32_16x16x32_bf16 v[94:97], v[38:41], v[22:25], v[94:97]
    v_mfma_f32_16x16x32_bf16 v[98:101], v[38:41], v[26:29], v[98:101]
    s_waitcnt lgkmcnt(0)
    s_waitcnt vmcnt(5)
    s_barrier
    v_add_u32 v14, 17408, v14
    v_add_u32 v16, 17408, v16
    v_add_u32 v17, 17408, v17
    v_add_u32 v18, 17408, v18
    v_add_u32 v19, 17408, v19
    v_add_u32 v20, 17408, v20
    v_add_u32 v21, 17408, v21
    ds_read_b128 v[6:9], v14 offset:0
    ds_read_b128 v[10:13], v14 offset:1024
    ds_read_b64_tr_b16 v[30:31], v16 offset:0
    ds_read_b64_tr_b16 v[32:33], v16 offset:512
    ds_read_b64_tr_b16 v[34:35], v17 offset:0
    ds_read_b64_tr_b16 v[36:37], v17 offset:512
    ds_read_b64_tr_b16 v[38:39], v18 offset:0
    ds_read_b64_tr_b16 v[40:41], v18 offset:512
    v_mfma_f32_16x16x32_bf16 v[102:105], v[42:45], v[22:25], v[102:105]
    v_mfma_f32_16x16x32_bf16 v[106:109], v[42:45], v[26:29], v[106:109]
    v_mfma_f32_16x16x32_bf16 v[110:113], v[46:49], v[22:25], v[110:113]
    v_mfma_f32_16x16x32_bf16 v[114:117], v[46:49], v[26:29], v[114:117]
    v_mfma_f32_16x16x32_bf16 v[118:121], v[50:53], v[22:25], v[118:121]
    v_mfma_f32_16x16x32_bf16 v[122:125], v[50:53], v[26:29], v[122:125]
    s_waitcnt lgkmcnt(0)
    ds_read_b64_tr_b16 v[42:43], v19 offset:0
    ds_read_b64_tr_b16 v[44:45], v19 offset:512
    ds_read_b64_tr_b16 v[46:47], v16 offset:4096
    ds_read_b64_tr_b16 v[48:49], v16 offset:4608
    ds_read_b64_tr_b16 v[50:51], v17 offset:4096
    ds_read_b64_tr_b16 v[52:53], v17 offset:4608
    v_mfma_f32_16x16x32_bf16 v[54:57], v[30:33], v[6:9], v[54:57]
    v_mfma_f32_16x16x32_bf16 v[58:61], v[30:33], v[10:13], v[58:61]
    v_mfma_f32_16x16x32_bf16 v[62:65], v[34:37], v[6:9], v[62:65]
    v_mfma_f32_16x16x32_bf16 v[66:69], v[34:37], v[10:13], v[66:69]
    v_mfma_f32_16x16x32_bf16 v[70:73], v[38:41], v[6:9], v[70:73]
    v_mfma_f32_16x16x32_bf16 v[74:77], v[38:41], v[10:13], v[74:77]
    s_waitcnt lgkmcnt(0)
    ds_read_b64_tr_b16 v[30:31], v18 offset:4096
    ds_read_b64_tr_b16 v[32:33], v18 offset:4608
    ds_read_b64_tr_b16 v[34:35], v19 offset:4096
    ds_read_b64_tr_b16 v[36:37], v19 offset:4608
    ds_read_b64_tr_b16 v[38:39], v20
    ds_read_b64_tr_b16 v[40:41], v21
    v_mfma_f32_16x16x32_bf16 v[78:81], v[42:45], v[6:9], v[78:81]
    v_mfma_f32_16x16x32_bf16 v[82:85], v[42:45], v[10:13], v[82:85]
    v_mfma_f32_16x16x32_bf16 v[86:89], v[46:49], v[6:9], v[86:89]
    v_mfma_f32_16x16x32_bf16 v[90:93], v[46:49], v[10:13], v[90:93]
    v_mfma_f32_16x16x32_bf16 v[94:97], v[50:53], v[6:9], v[94:97]
    v_mfma_f32_16x16x32_bf16 v[98:101], v[50:53], v[10:13], v[98:101]
    s_waitcnt lgkmcnt(0)
    s_waitcnt vmcnt(0)
    s_barrier
    v_add_u32 v14, 17408, v14
    v_add_u32 v16, 17408, v16
    v_add_u32 v17, 17408, v17
    v_add_u32 v18, 17408, v18
    v_add_u32 v19, 17408, v19
    v_add_u32 v20, 17408, v20
    v_add_u32 v21, 17408, v21
    ds_read_b128 v[22:25], v14 offset:0
    ds_read_b128 v[26:29], v14 offset:1024
    ds_read_b64_tr_b16 v[42:43], v16 offset:0
    ds_read_b64_tr_b16 v[44:45], v16 offset:512
    ds_read_b64_tr_b16 v[46:47], v17 offset:0
    ds_read_b64_tr_b16 v[48:49], v17 offset:512
    ds_read_b64_tr_b16 v[50:51], v18 offset:0
    ds_read_b64_tr_b16 v[52:53], v18 offset:512
    v_mfma_f32_16x16x32_bf16 v[102:105], v[30:33], v[6:9], v[102:105]
    v_mfma_f32_16x16x32_bf16 v[106:109], v[30:33], v[10:13], v[106:109]
    v_mfma_f32_16x16x32_bf16 v[110:113], v[34:37], v[6:9], v[110:113]
    v_mfma_f32_16x16x32_bf16 v[114:117], v[34:37], v[10:13], v[114:117]
    v_mfma_f32_16x16x32_bf16 v[118:121], v[38:41], v[6:9], v[118:121]
    v_mfma_f32_16x16x32_bf16 v[122:125], v[38:41], v[10:13], v[122:125]
    s_waitcnt lgkmcnt(0)
    ds_read_b64_tr_b16 v[30:31], v19 offset:0
    ds_read_b64_tr_b16 v[32:33], v19 offset:512
    ds_read_b64_tr_b16 v[34:35], v16 offset:4096
    ds_read_b64_tr_b16 v[36:37], v16 offset:4608
    ds_read_b64_tr_b16 v[38:39], v17 offset:4096
    ds_read_b64_tr_b16 v[40:41], v17 offset:4608
    v_mfma_f32_16x16x32_bf16 v[54:57], v[42:45], v[22:25], v[54:57]
    v_mfma_f32_16x16x32_bf16 v[58:61], v[42:45], v[26:29], v[58:61]
    v_mfma_f32_16x16x32_bf16 v[62:65], v[46:49], v[22:25], v[62:65]
    v_mfma_f32_16x16x32_bf16 v[66:69], v[46:49], v[26:29], v[66:69]
    v_mfma_f32_16x16x32_bf16 v[70:73], v[50:53], v[22:25], v[70:73]
    v_mfma_f32_16x16x32_bf16 v[74:77], v[50:53], v[26:29], v[74:77]
    s_waitcnt lgkmcnt(0)
    ds_read_b64_tr_b16 v[42:43], v18 offset:4096
    ds_read_b64_tr_b16 v[44:45], v18 offset:4608
    ds_read_b64_tr_b16 v[46:47], v19 offset:4096
    ds_read_b64_tr_b16 v[48:49], v19 offset:4608
    ds_read_b64_tr_b16 v[50:51], v20
    ds_read_b64_tr_b16 v[52:53], v21
    v_mfma_f32_16x16x32_bf16 v[78:81], v[30:33], v[22:25], v[78:81]
    v_mfma_f32_16x16x32_bf16 v[82:85], v[30:33], v[26:29], v[82:85]
    v_mfma_f32_16x16x32_bf16 v[86:89], v[34:37], v[22:25], v[86:89]
    v_mfma_f32_16x16x32_bf16 v[90:93], v[34:37], v[26:29], v[90:93]
    v_mfma_f32_16x16x32_bf16 v[94:97], v[38:41], v[22:25], v[94:97]
    v_mfma_f32_16x16x32_bf16 v[98:101], v[38:41], v[26:29], v[98:101]
    s_waitcnt lgkmcnt(0)
    v_mfma_f32_16x16x32_bf16 v[102:105], v[42:45], v[22:25], v[102:105]
    v_mfma_f32_16x16x32_bf16 v[106:109], v[42:45], v[26:29], v[106:109]
    v_mfma_f32_16x16x32_bf16 v[110:113], v[46:49], v[22:25], v[110:113]
    v_mfma_f32_16x16x32_bf16 v[114:117], v[46:49], v[26:29], v[114:117]
    v_mfma_f32_16x16x32_bf16 v[118:121], v[50:53], v[22:25], v[118:121]
    v_mfma_f32_16x16x32_bf16 v[122:125], v[50:53], v[26:29], v[122:125]
    s_nop 15
    s_nop 7
    v_and_b32 v10, 15, v0
    s_lshl_b32 s26, s29, 5
    v_add_u32 v10, s26, v10
    v_mul_u32_u24 v10, 2304, v10
    v_lshrrev_b32 v11, 4, v0
    v_lshl_add_u32 v10, v11, 4, v10
    s_lshl_b32 s26, s32, 11
    s_lshl_b32 s27, s30, 7
    s_add_u32 s26, s26, s27
    s_mul_i32 s26, s26, 2304
    s_mul_i32 s27, s31, 576
    s_add_u32 s26, s26, s27
    s_add_u32 s27, s26, 36864
    buffer_store_dwordx4 v[54:57], v10, s[20:23], s26 offen offset:0
    buffer_store_dwordx4 v[58:61], v10, s[20:23], s27 offen offset:0
    buffer_store_dwordx4 v[62:65], v10, s[20:23], s26 offen offset:64
    buffer_store_dwordx4 v[66:69], v10, s[20:23], s27 offen offset:64
    buffer_store_dwordx4 v[70:73], v10, s[20:23], s26 offen offset:128
    buffer_store_dwordx4 v[74:77], v10, s[20:23], s27 offen offset:128
    buffer_store_dwordx4 v[78:81], v10, s[20:23], s26 offen offset:192
    buffer_store_dwordx4 v[82:85], v10, s[20:23], s27 offen offset:192
    buffer_store_dwordx4 v[86:89], v10, s[20:23], s26 offen offset:256
    buffer_store_dwordx4 v[90:93], v10, s[20:23], s27 offen offset:256
    buffer_store_dwordx4 v[94:97], v10, s[20:23], s26 offen offset:320
    buffer_store_dwordx4 v[98:101], v10, s[20:23], s27 offen offset:320
    buffer_store_dwordx4 v[102:105], v10, s[20:23], s26 offen offset:384
    buffer_store_dwordx4 v[106:109], v10, s[20:23], s27 offen offset:384
    buffer_store_dwordx4 v[110:113], v10, s[20:23], s26 offen offset:448
    buffer_store_dwordx4 v[114:117], v10, s[20:23], s27 offen offset:448
    buffer_store_dwordx4 v[118:121], v10, s[20:23], s26 offen offset:512
    buffer_store_dwordx4 v[122:125], v10, s[20:23], s27 offen offset:512
    s_or_b32 s26, s31, s32
    s_cmp_lg_u32 s26, 0
    s_cbranch_scc1 down_done
    s_load_dwordx2 s[46:47], s[0:1], 56
    s_load_dwordx2 s[48:49], s[0:1], 0
    s_waitcnt lgkmcnt(0) vmcnt(0)
    s_mov_b32 s52, s46
    s_mov_b32 s53, s47
    s_mov_b32 s54, 1152
    s_mov_b32 s55, 0x00020000
    s_mov_b32 s56, s48
    s_mov_b32 s57, s49
    s_mov_b32 s58, 2359296
    s_mov_b32 s59, 0x00020000
    s_add_u32 s60, s44, 7340032
    s_addc_u32 s61, s45, 0
    s_mov_b32 s62, 8192
    s_mov_b32 s63, 0x00020000
    v_and_b32 v11, 3, v0
    v_mul_u32_u24 v11, 288, v11
    v_lshrrev_b32 v10, 2, v0
    s_lshl_b32 s33, s24, 5
    s_lshl_b32 s34, s30, 7
    s_add_u32 s33, s33, s34
    s_add_u32 s33, s33, 0
    v_add_u32 v13, s33, v10
    v_mul_u32_u24 v10, 1152, v13
    v_add_u32 v10, v10, v11
    v_mov_b32 v12, 0
    buffer_load_dwordx4 v[20:23], v11, s[52:55], 0 offen offset:0
    buffer_load_dwordx4 v[60:63], v10, s[56:59], 0 offen offset:0
    buffer_load_dwordx4 v[24:27], v11, s[52:55], 0 offen offset:16
    buffer_load_dwordx4 v[64:67], v10, s[56:59], 0 offen offset:16
    buffer_load_dwordx4 v[28:31], v11, s[52:55], 0 offen offset:32
    buffer_load_dwordx4 v[68:71], v10, s[56:59], 0 offen offset:32
    buffer_load_dwordx4 v[32:35], v11, s[52:55], 0 offen offset:48
    buffer_load_dwordx4 v[72:75], v10, s[56:59], 0 offen offset:48
    buffer_load_dwordx4 v[36:39], v11, s[52:55], 0 offen offset:64
    buffer_load_dwordx4 v[76:79], v10, s[56:59], 0 offen offset:64
    buffer_load_dwordx4 v[40:43], v11, s[52:55], 0 offen offset:80
    buffer_load_dwordx4 v[80:83], v10, s[56:59], 0 offen offset:80
    buffer_load_dwordx4 v[44:47], v11, s[52:55], 0 offen offset:96
    buffer_load_dwordx4 v[84:87], v10, s[56:59], 0 offen offset:96
    buffer_load_dwordx4 v[48:51], v11, s[52:55], 0 offen offset:112
    buffer_load_dwordx4 v[88:91], v10, s[56:59], 0 offen offset:112
    buffer_load_dwordx4 v[52:55], v11, s[52:55], 0 offen offset:128
    buffer_load_dwordx4 v[92:95], v10, s[56:59], 0 offen offset:128
    s_waitcnt vmcnt(0)
    v_dot2_f32_bf16 v12, v60, v20, v12
    v_dot2_f32_bf16 v12, v61, v21, v12
    v_dot2_f32_bf16 v12, v62, v22, v12
    v_dot2_f32_bf16 v12, v63, v23, v12
    v_dot2_f32_bf16 v12, v64, v24, v12
    v_dot2_f32_bf16 v12, v65, v25, v12
    v_dot2_f32_bf16 v12, v66, v26, v12
    v_dot2_f32_bf16 v12, v67, v27, v12
    v_dot2_f32_bf16 v12, v68, v28, v12
    v_dot2_f32_bf16 v12, v69, v29, v12
    v_dot2_f32_bf16 v12, v70, v30, v12
    v_dot2_f32_bf16 v12, v71, v31, v12
    v_dot2_f32_bf16 v12, v72, v32, v12
    v_dot2_f32_bf16 v12, v73, v33, v12
    v_dot2_f32_bf16 v12, v74, v34, v12
    v_dot2_f32_bf16 v12, v75, v35, v12
    v_dot2_f32_bf16 v12, v76, v36, v12
    v_dot2_f32_bf16 v12, v77, v37, v12
    v_dot2_f32_bf16 v12, v78, v38, v12
    v_dot2_f32_bf16 v12, v79, v39, v12
    v_dot2_f32_bf16 v12, v80, v40, v12
    v_dot2_f32_bf16 v12, v81, v41, v12
    v_dot2_f32_bf16 v12, v82, v42, v12
    v_dot2_f32_bf16 v12, v83, v43, v12
    v_dot2_f32_bf16 v12, v84, v44, v12
    v_dot2_f32_bf16 v12, v85, v45, v12
    v_dot2_f32_bf16 v12, v86, v46, v12
    v_dot2_f32_bf16 v12, v87, v47, v12
    v_dot2_f32_bf16 v12, v88, v48, v12
    v_dot2_f32_bf16 v12, v89, v49, v12
    v_dot2_f32_bf16 v12, v90, v50, v12
    v_dot2_f32_bf16 v12, v91, v51, v12
    v_dot2_f32_bf16 v12, v92, v52, v12
    v_dot2_f32_bf16 v12, v93, v53, v12
    v_dot2_f32_bf16 v12, v94, v54, v12
    v_dot2_f32_bf16 v12, v95, v55, v12
    buffer_load_dwordx4 v[20:23], v11, s[52:55], 0 offen offset:144
    buffer_load_dwordx4 v[60:63], v10, s[56:59], 0 offen offset:144
    buffer_load_dwordx4 v[24:27], v11, s[52:55], 0 offen offset:160
    buffer_load_dwordx4 v[64:67], v10, s[56:59], 0 offen offset:160
    buffer_load_dwordx4 v[28:31], v11, s[52:55], 0 offen offset:176
    buffer_load_dwordx4 v[68:71], v10, s[56:59], 0 offen offset:176
    buffer_load_dwordx4 v[32:35], v11, s[52:55], 0 offen offset:192
    buffer_load_dwordx4 v[72:75], v10, s[56:59], 0 offen offset:192
    buffer_load_dwordx4 v[36:39], v11, s[52:55], 0 offen offset:208
    buffer_load_dwordx4 v[76:79], v10, s[56:59], 0 offen offset:208
    buffer_load_dwordx4 v[40:43], v11, s[52:55], 0 offen offset:224
    buffer_load_dwordx4 v[80:83], v10, s[56:59], 0 offen offset:224
    buffer_load_dwordx4 v[44:47], v11, s[52:55], 0 offen offset:240
    buffer_load_dwordx4 v[84:87], v10, s[56:59], 0 offen offset:240
    buffer_load_dwordx4 v[48:51], v11, s[52:55], 0 offen offset:256
    buffer_load_dwordx4 v[88:91], v10, s[56:59], 0 offen offset:256
    buffer_load_dwordx4 v[52:55], v11, s[52:55], 0 offen offset:272
    buffer_load_dwordx4 v[92:95], v10, s[56:59], 0 offen offset:272
    s_waitcnt vmcnt(0)
    v_dot2_f32_bf16 v12, v60, v20, v12
    v_dot2_f32_bf16 v12, v61, v21, v12
    v_dot2_f32_bf16 v12, v62, v22, v12
    v_dot2_f32_bf16 v12, v63, v23, v12
    v_dot2_f32_bf16 v12, v64, v24, v12
    v_dot2_f32_bf16 v12, v65, v25, v12
    v_dot2_f32_bf16 v12, v66, v26, v12
    v_dot2_f32_bf16 v12, v67, v27, v12
    v_dot2_f32_bf16 v12, v68, v28, v12
    v_dot2_f32_bf16 v12, v69, v29, v12
    v_dot2_f32_bf16 v12, v70, v30, v12
    v_dot2_f32_bf16 v12, v71, v31, v12
    v_dot2_f32_bf16 v12, v72, v32, v12
    v_dot2_f32_bf16 v12, v73, v33, v12
    v_dot2_f32_bf16 v12, v74, v34, v12
    v_dot2_f32_bf16 v12, v75, v35, v12
    v_dot2_f32_bf16 v12, v76, v36, v12
    v_dot2_f32_bf16 v12, v77, v37, v12
    v_dot2_f32_bf16 v12, v78, v38, v12
    v_dot2_f32_bf16 v12, v79, v39, v12
    v_dot2_f32_bf16 v12, v80, v40, v12
    v_dot2_f32_bf16 v12, v81, v41, v12
    v_dot2_f32_bf16 v12, v82, v42, v12
    v_dot2_f32_bf16 v12, v83, v43, v12
    v_dot2_f32_bf16 v12, v84, v44, v12
    v_dot2_f32_bf16 v12, v85, v45, v12
    v_dot2_f32_bf16 v12, v86, v46, v12
    v_dot2_f32_bf16 v12, v87, v47, v12
    v_dot2_f32_bf16 v12, v88, v48, v12
    v_dot2_f32_bf16 v12, v89, v49, v12
    v_dot2_f32_bf16 v12, v90, v50, v12
    v_dot2_f32_bf16 v12, v91, v51, v12
    v_dot2_f32_bf16 v12, v92, v52, v12
    v_dot2_f32_bf16 v12, v93, v53, v12
    v_dot2_f32_bf16 v12, v94, v54, v12
    v_dot2_f32_bf16 v12, v95, v55, v12
    s_nop 3
    v_add_f32 v12, v12, v12 quad_perm:[1,0,3,2] row_mask:0xf bank_mask:0xf
    s_nop 1
    v_add_f32 v12, v12, v12 quad_perm:[2,3,0,1] row_mask:0xf bank_mask:0xf
    v_cvt_pk_bf16_f32 v12, v12, v12
    v_lshlrev_b32 v12, 16, v12
    v_mul_f32 v12, 0xbfb8aa3b, v12
    v_exp_f32 v12, v12
    s_nop 0
    v_add_f32 v12, 1.0, v12
    v_rcp_f32 v12, v12
    s_nop 0
    v_cvt_pk_bf16_f32 v12, v12, v12
    v_lshlrev_b32 v12, 16, v12
    v_lshlrev_b32 v13, 2, v13
    buffer_store_dword v12, v13, s[60:63], 0 offen
    v_lshrrev_b32 v10, 2, v0
    s_lshl_b32 s33, s24, 5
    s_lshl_b32 s34, s30, 7
    s_add_u32 s33, s33, s34
    s_add_u32 s33, s33, 16
    v_add_u32 v13, s33, v10
    v_mul_u32_u24 v10, 1152, v13
    v_add_u32 v10, v10, v11
    v_mov_b32 v12, 0
    buffer_load_dwordx4 v[20:23], v11, s[52:55], 0 offen offset:0
    buffer_load_dwordx4 v[60:63], v10, s[56:59], 0 offen offset:0
    buffer_load_dwordx4 v[24:27], v11, s[52:55], 0 offen offset:16
    buffer_load_dwordx4 v[64:67], v10, s[56:59], 0 offen offset:16
    buffer_load_dwordx4 v[28:31], v11, s[52:55], 0 offen offset:32
    buffer_load_dwordx4 v[68:71], v10, s[56:59], 0 offen offset:32
    buffer_load_dwordx4 v[32:35], v11, s[52:55], 0 offen offset:48
    buffer_load_dwordx4 v[72:75], v10, s[56:59], 0 offen offset:48
    buffer_load_dwordx4 v[36:39], v11, s[52:55], 0 offen offset:64
    buffer_load_dwordx4 v[76:79], v10, s[56:59], 0 offen offset:64
    buffer_load_dwordx4 v[40:43], v11, s[52:55], 0 offen offset:80
    buffer_load_dwordx4 v[80:83], v10, s[56:59], 0 offen offset:80
    buffer_load_dwordx4 v[44:47], v11, s[52:55], 0 offen offset:96
    buffer_load_dwordx4 v[84:87], v10, s[56:59], 0 offen offset:96
    buffer_load_dwordx4 v[48:51], v11, s[52:55], 0 offen offset:112
    buffer_load_dwordx4 v[88:91], v10, s[56:59], 0 offen offset:112
    buffer_load_dwordx4 v[52:55], v11, s[52:55], 0 offen offset:128
    buffer_load_dwordx4 v[92:95], v10, s[56:59], 0 offen offset:128
    s_waitcnt vmcnt(0)
    v_dot2_f32_bf16 v12, v60, v20, v12
    v_dot2_f32_bf16 v12, v61, v21, v12
    v_dot2_f32_bf16 v12, v62, v22, v12
    v_dot2_f32_bf16 v12, v63, v23, v12
    v_dot2_f32_bf16 v12, v64, v24, v12
    v_dot2_f32_bf16 v12, v65, v25, v12
    v_dot2_f32_bf16 v12, v66, v26, v12
    v_dot2_f32_bf16 v12, v67, v27, v12
    v_dot2_f32_bf16 v12, v68, v28, v12
    v_dot2_f32_bf16 v12, v69, v29, v12
    v_dot2_f32_bf16 v12, v70, v30, v12
    v_dot2_f32_bf16 v12, v71, v31, v12
    v_dot2_f32_bf16 v12, v72, v32, v12
    v_dot2_f32_bf16 v12, v73, v33, v12
    v_dot2_f32_bf16 v12, v74, v34, v12
    v_dot2_f32_bf16 v12, v75, v35, v12
    v_dot2_f32_bf16 v12, v76, v36, v12
    v_dot2_f32_bf16 v12, v77, v37, v12
    v_dot2_f32_bf16 v12, v78, v38, v12
    v_dot2_f32_bf16 v12, v79, v39, v12
    v_dot2_f32_bf16 v12, v80, v40, v12
    v_dot2_f32_bf16 v12, v81, v41, v12
    v_dot2_f32_bf16 v12, v82, v42, v12
    v_dot2_f32_bf16 v12, v83, v43, v12
    v_dot2_f32_bf16 v12, v84, v44, v12
    v_dot2_f32_bf16 v12, v85, v45, v12
    v_dot2_f32_bf16 v12, v86, v46, v12
    v_dot2_f32_bf16 v12, v87, v47, v12
    v_dot2_f32_bf16 v12, v88, v48, v12
    v_dot2_f32_bf16 v12, v89, v49, v12
    v_dot2_f32_bf16 v12, v90, v50, v12
    v_dot2_f32_bf16 v12, v91, v51, v12
    v_dot2_f32_bf16 v12, v92, v52, v12
    v_dot2_f32_bf16 v12, v93, v53, v12
    v_dot2_f32_bf16 v12, v94, v54, v12
    v_dot2_f32_bf16 v12, v95, v55, v12
    buffer_load_dwordx4 v[20:23], v11, s[52:55], 0 offen offset:144
    buffer_load_dwordx4 v[60:63], v10, s[56:59], 0 offen offset:144
    buffer_load_dwordx4 v[24:27], v11, s[52:55], 0 offen offset:160
    buffer_load_dwordx4 v[64:67], v10, s[56:59], 0 offen offset:160
    buffer_load_dwordx4 v[28:31], v11, s[52:55], 0 offen offset:176
    buffer_load_dwordx4 v[68:71], v10, s[56:59], 0 offen offset:176
    buffer_load_dwordx4 v[32:35], v11, s[52:55], 0 offen offset:192
    buffer_load_dwordx4 v[72:75], v10, s[56:59], 0 offen offset:192
    buffer_load_dwordx4 v[36:39], v11, s[52:55], 0 offen offset:208
    buffer_load_dwordx4 v[76:79], v10, s[56:59], 0 offen offset:208
    buffer_load_dwordx4 v[40:43], v11, s[52:55], 0 offen offset:224
    buffer_load_dwordx4 v[80:83], v10, s[56:59], 0 offen offset:224
    buffer_load_dwordx4 v[44:47], v11, s[52:55], 0 offen offset:240
    buffer_load_dwordx4 v[84:87], v10, s[56:59], 0 offen offset:240
    buffer_load_dwordx4 v[48:51], v11, s[52:55], 0 offen offset:256
    buffer_load_dwordx4 v[88:91], v10, s[56:59], 0 offen offset:256
    buffer_load_dwordx4 v[52:55], v11, s[52:55], 0 offen offset:272
    buffer_load_dwordx4 v[92:95], v10, s[56:59], 0 offen offset:272
    s_waitcnt vmcnt(0)
    v_dot2_f32_bf16 v12, v60, v20, v12
    v_dot2_f32_bf16 v12, v61, v21, v12
    v_dot2_f32_bf16 v12, v62, v22, v12
    v_dot2_f32_bf16 v12, v63, v23, v12
    v_dot2_f32_bf16 v12, v64, v24, v12
    v_dot2_f32_bf16 v12, v65, v25, v12
    v_dot2_f32_bf16 v12, v66, v26, v12
    v_dot2_f32_bf16 v12, v67, v27, v12
    v_dot2_f32_bf16 v12, v68, v28, v12
    v_dot2_f32_bf16 v12, v69, v29, v12
    v_dot2_f32_bf16 v12, v70, v30, v12
    v_dot2_f32_bf16 v12, v71, v31, v12
    v_dot2_f32_bf16 v12, v72, v32, v12
    v_dot2_f32_bf16 v12, v73, v33, v12
    v_dot2_f32_bf16 v12, v74, v34, v12
    v_dot2_f32_bf16 v12, v75, v35, v12
    v_dot2_f32_bf16 v12, v76, v36, v12
    v_dot2_f32_bf16 v12, v77, v37, v12
    v_dot2_f32_bf16 v12, v78, v38, v12
    v_dot2_f32_bf16 v12, v79, v39, v12
    v_dot2_f32_bf16 v12, v80, v40, v12
    v_dot2_f32_bf16 v12, v81, v41, v12
    v_dot2_f32_bf16 v12, v82, v42, v12
    v_dot2_f32_bf16 v12, v83, v43, v12
    v_dot2_f32_bf16 v12, v84, v44, v12
    v_dot2_f32_bf16 v12, v85, v45, v12
    v_dot2_f32_bf16 v12, v86, v46, v12
    v_dot2_f32_bf16 v12, v87, v47, v12
    v_dot2_f32_bf16 v12, v88, v48, v12
    v_dot2_f32_bf16 v12, v89, v49, v12
    v_dot2_f32_bf16 v12, v90, v50, v12
    v_dot2_f32_bf16 v12, v91, v51, v12
    v_dot2_f32_bf16 v12, v92, v52, v12
    v_dot2_f32_bf16 v12, v93, v53, v12
    v_dot2_f32_bf16 v12, v94, v54, v12
    v_dot2_f32_bf16 v12, v95, v55, v12
    s_nop 3
    v_add_f32 v12, v12, v12 quad_perm:[1,0,3,2] row_mask:0xf bank_mask:0xf
    s_nop 1
    v_add_f32 v12, v12, v12 quad_perm:[2,3,0,1] row_mask:0xf bank_mask:0xf
    v_cvt_pk_bf16_f32 v12, v12, v12
    v_lshlrev_b32 v12, 16, v12
    v_mul_f32 v12, 0xbfb8aa3b, v12
    v_exp_f32 v12, v12
    s_nop 0
    v_add_f32 v12, 1.0, v12
    v_rcp_f32 v12, v12
    s_nop 0
    v_cvt_pk_bf16_f32 v12, v12, v12
    v_lshlrev_b32 v12, 16, v12
    v_lshlrev_b32 v13, 2, v13
    buffer_store_dword v12, v13, s[60:63], 0 offen
down_done:
    s_endpgm
    .globl final_kernel
    .p2align 8
    .type final_kernel,@function
final_kernel:
    s_cmp_ge_u32 s2, 192
    s_cbranch_scc1 fin_done
    s_load_dwordx2 s[4:5], s[0:1], 0
    s_load_dwordx2 s[6:7], s[0:1], 16
    s_load_dwordx4 s[40:43], s[0:1], 48
    s_load_dwordx2 s[46:47], s[0:1], 64
    s_load_dwordx2 s[44:45], s[0:1], 80
    v_lshrrev_b32 v1, 6, v0
    s_nop 0
    v_readfirstlane_b32 s24, v1
    v_and_b32 v0, 63, v0
    s_lshl_b32 s25, s24, 10
    s_and_b32 s30, s2, 7
    s_mul_i32 s30, s30, 24
    s_lshr_b32 s31, s2, 3
    s_add_u32 s30, s30, s31
    s_lshr_b32 s31, s30, 5
    s_and_b32 s30, s30, 31
    s_waitcnt lgkmcnt(0)
    s_add_u32 s8, s44, 27262976
    s_addc_u32 s9, s45, 0
    s_mov_b32 s10, 2359296
    s_mov_b32 s11, 0x00020000
    s_mov_b32 s12, s6
    s_mov_b32 s13, s7
    s_mov_b32 s14, 663552
    s_mov_b32 s15, 0x00020000
    s_add_u32 s16, s44, 33554432
    s_addc_u32 s17, s45, 0
    s_mov_b32 s18, 18874368
    s_mov_b32 s19, 0x00020000
    s_mov_b32 s20, s40
    s_mov_b32 s21, s41
    s_mov_b32 s22, 5308416
    s_mov_b32 s23, 0x00020000
    s_add_u32 s48, s44, 7340032
    s_addc_u32 s49, s45, 0
    s_mov_b32 s50, 8192
    s_mov_b32 s51, 0x00020000
    s_mov_b32 s52, s42
    s_mov_b32 s53, s43
    s_mov_b32 s54, 1152
    s_mov_b32 s55, 0x00020000
    s_mov_b32 s56, s46
    s_mov_b32 s57, s47
    s_mov_b32 s58, 2359296
    s_mov_b32 s59, 0x00020000
    v_lshrrev_b32 v10, 2, v0
    v_lshrrev_b32 v11, 4, v0
    v_sub_u32 v11, 4, v11
    v_and_b32 v11, 3, v11
    v_and_b32 v12, 3, v0
    v_xor_b32 v12, v12, v11
    s_lshl_b32 s26, s24, 4
    v_add_u32 v10, s26, v10
    s_mov_b32 s26, 9216
    v_mul_lo_u32 v10, v10, s26
    v_lshl_add_u32 v2, v12, 4, v10
    v_lshrrev_b32 v10, 3, v0
    v_lshrrev_b32 v11, 4, v0
    v_and_b32 v11, 1, v11
    s_and_b32 s26, s24, 1
    s_lshl_b32 s26, s26, 1
    v_or_b32 v11, s26, v11
    v_bfe_u32 v12, v0, 1, 2
    v_xor_b32 v12, v12, v11
    v_and_b32 v13, 1, v0
    v_lshlrev_b32 v13, 4, v13
    v_lshl_add_u32 v13, v12, 5, v13
    s_lshl_b32 s26, s24, 3
    v_add_u32 v10, s26, v10
    s_mov_b32 s26, 1152
    v_mul_lo_u32 v10, v10, s26
    v_add_u32 v4, v10, v13
    v_cmp_lt_u32 vcc, 1, v12
    v_mov_b32 v5, 0x7f000000
    s_nop 1
    v_cndmask_b32 v5, v4, v5, vcc
    v_bfe_u32 v10, v0, 2, 2
    v_sub_u32 v10, 4, v10
    v_and_b32 v10, 3, v10
    v_lshrrev_b32 v11, 4, v0
    v_xor_b32 v10, v10, v11
    v_and_b32 v11, 15, v0
    s_lshr_b32 s26, s24, 1
    s_mul_i32 s26, s26, 32
    v_add_u32 v11, s26, v11
    v_lshlrev_b32 v11, 6, v11
    v_lshl_add_u32 v6, v10, 4, v11
    v_lshrrev_b32 v10, 4, v0
    v_bfe_u32 v11, v0, 2, 2
    v_lshl_add_u32 v11, v10, 3, v11
    v_lshlrev_b32 v11, 7, v11
    v_and_b32 v12, 3, v0
    v_lshl_add_u32 v11, v12, 3, v11
    v_bfe_u32 v12, v0, 3, 1
    v_and_b32 v10, 1, v10
    v_lshl_or_b32 v12, v10, 1, v12
    s_and_b32 s26, s24, 1
    s_mul_i32 s26, s26, 3
    s_add_u32 s27, s26, 0
    s_and_b32 s28, s27, 3
    s_lshr_b32 s27, s27, 2
    s_lshl_b32 s27, s27, 12
    s_add_u32 s27, s27, 4096
    v_xor_b32 v10, s28, v12
    v_lshl_add_u32 v10, v10, 5, v11
    v_add_u32 v14, s27, v10
    s_add_u32 s27, s26, 1
    s_and_b32 s28, s27, 3
    s_lshr_b32 s27, s27, 2
    s_lshl_b32 s27, s27, 12
    s_add_u32 s27, s27, 4096
    v_xor_b32 v10, s28, v12
    v_lshl_add_u32 v10, v10, 5, v11
    v_add_u32 v15, s27, v10
    s_add_u32 s27, s26, 2
    s_and_b32 s28, s27, 3
    s_lshr_b32 s27, s27, 2
    s_lshl_b32 s27, s27, 12
    s_add_u32 s27, s27, 4096
    v_xor_b32 v10, s28, v12
    v_lshl_add_u32 v10, v10, 5, v11
    v_add_u32 v16, s27, v10
    v_mov_b32 v3, v2
    v_lshrrev_b32 v10, 2, v0
    v_lshrrev_b32 v11, 4, v0
    v_sub_u32 v11, 4, v11
    v_and_b32 v11, 3, v11
    v_and_b32 v12, 3, v0
    v_xor_b32 v12, v12, v11
    s_lshl_b32 s26, s24, 4
    v_add_u32 v10, s26, v10
    s_mov_b32 s26, 1152
    v_mul_lo_u32 v10, v10, s26
    v_lshl_add_u32 v2, v12, 4, v10
    v_lshrrev_b32 v10, 3, v0
    v_lshrrev_b32 v11, 4, v0
    v_and_b32 v11, 1, v11
    s_and_b32 s26, s24, 1
    s_lshl_b32 s26, s26, 1
    v_or_b32 v11, s26, v11
    v_bfe_u32 v12, v0, 1, 2
    v_xor_b32 v12, v12, v11
    v_and_b32 v13, 1, v0
    v_lshlrev_b32 v13, 4, v13
    v_lshl_add_u32 v13, v12, 5, v13
    s_lshl_b32 s26, s24, 3
    v_add_u32 v10, s26, v10
    s_mov_b32 s26, 1152
    v_mul_lo_u32 v10, v10, s26
    v_add_u32 v4, v10, v13
    v_cmp_lt_u32 vcc, 1, v12
    v_mov_b32 v5, 0x7f000000
    s_nop 1
    v_cndmask_b32 v5, v4, v5, vcc
    v_bfe_u32 v10, v0, 2, 2
    v_sub_u32 v10, 4, v10
    v_and_b32 v10, 3, v10
    v_lshrrev_b32 v11, 4, v0
    v_xor_b32 v10, v10, v11
    v_and_b32 v11, 15, v0
    s_lshr_b32 s26, s24, 1
    s_mul_i32 s26, s26, 32
    v_add_u32 v11, s26, v11
    v_lshlrev_b32 v11, 6, v11
    v_lshl_add_u32 v6, v10, 4, v11
    v_lshrrev_b32 v10, 4, v0
    v_bfe_u32 v11, v0, 2, 2
    v_lshl_add_u32 v11, v10, 3, v11
    v_lshlrev_b32 v11, 7, v11
    v_and_b32 v12, 3, v0
    v_lshl_add_u32 v11, v12, 3, v11
    v_bfe_u32 v12, v0, 3, 1
    v_and_b32 v10, 1, v10
    v_lshl_or_b32 v12, v10, 1, v12
    s_and_b32 s26, s24, 1
    s_mul_i32 s26, s26, 3
    s_add_u32 s27, s26, 0
    s_and_b32 s28, s27, 3
    s_lshr_b32 s27, s27, 2
    s_lshl_b32 s27, s27, 12
    s_add_u32 s27, s27, 4096
    v_xor_b32 v10, s28, v12
    v_lshl_add_u32 v10, v10, 5, v11
    v_add_u32 v14, s27, v10
    s_add_u32 s27, s26, 1
    s_and_b32 s28, s27, 3
    s_lshr_b32 s27, s27, 2
    s_lshl_b32 s27, s27, 12
    s_add_u32 s27, s27, 4096
    v_xor_b32 v10, s28, v12
    v_lshl_add_u32 v10, v10, 5, v11
    v_add_u32 v15, s27, v10
    s_add_u32 s27, s26, 2
    s_and_b32 s28, s27, 3
    s_lshr_b32 s27, s27, 2
    s_lshl_b32 s27, s27, 12
    s_add_u32 s27, s27, 4096
    v_xor_b32 v10, s28, v12
    v_lshl_add_u32 v10, v10, 5, v11
    v_add_u32 v16, s27, v10
    v_add_u32 v7, 49152, v6
    v_add_u32 v224, 49152, v14
    v_add_u32 v225, 49152, v15
    v_add_u32 v226, 49152, v16
    s_mul_i32 s26, s30, 73728
    s_mul_i32 s27, s31, 192
    s_add_u32 s28, s27, 128
    v_mov_b32 v40, 0
    v_mov_b32 v41, 0
    v_mov_b32 v42, 0
    v_mov_b32 v43, 0
    v_mov_b32 v44, 0
    v_mov_b32 v45, 0
    v_mov_b32 v46, 0
    v_mov_b32 v47, 0
    v_mov_b32 v48, 0
    v_mov_b32 v49, 0
    v_mov_b32 v50, 0
    v_mov_b32 v51, 0
    v_mov_b32 v52, 0
    v_mov_b32 v53, 0
    v_mov_b32 v54, 0
    v_mov_b32 v55, 0
    v_mov_b32 v56, 0
    v_mov_b32 v57, 0
    v_mov_b32 v58, 0
    v_mov_b32 v59, 0
    v_mov_b32 v60, 0
    v_mov_b32 v61, 0
    v_mov_b32 v62, 0
    v_mov_b32 v63, 0
    s_add_u32 m0, s25, 0
    s_nop 0
    buffer_load_dwordx4 v2, s[8:11], s26 offen lds
    s_add_u32 m0, s25, 4096
    s_nop 0
    buffer_load_dwordx4 v4, s[12:15], s27 offen lds
    s_add_u32 m0, s25, 8192
    s_nop 0
    buffer_load_dwordx4 v5, s[12:15], s28 offen lds
    s_add_u32 s26, s26, 64
    s_add_u32 s27, s27, 36864
    s_add_u32 s28, s28, 36864
    s_add_u32 m0, s25, 12288
    s_nop 0
    buffer_load_dwordx4 v2, s[8:11], s26 offen lds
    s_add_u32 m0, s25, 16384
    s_nop 0
    buffer_load_dwordx4 v4, s[12:15], s27 offen lds
    s_add_u32 m0, s25, 20480
    s_nop 0
    buffer_load_dwordx4 v5, s[12:15], s28 offen lds
    s_add_u32 s26, s26, 64
    s_add_u32 s27, s27, 36864
    s_add_u32 s28, s28, 36864
    s_add_u32 m0, s25, 24576
    s_nop 0
    buffer_load_dwordx4 v2, s[8:11], s26 offen lds
    s_add_u32 m0, s25, 28672
    s_nop 0
    buffer_load_dwordx4 v4, s[12:15], s27 offen lds
    s_add_u32 m0, s25, 32768
    s_nop 0
    buffer_load_dwordx4 v5, s[12:15], s28 offen lds
    s_add_u32 s26, s26, 64
    s_add_u32 s27, s27, 36864
    s_add_u32 s28, s28, 36864
    s_add_u32 m0, s25, 36864
    s_nop 0
    buffer_load_dwordx4 v2, s[8:11], s26 offen lds
    s_add_u32 m0, s25, 40960
    s_nop 0
    buffer_load_dwordx4 v4, s[12:15], s27 offen lds
    s_add_u32 m0, s25, 45056
    s_nop 0
    buffer_load_dwordx4 v5, s[12:15], s28 offen lds
    s_add_u32 s26, s26, 64
    s_add_u32 s27, s27, 36864
    s_add_u32 s28, s28, 36864
    s_add_u32 m0, s25, 49152
    s_nop 0
    buffer_load_dwordx4 v2, s[8:11], s26 offen lds
    s_add_u32 m0, s25, 53248
    s_nop 0
    buffer_load_dwordx4 v4, s[12:15], s27 offen lds
    s_add_u32 m0, s25, 57344
    s_nop 0
    buffer_load_dwordx4 v5, s[12:15], s28 offen lds
    s_add_u32 s26, s26, 64
    s_add_u32 s27, s27, 36864
    s_add_u32 s28, s28, 36864
    v_and_b32 v13, 15, v0
    s_lshr_b32 s33, s24, 1
    s_lshl_b32 s33, s33, 5
    s_lshl_b32 s34, s30, 6
    s_add_u32 s33, s33, s34
    v_add_u32 v13, s33, v13
    v_lshlrev_b32 v13, 2, v13
    buffer_load_dword v76, v13, s[48:51], 0 offen
    buffer_load_dword v77, v13, s[48:51], 0 offen offset:64
    s_mov_b32 s60, s26
    s_mov_b32 s61, s27
    s_mov_b32 s62, s28
    v_and_b32 v10, 15, v0
    s_lshr_b32 s26, s24, 1
    s_lshl_b32 s26, s26, 5
    v_add_u32 v10, s26, v10
    v_mul_u32_u24 v10, 2304, v10
    v_lshrrev_b32 v11, 4, v0
    v_lshlrev_b32 v11, 4, v11
    s_and_b32 s26, s24, 1
    s_mul_i32 s26, s26, 192
    v_add3_u32 v10, v10, v11, s26
    s_mul_i32 s26, s30, 147456
    s_mul_i32 s27, s31, 384
    s_add_u32 s26, s26, s27
    buffer_load_dwordx4 v[80:83], v10, s[16:19], s26 offen offset:0
    buffer_load_dwordx4 v[88:91], v10, s[16:19], s26 offen offset:64
    buffer_load_dwordx4 v[96:99], v10, s[16:19], s26 offen offset:128
    s_add_u32 s26, s26, 36864
    buffer_load_dwordx4 v[84:87], v10, s[16:19], s26 offen offset:0
    buffer_load_dwordx4 v[92:95], v10, s[16:19], s26 offen offset:64
    buffer_load_dwordx4 v[100:103], v10, s[16:19], s26 offen offset:128
    s_add_u32 s26, s26, 4681728
    buffer_load_dwordx4 v[104:107], v10, s[16:19], s26 offen offset:0
    buffer_load_dwordx4 v[112:115], v10, s[16:19], s26 offen offset:64
    buffer_load_dwordx4 v[120:123], v10, s[16:19], s26 offen offset:128
    s_add_u32 s26, s26, 36864
    buffer_load_dwordx4 v[108:111], v10, s[16:19], s26 offen offset:0
    buffer_load_dwordx4 v[116:119], v10, s[16:19], s26 offen offset:64
    buffer_load_dwordx4 v[124:127], v10, s[16:19], s26 offen offset:128
    s_add_u32 s26, s26, 4681728
    buffer_load_dwordx4 v[128:131], v10, s[16:19], s26 offen offset:0
    buffer_load_dwordx4 v[136:139], v10, s[16:19], s26 offen offset:64
    buffer_load_dwordx4 v[144:147], v10, s[16:19], s26 offen offset:128
    s_add_u32 s26, s26, 36864
    buffer_load_dwordx4 v[132:135], v10, s[16:19], s26 offen offset:0
    buffer_load_dwordx4 v[140:143], v10, s[16:19], s26 offen offset:64
    buffer_load_dwordx4 v[148:151], v10, s[16:19], s26 offen offset:128
    s_add_u32 s26, s26, 4681728
    buffer_load_dwordx4 v[152:155], v10, s[16:19], s26 offen offset:0
    buffer_load_dwordx4 v[160:163], v10, s[16:19], s26 offen offset:64
    buffer_load_dwordx4 v[168:171], v10, s[16:19], s26 offen offset:128
    s_add_u32 s26, s26, 36864
    buffer_load_dwordx4 v[156:159], v10, s[16:19], s26 offen offset:0
    buffer_load_dwordx4 v[164:167], v10, s[16:19], s26 offen offset:64
    buffer_load_dwordx4 v[172:175], v10, s[16:19], s26 offen offset:128
    s_add_u32 s26, s26, 4681728
    s_mov_b32 s26, s60
    s_mov_b32 s27, s61
    s_mov_b32 s28, s62
    s_waitcnt vmcnt(38)
    s_barrier
    ds_read_b128 v[20:23], v6 offset:0
    ds_read_b128 v[24:27], v6 offset:1024
    ds_read_b64_tr_b16 v[28:29], v14 offset:0
    ds_read_b64_tr_b16 v[30:31], v14 offset:512
    ds_read_b64_tr_b16 v[32:33], v15 offset:0
    ds_read_b64_tr_b16 v[34:35], v15 offset:512
    s_add_u32 m0, s25, 61440
    s_nop 0
    buffer_load_dwordx4 v2, s[8:11], s26 offen lds
    s_add_u32 m0, s25, 65536
    s_nop 0
    buffer_load_dwordx4 v4, s[12:15], s27 offen lds
    s_add_u32 m0, s25, 69632
    s_nop 0
    buffer_load_dwordx4 v5, s[12:15], s28 offen lds
    s_add_u32 s26, s26, 64
    s_add_u32 s27, s27, 36864
    s_add_u32 s28, s28, 36864
    s_waitcnt lgkmcnt(0)
    ds_read_b64_tr_b16 v[36:37], v16 offset:0
    ds_read_b64_tr_b16 v[38:39], v16 offset:512
    v_mfma_f32_16x16x32_bf16 v[40:43], v[28:31], v[20:23], v[40:43]
    v_mfma_f32_16x16x32_bf16 v[44:47], v[28:31], v[24:27], v[44:47]
    v_mfma_f32_16x16x32_bf16 v[48:51], v[32:35], v[20:23], v[48:51]
    v_mfma_f32_16x16x32_bf16 v[52:55], v[32:35], v[24:27], v[52:55]
    s_waitcnt lgkmcnt(0)
    v_mfma_f32_16x16x32_bf16 v[56:59], v[36:39], v[20:23], v[56:59]
    v_mfma_f32_16x16x32_bf16 v[60:63], v[36:39], v[24:27], v[60:63]
    s_waitcnt vmcnt(38)
    s_barrier
    ds_read_b128 v[20:23], v6 offset:12288
    ds_read_b128 v[24:27], v6 offset:13312
    ds_read_b64_tr_b16 v[28:29], v14 offset:12288
    ds_read_b64_tr_b16 v[30:31], v14 offset:12800
    ds_read_b64_tr_b16 v[32:33], v15 offset:12288
    ds_read_b64_tr_b16 v[34:35], v15 offset:12800
    s_add_u32 m0, s25, 0
    s_nop 0
    buffer_load_dwordx4 v2, s[8:11], s26 offen lds
    s_add_u32 m0, s25, 4096
    s_nop 0
    buffer_load_dwordx4 v4, s[12:15], s27 offen lds
    s_add_u32 m0, s25, 8192
    s_nop 0
    buffer_load_dwordx4 v5, s[12:15], s28 offen lds
    s_add_u32 s26, s26, 64
    s_add_u32 s27, s27, 36864
    s_add_u32 s28, s28, 36864
    s_waitcnt lgkmcnt(0)
    ds_read_b64_tr_b16 v[36:37], v16 offset:12288
    ds_read_b64_tr_b16 v[38:39], v16 offset:12800
    v_mfma_f32_16x16x32_bf16 v[40:43], v[28:31], v[20:23], v[40:43]
    v_mfma_f32_16x16x32_bf16 v[44:47], v[28:31], v[24:27], v[44:47]
    v_mfma_f32_16x16x32_bf16 v[48:51], v[32:35], v[20:23], v[48:51]
    v_mfma_f32_16x16x32_bf16 v[52:55], v[32:35], v[24:27], v[52:55]
    s_waitcnt lgkmcnt(0)
    v_mfma_f32_16x16x32_bf16 v[56:59], v[36:39], v[20:23], v[56:59]
    v_mfma_f32_16x16x32_bf16 v[60:63], v[36:39], v[24:27], v[60:63]
    s_waitcnt vmcnt(38)
    s_barrier
    ds_read_b128 v[20:23], v6 offset:24576
    ds_read_b128 v[24:27], v6 offset:25600
    ds_read_b64_tr_b16 v[28:29], v14 offset:24576
    ds_read_b64_tr_b16 v[30:31], v14 offset:25088
    ds_read_b64_tr_b16 v[32:33], v15 offset:24576
    ds_read_b64_tr_b16 v[34:35], v15 offset:25088
    s_add_u32 m0, s25, 12288
    s_nop 0
    buffer_load_dwordx4 v2, s[8:11], s26 offen lds
    s_add_u32 m0, s25, 16384
    s_nop 0
    buffer_load_dwordx4 v4, s[12:15], s27 offen lds
    s_add_u32 m0, s25, 20480
    s_nop 0
    buffer_load_dwordx4 v5, s[12:15], s28 offen lds
    s_add_u32 s26, s26, 64
    s_add_u32 s27, s27, 36864
    s_add_u32 s28, s28, 36864
    s_waitcnt lgkmcnt(0)
    ds_read_b64_tr_b16 v[36:37], v16 offset:24576
    ds_read_b64_tr_b16 v[38:39], v16 offset:25088
    v_mfma_f32_16x16x32_bf16 v[40:43], v[28:31], v[20:23], v[40:43]
    v_mfma_f32_16x16x32_bf16 v[44:47], v[28:31], v[24:27], v[44:47]
    v_mfma_f32_16x16x32_bf16 v[48:51], v[32:35], v[20:23], v[48:51]
    v_mfma_f32_16x16x32_bf16 v[52:55], v[32:35], v[24:27], v[52:55]
    s_waitcnt lgkmcnt(0)
    v_mfma_f32_16x16x32_bf16 v[56:59], v[36:39], v[20:23], v[56:59]
    v_mfma_f32_16x16x32_bf16 v[60:63], v[36:39], v[24:27], v[60:63]
    s_waitcnt vmcnt(38)
    s_barrier
    ds_read_b128 v[20:23], v6 offset:36864
    ds_read_b128 v[24:27], v6 offset:37888
    ds_read_b64_tr_b16 v[28:29], v14 offset:36864
    ds_read_b64_tr_b16 v[30:31], v14 offset:37376
    ds_read_b64_tr_b16 v[32:33], v15 offset:36864
    ds_read_b64_tr_b16 v[34:35], v15 offset:37376
    s_add_u32 m0, s25, 24576
    s_nop 0
    buffer_load_dwordx4 v2, s[8:11], s26 offen lds
    s_add_u32 m0, s25, 28672
    s_nop 0
    buffer_load_dwordx4 v4, s[12:15], s27 offen lds
    s_add_u32 m0, s25, 32768
    s_nop 0
    buffer_load_dwordx4 v5, s[12:15], s28 offen lds
    s_add_u32 s26, s26, 64
    s_add_u32 s27, s27, 36864
    s_add_u32 s28, s28, 36864
    s_waitcnt lgkmcnt(0)
    ds_read_b64_tr_b16 v[36:37], v16 offset:36864
    ds_read_b64_tr_b16 v[38:39], v16 offset:37376
    v_mfma_f32_16x16x32_bf16 v[40:43], v[28:31], v[20:23], v[40:43]
    v_mfma_f32_16x16x32_bf16 v[44:47], v[28:31], v[24:27], v[44:47]
    v_mfma_f32_16x16x32_bf16 v[48:51], v[32:35], v[20:23], v[48:51]
    v_mfma_f32_16x16x32_bf16 v[52:55], v[32:35], v[24:27], v[52:55]
    s_waitcnt lgkmcnt(0)
    v_mfma_f32_16x16x32_bf16 v[56:59], v[36:39], v[20:23], v[56:59]
    v_mfma_f32_16x16x32_bf16 v[60:63], v[36:39], v[24:27], v[60:63]
    s_waitcnt vmcnt(38)
    s_barrier
    ds_read_b128 v[20:23], v7 offset:0
    ds_read_b128 v[24:27], v7 offset:1024
    ds_read_b64_tr_b16 v[28:29], v224 offset:0
    ds_read_b64_tr_b16 v[30:31], v224 offset:512
    ds_read_b64_tr_b16 v[32:33], v225 offset:0
    ds_read_b64_tr_b16 v[34:35], v225 offset:512
    s_add_u32 m0, s25, 36864
    s_nop 0
    buffer_load_dwordx4 v2, s[8:11], s26 offen lds
    s_add_u32 m0, s25, 40960
    s_nop 0
    buffer_load_dwordx4 v4, s[12:15], s27 offen lds
    s_add_u32 m0, s25, 45056
    s_nop 0
    buffer_load_dwordx4 v5, s[12:15], s28 offen lds
    s_add_u32 s26, s26, 64
    s_add_u32 s27, s27, 36864
    s_add_u32 s28, s28, 36864
    s_waitcnt lgkmcnt(0)
    ds_read_b64_tr_b16 v[36:37], v226 offset:0
    ds_read_b64_tr_b16 v[38:39], v226 offset:512
    v_mfma_f32_16x16x32_bf16 v[40:43], v[28:31], v[20:23], v[40:43]
    v_mfma_f32_16x16x32_bf16 v[44:47], v[28:31], v[24:27], v[44:47]
    v_mfma_f32_16x16x32_bf16 v[48:51], v[32:35], v[20:23], v[48:51]
    v_mfma_f32_16x16x32_bf16 v[52:55], v[32:35], v[24:27], v[52:55]
    s_waitcnt lgkmcnt(0)
    v_mfma_f32_16x16x32_bf16 v[56:59], v[36:39], v[20:23], v[56:59]
    v_mfma_f32_16x16x32_bf16 v[60:63], v[36:39], v[24:27], v[60:63]
    s_waitcnt vmcnt(12)
    s_barrier
    ds_read_b128 v[20:23], v7 offset:12288
    ds_read_b128 v[24:27], v7 offset:13312
    ds_read_b64_tr_b16 v[28:29], v224 offset:12288
    ds_read_b64_tr_b16 v[30:31], v224 offset:12800
    ds_read_b64_tr_b16 v[32:33], v225 offset:12288
    ds_read_b64_tr_b16 v[34:35], v225 offset:12800
    s_add_u32 m0, s25, 49152
    s_nop 0
    buffer_load_dwordx4 v2, s[8:11], s26 offen lds
    s_add_u32 m0, s25, 53248
    s_nop 0
    buffer_load_dwordx4 v4, s[12:15], s27 offen lds
    s_add_u32 m0, s25, 57344
    s_nop 0
    buffer_load_dwordx4 v5, s[12:15], s28 offen lds
    s_add_u32 s26, s26, 64
    s_add_u32 s27, s27, 36864
    s_add_u32 s28, s28, 36864
    s_waitcnt lgkmcnt(0)
    ds_read_b64_tr_b16 v[36:37], v226 offset:12288
    ds_read_b64_tr_b16 v[38:39], v226 offset:12800
    v_mfma_f32_16x16x32_bf16 v[40:43], v[28:31], v[20:23], v[40:43]
    v_mfma_f32_16x16x32_bf16 v[44:47], v[28:31], v[24:27], v[44:47]
    v_mfma_f32_16x16x32_bf16 v[48:51], v[32:35], v[20:23], v[48:51]
    v_mfma_f32_16x16x32_bf16 v[52:55], v[32:35], v[24:27], v[52:55]
    s_waitcnt lgkmcnt(0)
    v_mfma_f32_16x16x32_bf16 v[56:59], v[36:39], v[20:23], v[56:59]
    v_mfma_f32_16x16x32_bf16 v[60:63], v[36:39], v[24:27], v[60:63]
    s_waitcnt vmcnt(12)
    s_barrier
    ds_read_b128 v[20:23], v6 offset:0
    ds_read_b128 v[24:27], v6 offset:1024
    ds_read_b64_tr_b16 v[28:29], v14 offset:0
    ds_read_b64_tr_b16 v[30:31], v14 offset:512
    ds_read_b64_tr_b16 v[32:33], v15 offset:0
    ds_read_b64_tr_b16 v[34:35], v15 offset:512
    s_add_u32 m0, s25, 61440
    s_nop 0
    buffer_load_dwordx4 v2, s[8:11], s26 offen lds
    s_add_u32 m0, s25, 65536
    s_nop 0
    buffer_load_dwordx4 v4, s[12:15], s27 offen lds
    s_add_u32 m0, s25, 69632
    s_nop 0
    buffer_load_dwordx4 v5, s[12:15], s28 offen lds
    s_add_u32 s26, s26, 64
    s_add_u32 s27, s27, 36864
    s_add_u32 s28, s28, 36864
    s_waitcnt lgkmcnt(0)
    ds_read_b64_tr_b16 v[36:37], v16 offset:0
    ds_read_b64_tr_b16 v[38:39], v16 offset:512
    v_mfma_f32_16x16x32_bf16 v[40:43], v[28:31], v[20:23], v[40:43]
    v_mfma_f32_16x16x32_bf16 v[44:47], v[28:31], v[24:27], v[44:47]
    v_mfma_f32_16x16x32_bf16 v[48:51], v[32:35], v[20:23], v[48:51]
    v_mfma_f32_16x16x32_bf16 v[52:55], v[32:35], v[24:27], v[52:55]
    s_waitcnt lgkmcnt(0)
    v_mfma_f32_16x16x32_bf16 v[56:59], v[36:39], v[20:23], v[56:59]
    v_mfma_f32_16x16x32_bf16 v[60:63], v[36:39], v[24:27], v[60:63]
    s_waitcnt vmcnt(12)
    s_barrier
    ds_read_b128 v[20:23], v6 offset:12288
    ds_read_b128 v[24:27], v6 offset:13312
    ds_read_b64_tr_b16 v[28:29], v14 offset:12288
    ds_read_b64_tr_b16 v[30:31], v14 offset:12800
    ds_read_b64_tr_b16 v[32:33], v15 offset:12288
    ds_read_b64_tr_b16 v[34:35], v15 offset:12800
    s_add_u32 m0, s25, 0
    s_nop 0
    buffer_load_dwordx4 v2, s[8:11], s26 offen lds
    s_add_u32 m0, s25, 4096
    s_nop 0
    buffer_load_dwordx4 v4, s[12:15], s27 offen lds
    s_add_u32 m0, s25, 8192
    s_nop 0
    buffer_load_dwordx4 v5, s[12:15], s28 offen lds
    s_add_u32 s26, s26, 64
    s_add_u32 s27, s27, 36864
    s_add_u32 s28, s28, 36864
    s_waitcnt lgkmcnt(0)
    ds_read_b64_tr_b16 v[36:37], v16 offset:12288
    ds_read_b64_tr_b16 v[38:39], v16 offset:12800
    v_mfma_f32_16x16x32_bf16 v[40:43], v[28:31], v[20:23], v[40:43]
    v_mfma_f32_16x16x32_bf16 v[44:47], v[28:31], v[24:27], v[44:47]
    v_mfma_f32_16x16x32_bf16 v[48:51], v[32:35], v[20:23], v[48:51]
    v_mfma_f32_16x16x32_bf16 v[52:55], v[32:35], v[24:27], v[52:55]
    s_waitcnt lgkmcnt(0)
    v_mfma_f32_16x16x32_bf16 v[56:59], v[36:39], v[20:23], v[56:59]
    v_mfma_f32_16x16x32_bf16 v[60:63], v[36:39], v[24:27], v[60:63]
    s_waitcnt vmcnt(12)
    s_barrier
    ds_read_b128 v[20:23], v6 offset:24576
    ds_read_b128 v[24:27], v6 offset:25600
    ds_read_b64_tr_b16 v[28:29], v14 offset:24576
    ds_read_b64_tr_b16 v[30:31], v14 offset:25088
    ds_read_b64_tr_b16 v[32:33], v15 offset:24576
    ds_read_b64_tr_b16 v[34:35], v15 offset:25088
    s_add_u32 m0, s25, 12288
    s_nop 0
    buffer_load_dwordx4 v2, s[8:11], s26 offen lds
    s_add_u32 m0, s25, 16384
    s_nop 0
    buffer_load_dwordx4 v4, s[12:15], s27 offen lds
    s_add_u32 m0, s25, 20480
    s_nop 0
    buffer_load_dwordx4 v5, s[12:15], s28 offen lds
    s_add_u32 s26, s26, 64
    s_add_u32 s27, s27, 36864
    s_add_u32 s28, s28, 36864
    s_waitcnt lgkmcnt(0)
    ds_read_b64_tr_b16 v[36:37], v16 offset:24576
    ds_read_b64_tr_b16 v[38:39], v16 offset:25088
    v_mfma_f32_16x16x32_bf16 v[40:43], v[28:31], v[20:23], v[40:43]
    v_mfma_f32_16x16x32_bf16 v[44:47], v[28:31], v[24:27], v[44:47]
    v_mfma_f32_16x16x32_bf16 v[48:51], v[32:35], v[20:23], v[48:51]
    v_mfma_f32_16x16x32_bf16 v[52:55], v[32:35], v[24:27], v[52:55]
    s_waitcnt lgkmcnt(0)
    v_mfma_f32_16x16x32_bf16 v[56:59], v[36:39], v[20:23], v[56:59]
    v_mfma_f32_16x16x32_bf16 v[60:63], v[36:39], v[24:27], v[60:63]
    s_waitcnt vmcnt(12)
    s_barrier
    ds_read_b128 v[20:23], v6 offset:36864
    ds_read_b128 v[24:27], v6 offset:37888
    ds_read_b64_tr_b16 v[28:29], v14 offset:36864
    ds_read_b64_tr_b16 v[30:31], v14 offset:37376
    ds_read_b64_tr_b16 v[32:33], v15 offset:36864
    ds_read_b64_tr_b16 v[34:35], v15 offset:37376
    s_add_u32 m0, s25, 24576
    s_nop 0
    buffer_load_dwordx4 v2, s[8:11], s26 offen lds
    s_add_u32 m0, s25, 28672
    s_nop 0
    buffer_load_dwordx4 v4, s[12:15], s27 offen lds
    s_add_u32 m0, s25, 32768
    s_nop 0
    buffer_load_dwordx4 v5, s[12:15], s28 offen lds
    s_add_u32 s26, s26, 64
    s_add_u32 s27, s27, 36864
    s_add_u32 s28, s28, 36864
    s_waitcnt lgkmcnt(0)
    ds_read_b64_tr_b16 v[36:37], v16 offset:36864
    ds_read_b64_tr_b16 v[38:39], v16 offset:37376
    v_mfma_f32_16x16x32_bf16 v[40:43], v[28:31], v[20:23], v[40:43]
    v_mfma_f32_16x16x32_bf16 v[44:47], v[28:31], v[24:27], v[44:47]
    v_mfma_f32_16x16x32_bf16 v[48:51], v[32:35], v[20:23], v[48:51]
    v_mfma_f32_16x16x32_bf16 v[52:55], v[32:35], v[24:27], v[52:55]
    s_waitcnt lgkmcnt(0)
    v_mfma_f32_16x16x32_bf16 v[56:59], v[36:39], v[20:23], v[56:59]
    v_mfma_f32_16x16x32_bf16 v[60:63], v[36:39], v[24:27], v[60:63]
    s_waitcnt vmcnt(12)
    s_barrier
    ds_read_b128 v[20:23], v7 offset:0
    ds_read_b128 v[24:27], v7 offset:1024
    ds_read_b64_tr_b16 v[28:29], v224 offset:0
    ds_read_b64_tr_b16 v[30:31], v224 offset:512
    ds_read_b64_tr_b16 v[32:33], v225 offset:0
    ds_read_b64_tr_b16 v[34:35], v225 offset:512
    s_add_u32 m0, s25, 36864
    s_nop 0
    buffer_load_dwordx4 v2, s[8:11], s26 offen lds
    s_add_u32 m0, s25, 40960
    s_nop 0
    buffer_load_dwordx4 v4, s[12:15], s27 offen lds
    s_add_u32 m0, s25, 45056
    s_nop 0
    buffer_load_dwordx4 v5, s[12:15], s28 offen lds
    s_add_u32 s26, s26, 64
    s_add_u32 s27, s27, 36864
    s_add_u32 s28, s28, 36864
    s_waitcnt lgkmcnt(0)
    ds_read_b64_tr_b16 v[36:37], v226 offset:0
    ds_read_b64_tr_b16 v[38:39], v226 offset:512
    v_mfma_f32_16x16x32_bf16 v[40:43], v[28:31], v[20:23], v[40:43]
    v_mfma_f32_16x16x32_bf16 v[44:47], v[28:31], v[24:27], v[44:47]
    v_mfma_f32_16x16x32_bf16 v[48:51], v[32:35], v[20:23], v[48:51]
    v_mfma_f32_16x16x32_bf16 v[52:55], v[32:35], v[24:27], v[52:55]
    s_waitcnt lgkmcnt(0)
    v_mfma_f32_16x16x32_bf16 v[56:59], v[36:39], v[20:23], v[56:59]
    v_mfma_f32_16x16x32_bf16 v[60:63], v[36:39], v[24:27], v[60:63]
    s_waitcnt vmcnt(12)
    s_barrier
    ds_read_b128 v[20:23], v7 offset:12288
    ds_read_b128 v[24:27], v7 offset:13312
    ds_read_b64_tr_b16 v[28:29], v224 offset:12288
    ds_read_b64_tr_b16 v[30:31], v224 offset:12800
    ds_read_b64_tr_b16 v[32:33], v225 offset:12288
    ds_read_b64_tr_b16 v[34:35], v225 offset:12800
    s_add_u32 m0, s25, 49152
    s_nop 0
    buffer_load_dwordx4 v2, s[8:11], s26 offen lds
    s_add_u32 m0, s25, 53248
    s_nop 0
    buffer_load_dwordx4 v4, s[12:15], s27 offen lds
    s_add_u32 m0, s25, 57344
    s_nop 0
    buffer_load_dwordx4 v5, s[12:15], s28 offen lds
    s_add_u32 s26, s26, 64
    s_add_u32 s27, s27, 36864
    s_add_u32 s28, s28, 36864
    s_waitcnt lgkmcnt(0)
    ds_read_b64_tr_b16 v[36:37], v226 offset:12288
    ds_read_b64_tr_b16 v[38:39], v226 offset:12800
    v_mfma_f32_16x16x32_bf16 v[40:43], v[28:31], v[20:23], v[40:43]
    v_mfma_f32_16x16x32_bf16 v[44:47], v[28:31], v[24:27], v[44:47]
    v_mfma_f32_16x16x32_bf16 v[48:51], v[32:35], v[20:23], v[48:51]
    v_mfma_f32_16x16x32_bf16 v[52:55], v[32:35], v[24:27], v[52:55]
    s_waitcnt lgkmcnt(0)
    v_mfma_f32_16x16x32_bf16 v[56:59], v[36:39], v[20:23], v[56:59]
    v_mfma_f32_16x16x32_bf16 v[60:63], v[36:39], v[24:27], v[60:63]
    s_waitcnt vmcnt(12)
    s_barrier
    ds_read_b128 v[20:23], v6 offset:0
    ds_read_b128 v[24:27], v6 offset:1024
    ds_read_b64_tr_b16 v[28:29], v14 offset:0
    ds_read_b64_tr_b16 v[30:31], v14 offset:512
    ds_read_b64_tr_b16 v[32:33], v15 offset:0
    ds_read_b64_tr_b16 v[34:35], v15 offset:512
    s_add_u32 m0, s25, 61440
    s_nop 0
    buffer_load_dwordx4 v2, s[8:11], s26 offen lds
    s_add_u32 m0, s25, 65536
    s_nop 0
    buffer_load_dwordx4 v4, s[12:15], s27 offen lds
    s_add_u32 m0, s25, 69632
    s_nop 0
    buffer_load_dwordx4 v5, s[12:15], s28 offen lds
    s_add_u32 s26, s26, 64
    s_add_u32 s27, s27, 36864
    s_add_u32 s28, s28, 36864
    s_waitcnt lgkmcnt(0)
    ds_read_b64_tr_b16 v[36:37], v16 offset:0
    ds_read_b64_tr_b16 v[38:39], v16 offset:512
    v_mfma_f32_16x16x32_bf16 v[40:43], v[28:31], v[20:23], v[40:43]
    v_mfma_f32_16x16x32_bf16 v[44:47], v[28:31], v[24:27], v[44:47]
    v_mfma_f32_16x16x32_bf16 v[48:51], v[32:35], v[20:23], v[48:51]
    v_mfma_f32_16x16x32_bf16 v[52:55], v[32:35], v[24:27], v[52:55]
    s_waitcnt lgkmcnt(0)
    v_mfma_f32_16x16x32_bf16 v[56:59], v[36:39], v[20:23], v[56:59]
    v_mfma_f32_16x16x32_bf16 v[60:63], v[36:39], v[24:27], v[60:63]
    s_waitcnt vmcnt(12)
    s_barrier
    ds_read_b128 v[20:23], v6 offset:12288
    ds_read_b128 v[24:27], v6 offset:13312
    ds_read_b64_tr_b16 v[28:29], v14 offset:12288
    ds_read_b64_tr_b16 v[30:31], v14 offset:12800
    ds_read_b64_tr_b16 v[32:33], v15 offset:12288
    ds_read_b64_tr_b16 v[34:35], v15 offset:12800
    s_waitcnt lgkmcnt(0)
    ds_read_b64_tr_b16 v[36:37], v16 offset:12288
    ds_read_b64_tr_b16 v[38:39], v16 offset:12800
    v_mfma_f32_16x16x32_bf16 v[40:43], v[28:31], v[20:23], v[40:43]
    v_mfma_f32_16x16x32_bf16 v[44:47], v[28:31], v[24:27], v[44:47]
    v_mfma_f32_16x16x32_bf16 v[48:51], v[32:35], v[20:23], v[48:51]
    v_mfma_f32_16x16x32_bf16 v[52:55], v[32:35], v[24:27], v[52:55]
    s_waitcnt lgkmcnt(0)
    v_mfma_f32_16x16x32_bf16 v[56:59], v[36:39], v[20:23], v[56:59]
    v_mfma_f32_16x16x32_bf16 v[60:63], v[36:39], v[24:27], v[60:63]
    s_waitcnt vmcnt(9)
    s_barrier
    ds_read_b128 v[20:23], v6 offset:24576
    ds_read_b128 v[24:27], v6 offset:25600
    ds_read_b64_tr_b16 v[28:29], v14 offset:24576
    ds_read_b64_tr_b16 v[30:31], v14 offset:25088
    ds_read_b64_tr_b16 v[32:33], v15 offset:24576
    ds_read_b64_tr_b16 v[34:35], v15 offset:25088
    s_waitcnt lgkmcnt(0)
    ds_read_b64_tr_b16 v[36:37], v16 offset:24576
    ds_read_b64_tr_b16 v[38:39], v16 offset:25088
    v_mfma_f32_16x16x32_bf16 v[40:43], v[28:31], v[20:23], v[40:43]
    v_mfma_f32_16x16x32_bf16 v[44:47], v[28:31], v[24:27], v[44:47]
    v_mfma_f32_16x16x32_bf16 v[48:51], v[32:35], v[20:23], v[48:51]
    v_mfma_f32_16x16x32_bf16 v[52:55], v[32:35], v[24:27], v[52:55]
    s_waitcnt lgkmcnt(0)
    v_mfma_f32_16x16x32_bf16 v[56:59], v[36:39], v[20:23], v[56:59]
    v_mfma_f32_16x16x32_bf16 v[60:63], v[36:39], v[24:27], v[60:63]
    s_waitcnt vmcnt(6)
    s_barrier
    ds_read_b128 v[20:23], v6 offset:36864
    ds_read_b128 v[24:27], v6 offset:37888
    ds_read_b64_tr_b16 v[28:29], v14 offset:36864
    ds_read_b64_tr_b16 v[30:31], v14 offset:37376
    ds_read_b64_tr_b16 v[32:33], v15 offset:36864
    ds_read_b64_tr_b16 v[34:35], v15 offset:37376
    s_waitcnt lgkmcnt(0)
    ds_read_b64_tr_b16 v[36:37], v16 offset:36864
    ds_read_b64_tr_b16 v[38:39], v16 offset:37376
    v_mfma_f32_16x16x32_bf16 v[40:43], v[28:31], v[20:23], v[40:43]
    v_mfma_f32_16x16x32_bf16 v[44:47], v[28:31], v[24:27], v[44:47]
    v_mfma_f32_16x16x32_bf16 v[48:51], v[32:35], v[20:23], v[48:51]
    v_mfma_f32_16x16x32_bf16 v[52:55], v[32:35], v[24:27], v[52:55]
    s_waitcnt lgkmcnt(0)
    v_mfma_f32_16x16x32_bf16 v[56:59], v[36:39], v[20:23], v[56:59]
    v_mfma_f32_16x16x32_bf16 v[60:63], v[36:39], v[24:27], v[60:63]
    s_waitcnt vmcnt(3)
    s_barrier
    ds_read_b128 v[20:23], v7 offset:0
    ds_read_b128 v[24:27], v7 offset:1024
    ds_read_b64_tr_b16 v[28:29], v224 offset:0
    ds_read_b64_tr_b16 v[30:31], v224 offset:512
    ds_read_b64_tr_b16 v[32:33], v225 offset:0
    ds_read_b64_tr_b16 v[34:35], v225 offset:512
    s_waitcnt lgkmcnt(0)
    ds_read_b64_tr_b16 v[36:37], v226 offset:0
    ds_read_b64_tr_b16 v[38:39], v226 offset:512
    v_mfma_f32_16x16x32_bf16 v[40:43], v[28:31], v[20:23], v[40:43]
    v_mfma_f32_16x16x32_bf16 v[44:47], v[28:31], v[24:27], v[44:47]
    v_mfma_f32_16x16x32_bf16 v[48:51], v[32:35], v[20:23], v[48:51]
    v_mfma_f32_16x16x32_bf16 v[52:55], v[32:35], v[24:27], v[52:55]
    s_waitcnt lgkmcnt(0)
    v_mfma_f32_16x16x32_bf16 v[56:59], v[36:39], v[20:23], v[56:59]
    v_mfma_f32_16x16x32_bf16 v[60:63], v[36:39], v[24:27], v[60:63]
    s_waitcnt vmcnt(0)
    s_barrier
    ds_read_b128 v[20:23], v7 offset:12288
    ds_read_b128 v[24:27], v7 offset:13312
    ds_read_b64_tr_b16 v[28:29], v224 offset:12288
    ds_read_b64_tr_b16 v[30:31], v224 offset:12800
    ds_read_b64_tr_b16 v[32:33], v225 offset:12288
    ds_read_b64_tr_b16 v[34:35], v225 offset:12800
    s_waitcnt lgkmcnt(0)
    ds_read_b64_tr_b16 v[36:37], v226 offset:12288
    ds_read_b64_tr_b16 v[38:39], v226 offset:12800
    v_mfma_f32_16x16x32_bf16 v[40:43], v[28:31], v[20:23], v[40:43]
    v_mfma_f32_16x16x32_bf16 v[44:47], v[28:31], v[24:27], v[44:47]
    v_mfma_f32_16x16x32_bf16 v[48:51], v[32:35], v[20:23], v[48:51]
    v_mfma_f32_16x16x32_bf16 v[52:55], v[32:35], v[24:27], v[52:55]
    s_waitcnt lgkmcnt(0)
    v_mfma_f32_16x16x32_bf16 v[56:59], v[36:39], v[20:23], v[56:59]
    v_mfma_f32_16x16x32_bf16 v[60:63], v[36:39], v[24:27], v[60:63]
    s_nop 15
    s_nop 7
    v_cvt_pk_bf16_f32 v64, v40, v41
    v_cvt_pk_bf16_f32 v65, v42, v43
    v_cvt_pk_bf16_f32 v66, v44, v45
    v_cvt_pk_bf16_f32 v67, v46, v47
    v_cvt_pk_bf16_f32 v68, v48, v49
    v_cvt_pk_bf16_f32 v69, v50, v51
    v_cvt_pk_bf16_f32 v70, v52, v53
    v_cvt_pk_bf16_f32 v71, v54, v55
    v_cvt_pk_bf16_f32 v72, v56, v57
    v_cvt_pk_bf16_f32 v73, v58, v59
    v_cvt_pk_bf16_f32 v74, v60, v61
    v_cvt_pk_bf16_f32 v75, v62, v63
    s_waitcnt vmcnt(0)
    v_add_f32 v80, v80, v104
    v_add_f32 v128, v128, v152
    v_add_f32 v81, v81, v105
    v_add_f32 v129, v129, v153
    v_add_f32 v82, v82, v106
    v_add_f32 v130, v130, v154
    v_add_f32 v83, v83, v107
    v_add_f32 v131, v131, v155
    v_add_f32 v84, v84, v108
    v_add_f32 v132, v132, v156
    v_add_f32 v85, v85, v109
    v_add_f32 v133, v133, v157
    v_add_f32 v86, v86, v110
    v_add_f32 v134, v134, v158
    v_add_f32 v87, v87, v111
    v_add_f32 v135, v135, v159
    v_add_f32 v88, v88, v112
    v_add_f32 v136, v136, v160
    v_add_f32 v89, v89, v113
    v_add_f32 v137, v137, v161
    v_add_f32 v90, v90, v114
    v_add_f32 v138, v138, v162
    v_add_f32 v91, v91, v115
    v_add_f32 v139, v139, v163
    v_add_f32 v92, v92, v116
    v_add_f32 v140, v140, v164
    v_add_f32 v93, v93, v117
    v_add_f32 v141, v141, v165
    v_add_f32 v94, v94, v118
    v_add_f32 v142, v142, v166
    v_add_f32 v95, v95, v119
    v_add_f32 v143, v143, v167
    v_add_f32 v96, v96, v120
    v_add_f32 v144, v144, v168
    v_add_f32 v97, v97, v121
    v_add_f32 v145, v145, v169
    v_add_f32 v98, v98, v122
    v_add_f32 v146, v146, v170
    v_add_f32 v99, v99, v123
    v_add_f32 v147, v147, v171
    v_add_f32 v100, v100, v124
    v_add_f32 v148, v148, v172
    v_add_f32 v101, v101, v125
    v_add_f32 v149, v149, v173
    v_add_f32 v102, v102, v126
    v_add_f32 v150, v150, v174
    v_add_f32 v103, v103, v127
    v_add_f32 v151, v151, v175
    v_add_f32 v40, v80, v128
    v_add_f32 v41, v81, v129
    v_add_f32 v42, v82, v130
    v_add_f32 v43, v83, v131
    v_add_f32 v44, v84, v132
    v_add_f32 v45, v85, v133
    v_add_f32 v46, v86, v134
    v_add_f32 v47, v87, v135
    v_add_f32 v48, v88, v136
    v_add_f32 v49, v89, v137
    v_add_f32 v50, v90, v138
    v_add_f32 v51, v91, v139
    v_add_f32 v52, v92, v140
    v_add_f32 v53, v93, v141
    v_add_f32 v54, v94, v142
    v_add_f32 v55, v95, v143
    v_add_f32 v56, v96, v144
    v_add_f32 v57, v97, v145
    v_add_f32 v58, v98, v146
    v_add_f32 v59, v99, v147
    v_add_f32 v60, v100, v148
    v_add_f32 v61, v101, v149
    v_add_f32 v62, v102, v150
    v_add_f32 v63, v103, v151
    v_and_b32 v10, 15, v0
    s_lshr_b32 s26, s24, 1
    s_lshl_b32 s26, s26, 5
    v_add_u32 v10, s26, v10
    v_lshlrev_b32 v11, 2, v10
    v_mov_b32 v12, v76
    v_mov_b32 v13, v77
    s_mov_b32 s26, 1152
    v_mul_lo_u32 v10, v10, s26
    v_lshrrev_b32 v11, 4, v0
    v_lshlrev_b32 v11, 3, v11
    s_and_b32 s26, s24, 1
    s_mul_i32 s26, s26, 96
    v_add3_u32 v10, v10, v11, s26
    s_mul_i32 s26, s30, 73728
    s_mul_i32 s27, s31, 192
    s_add_u32 s26, s26, s27
    s_waitcnt lgkmcnt(0)
    v_sub_f32 v2, 1.0, v12
    v_cvt_pk_bf16_f32 v2, v2, v2
    v_lshlrev_b32 v2, 16, v2
    v_sub_f32 v3, 1.0, v13
    v_cvt_pk_bf16_f32 v3, v3, v3
    v_lshlrev_b32 v3, 16, v3
    v_lshlrev_b32 v22, 16, v64
    v_and_b32 v23, 0xffff0000, v64
    v_cvt_pk_bf16_f32 v24, v40, v41
    v_lshlrev_b32 v25, 16, v24
    v_and_b32 v26, 0xffff0000, v24
    v_mul_f32 v22, v12, v22
    v_mul_f32 v23, v12, v23
    v_mul_f32 v25, v2, v25
    v_mul_f32 v26, v2, v26
    v_cvt_pk_bf16_f32 v24, v22, v23
    v_cvt_pk_bf16_f32 v27, v25, v26
    v_lshlrev_b32 v22, 16, v24
    v_and_b32 v23, 0xffff0000, v24
    v_lshlrev_b32 v25, 16, v27
    v_and_b32 v26, 0xffff0000, v27
    v_add_f32 v22, v22, v25
    v_add_f32 v23, v23, v26
    v_cvt_pk_bf16_f32 v20, v22, v23
    v_lshlrev_b32 v22, 16, v65
    v_and_b32 v23, 0xffff0000, v65
    v_cvt_pk_bf16_f32 v24, v42, v43
    v_lshlrev_b32 v25, 16, v24
    v_and_b32 v26, 0xffff0000, v24
    v_mul_f32 v22, v12, v22
    v_mul_f32 v23, v12, v23
    v_mul_f32 v25, v2, v25
    v_mul_f32 v26, v2, v26
    v_cvt_pk_bf16_f32 v24, v22, v23
    v_cvt_pk_bf16_f32 v27, v25, v26
    v_lshlrev_b32 v22, 16, v24
    v_and_b32 v23, 0xffff0000, v24
    v_lshlrev_b32 v25, 16, v27
    v_and_b32 v26, 0xffff0000, v27
    v_add_f32 v22, v22, v25
    v_add_f32 v23, v23, v26
    v_cvt_pk_bf16_f32 v21, v22, v23
    buffer_store_dwordx2 v[20:21], v10, s[56:59], s26 offen offset:0
    v_lshlrev_b32 v22, 16, v68
    v_and_b32 v23, 0xffff0000, v68
    v_cvt_pk_bf16_f32 v24, v48, v49
    v_lshlrev_b32 v25, 16, v24
    v_and_b32 v26, 0xffff0000, v24
    v_mul_f32 v22, v12, v22
    v_mul_f32 v23, v12, v23
    v_mul_f32 v25, v2, v25
    v_mul_f32 v26, v2, v26
    v_cvt_pk_bf16_f32 v24, v22, v23
    v_cvt_pk_bf16_f32 v27, v25, v26
    v_lshlrev_b32 v22, 16, v24
    v_and_b32 v23, 0xffff0000, v24
    v_lshlrev_b32 v25, 16, v27
    v_and_b32 v26, 0xffff0000, v27
    v_add_f32 v22, v22, v25
    v_add_f32 v23, v23, v26
    v_cvt_pk_bf16_f32 v20, v22, v23
    v_lshlrev_b32 v22, 16, v69
    v_and_b32 v23, 0xffff0000, v69
    v_cvt_pk_bf16_f32 v24, v50, v51
    v_lshlrev_b32 v25, 16, v24
    v_and_b32 v26, 0xffff0000, v24
    v_mul_f32 v22, v12, v22
    v_mul_f32 v23, v12, v23
    v_mul_f32 v25, v2, v25
    v_mul_f32 v26, v2, v26
    v_cvt_pk_bf16_f32 v24, v22, v23
    v_cvt_pk_bf16_f32 v27, v25, v26
    v_lshlrev_b32 v22, 16, v24
    v_and_b32 v23, 0xffff0000, v24
    v_lshlrev_b32 v25, 16, v27
    v_and_b32 v26, 0xffff0000, v27
    v_add_f32 v22, v22, v25
    v_add_f32 v23, v23, v26
    v_cvt_pk_bf16_f32 v21, v22, v23
    buffer_store_dwordx2 v[20:21], v10, s[56:59], s26 offen offset:32
    v_lshlrev_b32 v22, 16, v72
    v_and_b32 v23, 0xffff0000, v72
    v_cvt_pk_bf16_f32 v24, v56, v57
    v_lshlrev_b32 v25, 16, v24
    v_and_b32 v26, 0xffff0000, v24
    v_mul_f32 v22, v12, v22
    v_mul_f32 v23, v12, v23
    v_mul_f32 v25, v2, v25
    v_mul_f32 v26, v2, v26
    v_cvt_pk_bf16_f32 v24, v22, v23
    v_cvt_pk_bf16_f32 v27, v25, v26
    v_lshlrev_b32 v22, 16, v24
    v_and_b32 v23, 0xffff0000, v24
    v_lshlrev_b32 v25, 16, v27
    v_and_b32 v26, 0xffff0000, v27
    v_add_f32 v22, v22, v25
    v_add_f32 v23, v23, v26
    v_cvt_pk_bf16_f32 v20, v22, v23
    v_lshlrev_b32 v22, 16, v73
    v_and_b32 v23, 0xffff0000, v73
    v_cvt_pk_bf16_f32 v24, v58, v59
    v_lshlrev_b32 v25, 16, v24
    v_and_b32 v26, 0xffff0000, v24
    v_mul_f32 v22, v12, v22
    v_mul_f32 v23, v12, v23
    v_mul_f32 v25, v2, v25
    v_mul_f32 v26, v2, v26
    v_cvt_pk_bf16_f32 v24, v22, v23
    v_cvt_pk_bf16_f32 v27, v25, v26
    v_lshlrev_b32 v22, 16, v24
    v_and_b32 v23, 0xffff0000, v24
    v_lshlrev_b32 v25, 16, v27
    v_and_b32 v26, 0xffff0000, v27
    v_add_f32 v22, v22, v25
    v_add_f32 v23, v23, v26
    v_cvt_pk_bf16_f32 v21, v22, v23
    buffer_store_dwordx2 v[20:21], v10, s[56:59], s26 offen offset:64
    s_add_u32 s26, s26, 18432
    v_lshlrev_b32 v32, 16, v66
    v_and_b32 v33, 0xffff0000, v66
    v_cvt_pk_bf16_f32 v34, v44, v45
    v_lshlrev_b32 v35, 16, v34
    v_and_b32 v36, 0xffff0000, v34
    v_mul_f32 v32, v13, v32
    v_mul_f32 v33, v13, v33
    v_mul_f32 v35, v3, v35
    v_mul_f32 v36, v3, v36
    v_cvt_pk_bf16_f32 v34, v32, v33
    v_cvt_pk_bf16_f32 v37, v35, v36
    v_lshlrev_b32 v32, 16, v34
    v_and_b32 v33, 0xffff0000, v34
    v_lshlrev_b32 v35, 16, v37
    v_and_b32 v36, 0xffff0000, v37
    v_add_f32 v32, v32, v35
    v_add_f32 v33, v33, v36
    v_cvt_pk_bf16_f32 v30, v32, v33
    v_lshlrev_b32 v32, 16, v67
    v_and_b32 v33, 0xffff0000, v67
    v_cvt_pk_bf16_f32 v34, v46, v47
    v_lshlrev_b32 v35, 16, v34
    v_and_b32 v36, 0xffff0000, v34
    v_mul_f32 v32, v13, v32
    v_mul_f32 v33, v13, v33
    v_mul_f32 v35, v3, v35
    v_mul_f32 v36, v3, v36
    v_cvt_pk_bf16_f32 v34, v32, v33
    v_cvt_pk_bf16_f32 v37, v35, v36
    v_lshlrev_b32 v32, 16, v34
    v_and_b32 v33, 0xffff0000, v34
    v_lshlrev_b32 v35, 16, v37
    v_and_b32 v36, 0xffff0000, v37
    v_add_f32 v32, v32, v35
    v_add_f32 v33, v33, v36
    v_cvt_pk_bf16_f32 v31, v32, v33
    buffer_store_dwordx2 v[30:31], v10, s[56:59], s26 offen offset:0
    v_lshlrev_b32 v32, 16, v70
    v_and_b32 v33, 0xffff0000, v70
    v_cvt_pk_bf16_f32 v34, v52, v53
    v_lshlrev_b32 v35, 16, v34
    v_and_b32 v36, 0xffff0000, v34
    v_mul_f32 v32, v13, v32
    v_mul_f32 v33, v13, v33
    v_mul_f32 v35, v3, v35
    v_mul_f32 v36, v3, v36
    v_cvt_pk_bf16_f32 v34, v32, v33
    v_cvt_pk_bf16_f32 v37, v35, v36
    v_lshlrev_b32 v32, 16, v34
    v_and_b32 v33, 0xffff0000, v34
    v_lshlrev_b32 v35, 16, v37
    v_and_b32 v36, 0xffff0000, v37
    v_add_f32 v32, v32, v35
    v_add_f32 v33, v33, v36
    v_cvt_pk_bf16_f32 v30, v32, v33
    v_lshlrev_b32 v32, 16, v71
    v_and_b32 v33, 0xffff0000, v71
    v_cvt_pk_bf16_f32 v34, v54, v55
    v_lshlrev_b32 v35, 16, v34
    v_and_b32 v36, 0xffff0000, v34
    v_mul_f32 v32, v13, v32
    v_mul_f32 v33, v13, v33
    v_mul_f32 v35, v3, v35
    v_mul_f32 v36, v3, v36
    v_cvt_pk_bf16_f32 v34, v32, v33
    v_cvt_pk_bf16_f32 v37, v35, v36
    v_lshlrev_b32 v32, 16, v34
    v_and_b32 v33, 0xffff0000, v34
    v_lshlrev_b32 v35, 16, v37
    v_and_b32 v36, 0xffff0000, v37
    v_add_f32 v32, v32, v35
    v_add_f32 v33, v33, v36
    v_cvt_pk_bf16_f32 v31, v32, v33
    buffer_store_dwordx2 v[30:31], v10, s[56:59], s26 offen offset:32
    v_lshlrev_b32 v32, 16, v74
    v_and_b32 v33, 0xffff0000, v74
    v_cvt_pk_bf16_f32 v34, v60, v61
    v_lshlrev_b32 v35, 16, v34
    v_and_b32 v36, 0xffff0000, v34
    v_mul_f32 v32, v13, v32
    v_mul_f32 v33, v13, v33
    v_mul_f32 v35, v3, v35
    v_mul_f32 v36, v3, v36
    v_cvt_pk_bf16_f32 v34, v32, v33
    v_cvt_pk_bf16_f32 v37, v35, v36
    v_lshlrev_b32 v32, 16, v34
    v_and_b32 v33, 0xffff0000, v34
    v_lshlrev_b32 v35, 16, v37
    v_and_b32 v36, 0xffff0000, v37
    v_add_f32 v32, v32, v35
    v_add_f32 v33, v33, v36
    v_cvt_pk_bf16_f32 v30, v32, v33
    v_lshlrev_b32 v32, 16, v75
    v_and_b32 v33, 0xffff0000, v75
    v_cvt_pk_bf16_f32 v34, v62, v63
    v_lshlrev_b32 v35, 16, v34
    v_and_b32 v36, 0xffff0000, v34
    v_mul_f32 v32, v13, v32
    v_mul_f32 v33, v13, v33
    v_mul_f32 v35, v3, v35
    v_mul_f32 v36, v3, v36
    v_cvt_pk_bf16_f32 v34, v32, v33
    v_cvt_pk_bf16_f32 v37, v35, v36
    v_lshlrev_b32 v32, 16, v34
    v_and_b32 v33, 0xffff0000, v34
    v_lshlrev_b32 v35, 16, v37
    v_and_b32 v36, 0xffff0000, v37
    v_add_f32 v32, v32, v35
    v_add_f32 v33, v33, v36
    v_cvt_pk_bf16_f32 v31, v32, v33
    buffer_store_dwordx2 v[30:31], v10, s[56:59], s26 offen offset:64
fin_done:
    s_endpgm
.section .rodata,"a"
.p2align 6
.amdhsa_kernel l1_kernel
  .amdhsa_next_free_vgpr 244
  .amdhsa_next_free_sgpr 102
  .amdhsa_accum_offset 244
  .amdhsa_group_segment_fixed_size 0
  .amdhsa_kernarg_size 88
  .amdhsa_user_sgpr_count 2
  .amdhsa_user_sgpr_kernarg_segment_ptr 1
  .amdhsa_system_sgpr_workgroup_id_x 1
.end_amdhsa_kernel
.text
.section .rodata,"a"
.p2align 6
.amdhsa_kernel l2_kernel
  .amdhsa_next_free_vgpr 128
  .amdhsa_next_free_sgpr 102
  .amdhsa_accum_offset 128
  .amdhsa_group_segment_fixed_size 0
  .amdhsa_kernarg_size 88
  .amdhsa_user_sgpr_count 2
  .amdhsa_user_sgpr_kernarg_segment_ptr 1
  .amdhsa_system_sgpr_workgroup_id_x 1
.end_amdhsa_kernel
.text
.section .rodata,"a"
.p2align 6
.amdhsa_kernel final_kernel
  .amdhsa_next_free_vgpr 236
  .amdhsa_next_free_sgpr 102
  .amdhsa_accum_offset 236
  .amdhsa_group_segment_fixed_size 0
  .amdhsa_kernarg_size 88
  .amdhsa_user_sgpr_count 2
  .amdhsa_user_sgpr_kernarg_segment_ptr 1
  .amdhsa_system_sgpr_workgroup_id_x 1
.end_amdhsa_kernel
.text
```
